```python
import torch

def _softmax(x, axis=-1):
    return torch.softmax(x, dim=axis)
def _gelu(x):
    return torch.nn.functional.gelu(x, approximate="tanh")
def _silu(x):
    return torch.nn.functional.silu(x)
def _sigmoid(x):
    return torch.sigmoid(x)
def _layernorm(x, axis=-1, eps=1e-5):
    m = x.mean(dim=axis, keepdim=True)
    v = x.var(dim=axis, keepdim=True, unbiased=False)
    return (x - m) / torch.sqrt(v + eps)
def _scatter_add(tgt, idx, src, axis=0):
    return tgt.clone().index_add_(axis, idx, src)
def _segment_sum(src, seg, n):
    out = torch.zeros((n,) + src.shape[1:], dtype=src.dtype)
    return out.index_add_(0, seg, src)
def _pad(x, pw):
    flat = tuple(v for pair in reversed(pw) for v in pair)
    return torch.nn.functional.pad(x, flat)

kernel_name = 'gated_mix__linear_kernel_hedgehog__glu_gated_glu__prompt'

def setup_inputs():

    _w = (lambda a: (lambda t: t.to(torch.bfloat16) if t.is_floating_point() else t)(torch.as_tensor(a)))
    def _A_setup():
        B, S, D, H = 1, 2048, 1024, 32
        Dh = D // H
        return {
            "x": _w((lambda *s: torch.randn(*s, dtype=torch.bfloat16) * 0.05)(B, S, D)),
            "wqkv": _w((lambda *s: torch.randn(*s, dtype=torch.bfloat16) * 0.8)(D, 3 * D)),
            "w_phi": _w((lambda *s: torch.randn(*s, dtype=torch.bfloat16) * 0.8)(H, Dh, Dh) * (Dh ** -0.5)),
            "wo": _w((lambda *s: torch.randn(*s, dtype=torch.bfloat16) * 0.1)(D, D)),
        }
    _A_in = _A_setup()

    def _B_setup():
        B, S, D, F = 1, 2048, 1024, 3584
        return {
            "x": _w((lambda *s: torch.randn(*s, dtype=torch.bfloat16) * 0.05)(B, S, D)),
            "w_gate": _w((lambda *s: torch.randn(*s, dtype=torch.bfloat16) * 0.2)(D, F)),
            "w_up": _w((lambda *s: torch.randn(*s, dtype=torch.bfloat16) * 0.05)(D, F)),
            "w_down": _w((lambda *s: torch.randn(*s, dtype=torch.bfloat16) * 0.05)(F, D)),
        }
    _B_in = _B_setup()

    return {
        "A_x": _A_in["x"],
        "A_wqkv": _A_in["wqkv"],
        "A_w_phi": _A_in["w_phi"],
        "A_wo": _A_in["wo"],
        "B_x": _B_in["x"],
        "B_w_gate": _B_in["w_gate"],
        "B_w_up": _B_in["w_up"],
        "B_w_down": _B_in["w_down"],
        "gate_w": _w((lambda *s: torch.randn(*s, dtype=torch.bfloat16) * 0.05)(1024) * 16.0),
    }

def reference(A_x, A_wqkv, A_w_phi, A_wo, B_x, B_w_gate, B_w_up, B_w_down, gate_w):
    def _A_ref(x, wqkv, w_phi, wo):
        B, S, D = x.shape
        H = 32; Dh = D // H
        qkv = (lambda x, *d: x.permute(*d))((x @ wqkv).reshape(B, S, 3, H, Dh), 2, 0, 3, 1, 4)
        q, k, v = qkv[0], qkv[1], qkv[2]
        pq = torch.einsum("bhsd,hdf->bhsf", q, w_phi)
        pk = torch.einsum("bhsd,hdf->bhsf", k, w_phi)
        phi_q = torch.concatenate([_softmax(pq, axis=-1), _softmax(-pq, axis=-1)], axis=-1)
        phi_k = torch.concatenate([_softmax(pk, axis=-1), _softmax(-pk, axis=-1)], axis=-1)
        kv = torch.einsum("bhsf,bhsd->bhfd", phi_k, v)
        z  = torch.einsum("bhsf->bhf", phi_k)
        num = torch.einsum("bhqf,bhfd->bhqd", phi_q, kv)
        den = torch.einsum("bhqf,bhf->bhq", phi_q, z)[..., None] + 1e-6
        o = num / den
        return (lambda x, *d: x.permute(*d))(o, 0, 2, 1, 3).reshape(B, S, D) @ wo

    def _B_ref(x, w_gate, w_up, w_down):
        g = torch.einsum("bsd,df->bsf", x, w_gate)
        u = torch.einsum("bsd,df->bsf", x, w_up)
        h = _sigmoid(g) * u
        return torch.einsum("bsf,fd->bsd", h, w_down)

    x = A_x
    g = _sigmoid((x * gate_w).sum(-1, keepdims=True))
    a = _A_ref(x, A_wqkv, A_w_phi, A_wo)
    b = _B_ref(x, B_w_gate, B_w_up, B_w_down)
    return g * a + (1 - g) * b
```

```asm
; @launch grid=(256,1,1) block=(512,1,1) lds=163840
.amdgcn_target "amdgcn-amd-amdhsa--gfx950"
.text
.globl gated_mix__linear_kernel_hedgehog__glu_gated_glu__prompt_kernel
.p2align 8
.type gated_mix__linear_kernel_hedgehog__glu_gated_glu__prompt_kernel,@function
gated_mix__linear_kernel_hedgehog__glu_gated_glu__prompt_kernel:
    s_load_dwordx4 s[4:7], s[0:1], 0
    s_load_dwordx4 s[52:55], s[0:1], 40
    s_load_dwordx4 s[56:59], s[0:1], 80
    s_load_dwordx2 s[66:67], s[0:1], 16
    s_load_dwordx4 s[40:43], s[0:1], 56
    s_cmp_ge_u32 s2, 256
    s_cbranch_scc1 L_end
    s_getpc_b64 s[72:73]
L_pc:
    s_mov_b32 s74, L_code_end-L_pc
    s_mov_b32 s75, 0x20000
    s_and_b32 s73, s73, 0xffff
    v_lshrrev_b32 v23, 6, v0
    v_and_b32 v1, 63, v0
    v_readfirstlane_b32 s30, v23
    v_mul_u32_u24 v23, 384, v23
    v_lshl_add_u32 v23, v1, 7, v23
    s_lshr_b32 s3, s2, 3
    s_mul_i32 s3, s3, 3072
    v_cmp_gt_u32 vcc, 3, v1
    v_mov_b32 v25, 0x7ffffff0
    s_nop 0
    v_cndmask_b32 v23, v25, v23, vcc
    buffer_load_dword v22, v23, s[72:75], s3 offen
    s_lshr_b32 s24, s2, 3
    s_and_b32 s24, s24, 7
    s_and_b32 s3, s2, 7
    s_lshl_b32 s3, s3, 2
    s_lshr_b32 s25, s2, 6
    s_add_u32 s25, s25, s3
    s_and_b32 s26, s30, 3
    v_lshrrev_b32 v23, 3, v1
    v_lshlrev_b32 v23, 11, v23
    v_and_b32 v24, 7, v1
    v_lshrrev_b32 v25, 4, v1
    v_xor_b32 v24, v24, v25
    v_lshl_add_u32 v23, v24, 4, v23
    s_lshl_b32 s3, s26, 17
    v_add_u32 v23, s3, v23
    v_xor_b32 v24, 64, v23
    s_lshl_b32 s32, s26, 13
    s_add_u32 s33, s32, 4096
    s_mov_b32 s28, 0
    s_mov_b32 s29, 0
    s_lshl_b32 s64, s24, 19
    s_mov_b32 s38, 0x3fb8aa3b
    s_mov_b32 s39, 0x3fb8aa3b
    s_cmp_ge_u32 s30, 4
    s_cbranch_scc1 L_classG
    v_add_u32 v2, 0, v23
    v_add_u32 v3, 15360, v24
    v_add_u32 v4, 30720, v23
    v_add_u32 v5, 46080, v24
    v_add_u32 v6, 65536, v23
    v_add_u32 v7, 80896, v24
    s_mul_i32 s34, s26, 3072
    s_add_u32 s34, s34, 32768
    s_waitcnt lgkmcnt(0)
    s_add_u32 s8, s4, s64
    s_addc_u32 s9, s5, 0
    s_sub_u32 s10, 4194304, s64
    s_mov_b32 s11, 0x20000
    s_mov_b32 m0, s32
    s_nop 0
    buffer_load_dwordx4 v2, s[8:11], s28 offen offset:0 lds
    buffer_load_dwordx4 v3, s[8:11], s28 offen offset:1024 lds
    buffer_load_dwordx4 v4, s[8:11], s28 offen offset:2048 lds
    buffer_load_dwordx4 v5, s[8:11], s28 offen offset:3072 lds
    s_mov_b32 m0, s33
    s_nop 0
    buffer_load_dwordx4 v6, s[8:11], s28 offen offset:0 lds
    buffer_load_dwordx4 v7, s[8:11], s28 offen offset:1024 lds
    s_lshl_b32 s3, s25, 6
    s_add_u32 s12, s6, s3
    s_addc_u32 s13, s7, 0
    s_sub_u32 s14, 6291456, s3
    s_mov_b32 s15, 0x20000
    s_mul_i32 s3, s26, 192
    v_add_u32 v23, s3, v1
    v_mul_u32_u24 v24, 5462, v23
    v_lshrrev_b32 v24, 16, v24
    v_mul_u32_u24 v25, 12, v24
    v_sub_u32 v25, v23, v25
    v_bfe_u32 v26, v24, 2, 1
    v_lshlrev_b32 v26, 1, v26
    v_xor_b32 v25, v25, v26
    v_and_b32 v27, 0xfffffff3, v24
    v_bfe_u32 v26, v24, 2, 1
    v_lshl_or_b32 v27, v26, 3, v27
    v_bfe_u32 v26, v24, 3, 1
    v_lshl_or_b32 v27, v26, 2, v27
    v_mul_u32_u24 v24, 6144, v27
    v_lshrrev_b32 v26, 2, v25
    v_lshlrev_b32 v26, 11, v26
    v_and_b32 v25, 3, v25
    v_lshlrev_b32 v25, 4, v25
    v_add3_u32 v24, v24, v25, v26
    v_subrev_u32 v8, 0, v24
    s_mov_b32 m0, s34
    s_nop 0
    buffer_load_dwordx4 v8, s[12:15], s29 offen offset:0 lds
    v_add_u32 v23, s3, v1
    v_add_u32 v23, 64, v23
    v_mul_u32_u24 v24, 5462, v23
    v_lshrrev_b32 v24, 16, v24
    v_mul_u32_u24 v25, 12, v24
    v_sub_u32 v25, v23, v25
    v_bfe_u32 v26, v24, 2, 1
    v_lshlrev_b32 v26, 1, v26
    v_xor_b32 v25, v25, v26
    v_and_b32 v27, 0xfffffff3, v24
    v_bfe_u32 v26, v24, 2, 1
    v_lshl_or_b32 v27, v26, 3, v27
    v_bfe_u32 v26, v24, 3, 1
    v_lshl_or_b32 v27, v26, 2, v27
    v_mul_u32_u24 v24, 6144, v27
    v_lshrrev_b32 v26, 2, v25
    v_lshlrev_b32 v26, 11, v26
    v_and_b32 v25, 3, v25
    v_lshlrev_b32 v25, 4, v25
    v_add3_u32 v24, v24, v25, v26
    v_subrev_u32 v9, 1024, v24
    buffer_load_dwordx4 v9, s[12:15], s29 offen offset:1024 lds
    v_add_u32 v23, s3, v1
    v_add_u32 v23, 128, v23
    v_mul_u32_u24 v24, 5462, v23
    v_lshrrev_b32 v24, 16, v24
    v_mul_u32_u24 v25, 12, v24
    v_sub_u32 v25, v23, v25
    v_bfe_u32 v26, v24, 2, 1
    v_lshlrev_b32 v26, 1, v26
    v_xor_b32 v25, v25, v26
    v_and_b32 v27, 0xfffffff3, v24
    v_bfe_u32 v26, v24, 2, 1
    v_lshl_or_b32 v27, v26, 3, v27
    v_bfe_u32 v26, v24, 3, 1
    v_lshl_or_b32 v27, v26, 2, v27
    v_mul_u32_u24 v24, 6144, v27
    v_lshrrev_b32 v26, 2, v25
    v_lshlrev_b32 v26, 11, v26
    v_and_b32 v25, 3, v25
    v_lshlrev_b32 v25, 4, v25
    v_add3_u32 v24, v24, v25, v26
    v_subrev_u32 v10, 2048, v24
    buffer_load_dwordx4 v10, s[12:15], s29 offen offset:2048 lds
    s_add_u32 s28, s28, 128
    s_add_u32 s29, s29, 393216
    s_mov_b32 s20, s58
    s_mov_b32 s21, s59
    s_mov_b32 s22, 35913728
    s_mov_b32 s23, 0x20000
    s_lshl_b32 s3, s24, 2
    s_add_u32 s3, s3, s26
    s_lshl_b32 s45, s3, 2
    s_lshr_b32 s3, s3, 1
    s_lshl_b32 s3, s3, 5
    s_add_u32 s3, s3, s25
    s_lshl_b32 s3, s3, 1
    s_and_b32 s60, s26, 1
    s_add_u32 s3, s3, s60
    s_lshl_b32 s65, s3, 2
    s_add_u32 s65, s65, 21594112
    s_lshl_b32 s77, s3, 3
    s_add_u32 s77, s77, 21577728
    v_mov_b32 v23, s77
    s_lshl_b32 s44, s25, 7
    s_add_u32 s44, s44, 21561344
    s_add_u32 s3, s44, s45
    v_writelane_b32 v23, s3, 1
    v_writelane_b32 v23, s65, 2
    v_mov_b32 v24, 0
    buffer_store_dword v24, v23, s[20:23], 0 offen sc1
    v_and_b32 v27, 15, v1
    v_lshlrev_b32 v27, 7, v27
    v_add_u32 v27, s32, v27
    v_bfe_u32 v28, v1, 1, 3
    v_lshrrev_b32 v29, 4, v1
    v_or_b32 v30, 0, v29
    v_xor_b32 v30, v30, v28
    v_lshl_add_u32 v11, v30, 4, v27
    v_add_u32 v13, 73984, v11
    v_or_b32 v30, 4, v29
    v_xor_b32 v30, v30, v28
    v_lshl_add_u32 v12, v30, 4, v27
    v_add_u32 v14, 73984, v12
    v_bfe_u32 v27, v1, 2, 2
    v_and_b32 v28, 3, v1
    v_bfe_u32 v30, v1, 4, 1
    v_lshrrev_b32 v31, 5, v1
    v_lshl_add_u32 v27, v31, 4, v27
    v_lshl_add_u32 v27, v30, 2, v27
    v_lshlrev_b32 v28, 3, v28
    v_mul_u32_u24 v29, 192, v27
    v_add_u32 v29, v29, v28
    v_xor_b32 v31, 0, v30
    v_lshl_add_u32 v31, v31, 5, v29
    v_add_u32 v15, 32768, v31
    v_add_u32 v17, 106752, v31
    v_xor_b32 v31, 1, v30
    v_lshl_add_u32 v31, v31, 5, v29
    v_add_u32 v16, 32768, v31
    v_add_u32 v18, 106752, v31
    v_mul_u32_u24 v29, 224, v27
    v_add_u32 v31, v29, v28
    v_add_u32 v19, 45056, v31
    v_add_u32 v20, 119040, v31
    s_lshl_b32 s3, s25, 11
    s_add_u32 s72, s66, s3
    s_addc_u32 s73, s67, 0
    s_sub_u32 s74, 65536, s3
    s_mov_b32 s75, 0x20000
    s_mov_b32 s68, s4
    s_mov_b32 s69, s5
    s_mov_b32 s70, 4194304
    s_mov_b32 s71, 0x20000
    s_and_b32 s3, s26, 1
    s_lshl_b32 s47, s3, 10
    v_lshl_add_u32 v21, v1, 4, s47
    s_mov_b32 s48, s56
    s_mov_b32 s49, s57
    s_mov_b32 s50, 256
    s_mov_b32 s51, 0x20000
    s_load_dwordx2 s[4:5], s[0:1], 24
    s_lshl_b32 s3, s25, 3
    s_add_u32 s3, s3, s24
    s_cmp_eq_u32 s26, 0
    s_cselect_b32 s3, s3, 0x1000
    v_mov_b32 v23, s3
    v_mov_b32 v24, 1
    s_waitcnt vmcnt(0) lgkmcnt(0)
    s_barrier
    ds_read_b128 a[0:3], v11 offset:0
    ds_read_b128 a[4:7], v11 offset:2048
    ds_read_b128 a[8:11], v11 offset:4096
    ds_read_b128 a[12:15], v11 offset:6144
    ds_read_b64_tr_b16 a[32:33], v15 offset:64
    ds_read_b64_tr_b16 a[34:35], v15 offset:1600
    ds_read_b64_tr_b16 a[36:37], v16 offset:64
    ds_read_b64_tr_b16 a[38:39], v16 offset:1600
    ds_read_b64_tr_b16 a[40:41], v15 offset:128
    ds_read_b64_tr_b16 a[42:43], v15 offset:1664
    s_waitcnt lgkmcnt(4)
    v_mfma_f32_16x16x32_bf16 v[32:35], a[32:35], a[0:3], 0
    ds_read_b64_tr_b16 a[44:45], v16 offset:128
    v_mfma_f32_16x16x32_bf16 v[36:39], a[32:35], a[4:7], 0
    ds_read_b64_tr_b16 a[46:47], v16 offset:1664
    v_mfma_f32_16x16x32_bf16 v[40:43], a[32:35], a[8:11], 0
    s_add_u32 m0, s32, 73984
    s_nop 0
    buffer_load_dwordx4 v2, s[8:11], s28 offen offset:0 lds
    v_mfma_f32_16x16x32_bf16 v[44:47], a[32:35], a[12:15], 0
    s_waitcnt lgkmcnt(4)
    v_mfma_f32_16x16x32_bf16 v[48:51], a[36:39], a[0:3], 0
    ds_read_b64_tr_b16 a[48:49], v15 offset:0
    v_mfma_f32_16x16x32_bf16 v[52:55], a[36:39], a[4:7], 0
    ds_read_b64_tr_b16 a[50:51], v15 offset:1536
    v_mfma_f32_16x16x32_bf16 v[56:59], a[36:39], a[8:11], 0
    ds_read_b128 a[16:19], v12 offset:0
    buffer_load_dwordx4 v3, s[8:11], s28 offen offset:1024 lds
    v_mfma_f32_16x16x32_bf16 v[60:63], a[36:39], a[12:15], 0
    s_waitcnt lgkmcnt(5)
    v_mfma_f32_16x16x32_bf16 v[64:67], a[0:3], a[40:43], 0
    ds_read_b64_tr_b16 a[32:33], v16 offset:0
    v_mfma_f32_16x16x32_bf16 v[68:71], a[4:7], a[40:43], 0
    ds_read_b64_tr_b16 a[34:35], v16 offset:1536
    v_mfma_f32_16x16x32_bf16 v[72:75], a[8:11], a[40:43], 0
    buffer_load_dwordx4 v4, s[8:11], s28 offen offset:2048 lds
    v_mfma_f32_16x16x32_bf16 v[76:79], a[12:15], a[40:43], 0
    s_waitcnt lgkmcnt(5)
    v_mfma_f32_16x16x32_bf16 v[80:83], a[0:3], a[44:47], 0
    ds_read_b64_tr_b16 a[36:37], v19 offset:0
    v_mfma_f32_16x16x32_bf16 v[84:87], a[4:7], a[44:47], 0
    ds_read_b64_tr_b16 a[38:39], v19 offset:1792
    v_mfma_f32_16x16x32_bf16 v[88:91], a[8:11], a[44:47], 0
    ds_read_b128 a[20:23], v12 offset:2048
    buffer_load_dwordx4 v5, s[8:11], s28 offen offset:3072 lds
    v_mfma_f32_16x16x32_bf16 v[92:95], a[12:15], a[44:47], 0
    s_waitcnt lgkmcnt(6)
    v_mfma_f32_16x16x32_bf16 v[96:99], a[48:51], a[0:3], 0
    ds_read_b64_tr_b16 a[40:41], v19 offset:14464
    v_mfma_f32_16x16x32_bf16 v[100:103], a[48:51], a[4:7], 0
    ds_read_b64_tr_b16 a[42:43], v19 offset:16256
    v_mfma_f32_16x16x32_bf16 v[104:107], a[48:51], a[8:11], 0
    s_add_u32 m0, s33, 73984
    s_nop 0
    buffer_load_dwordx4 v6, s[8:11], s28 offen offset:0 lds
    v_mfma_f32_16x16x32_bf16 v[108:111], a[48:51], a[12:15], 0
    s_waitcnt lgkmcnt(5)
    v_mfma_f32_16x16x32_bf16 v[112:115], a[32:35], a[0:3], 0
    ds_read_b64_tr_b16 a[44:45], v19 offset:32
    v_mfma_f32_16x16x32_bf16 v[116:119], a[32:35], a[4:7], 0
    ds_read_b64_tr_b16 a[46:47], v19 offset:1824
    v_mfma_f32_16x16x32_bf16 v[120:123], a[32:35], a[8:11], 0
    ds_read_b128 a[24:27], v12 offset:4096
    buffer_load_dwordx4 v7, s[8:11], s28 offen offset:1024 lds
    v_mfma_f32_16x16x32_bf16 v[124:127], a[32:35], a[12:15], 0
    s_waitcnt lgkmcnt(6)
    v_mfma_f32_16x16x32_bf16 v[128:131], a[36:39], a[0:3], 0
    ds_read_b64_tr_b16 a[48:49], v19 offset:14496
    v_mfma_f32_16x16x32_bf16 v[132:135], a[36:39], a[4:7], 0
    ds_read_b64_tr_b16 a[50:51], v19 offset:16288
    v_mfma_f32_16x16x32_bf16 v[136:139], a[36:39], a[8:11], 0
    s_add_u32 m0, s34, 73984
    s_nop 0
    buffer_load_dwordx4 v8, s[12:15], s29 offen offset:0 lds
    v_mfma_f32_16x16x32_bf16 v[140:143], a[36:39], a[12:15], 0
    s_waitcnt lgkmcnt(5)
    v_mfma_f32_16x16x32_bf16 v[144:147], a[40:43], a[0:3], 0
    ds_read_b64_tr_b16 a[32:33], v15 offset:6208
    v_mfma_f32_16x16x32_bf16 v[148:151], a[40:43], a[4:7], 0
    ds_read_b64_tr_b16 a[34:35], v15 offset:7744
    v_mfma_f32_16x16x32_bf16 v[152:155], a[40:43], a[8:11], 0
    ds_read_b128 a[28:31], v12 offset:6144
    buffer_load_dwordx4 v9, s[12:15], s29 offen offset:1024 lds
    v_mfma_f32_16x16x32_bf16 v[156:159], a[40:43], a[12:15], 0
    s_waitcnt lgkmcnt(6)
    v_mfma_f32_16x16x32_bf16 v[160:163], a[44:47], a[0:3], 0
    ds_read_b64_tr_b16 a[36:37], v16 offset:6208
    v_mfma_f32_16x16x32_bf16 v[164:167], a[44:47], a[4:7], 0
    ds_read_b64_tr_b16 a[38:39], v16 offset:7744
    v_mfma_f32_16x16x32_bf16 v[168:171], a[44:47], a[8:11], 0
    buffer_load_dwordx4 v10, s[12:15], s29 offen offset:2048 lds
    s_add_u32 s28, s28, 128
    s_add_u32 s29, s29, 393216
    v_mfma_f32_16x16x32_bf16 v[172:175], a[44:47], a[12:15], 0
    s_waitcnt lgkmcnt(5)
    v_mfma_f32_16x16x32_bf16 v[176:179], a[48:51], a[0:3], 0
    ds_read_b64_tr_b16 a[40:41], v15 offset:6272
    v_mfma_f32_16x16x32_bf16 v[180:183], a[48:51], a[4:7], 0
    ds_read_b64_tr_b16 a[42:43], v15 offset:7808
    v_mfma_f32_16x16x32_bf16 v[184:187], a[48:51], a[8:11], 0
    s_add_u32 m0, s47, 147968
    s_nop 0
    buffer_load_dwordx4 v21, s[72:75], 0 offen lds
    v_mfma_f32_16x16x32_bf16 v[188:191], a[48:51], a[12:15], 0
    s_waitcnt lgkmcnt(4)
    v_mfma_f32_16x16x32_bf16 v[32:35], a[32:35], a[16:19], v[32:35]
    ds_read_b64_tr_b16 a[44:45], v16 offset:6272
    v_mfma_f32_16x16x32_bf16 v[36:39], a[32:35], a[20:23], v[36:39]
    ds_read_b64_tr_b16 a[46:47], v16 offset:7808
    v_mfma_f32_16x16x32_bf16 v[40:43], a[32:35], a[24:27], v[40:43]
    v_mfma_f32_16x16x32_bf16 v[44:47], a[32:35], a[28:31], v[44:47]
    s_waitcnt lgkmcnt(4)
    v_mfma_f32_16x16x32_bf16 v[48:51], a[36:39], a[16:19], v[48:51]
    ds_read_b64_tr_b16 a[48:49], v15 offset:6144
    v_mfma_f32_16x16x32_bf16 v[52:55], a[36:39], a[20:23], v[52:55]
    ds_read_b64_tr_b16 a[50:51], v15 offset:7680
    v_mfma_f32_16x16x32_bf16 v[56:59], a[36:39], a[24:27], v[56:59]
    v_mfma_f32_16x16x32_bf16 v[60:63], a[36:39], a[28:31], v[60:63]
    s_waitcnt lgkmcnt(4)
    v_mfma_f32_16x16x32_bf16 v[64:67], a[16:19], a[40:43], v[64:67]
    ds_read_b64_tr_b16 a[32:33], v16 offset:6144
    v_mfma_f32_16x16x32_bf16 v[68:71], a[20:23], a[40:43], v[68:71]
    ds_read_b64_tr_b16 a[34:35], v16 offset:7680
    v_mfma_f32_16x16x32_bf16 v[72:75], a[24:27], a[40:43], v[72:75]
    v_mfma_f32_16x16x32_bf16 v[76:79], a[28:31], a[40:43], v[76:79]
    s_waitcnt lgkmcnt(4)
    v_mfma_f32_16x16x32_bf16 v[80:83], a[16:19], a[44:47], v[80:83]
    ds_read_b64_tr_b16 a[36:37], v19 offset:7168
    v_mfma_f32_16x16x32_bf16 v[84:87], a[20:23], a[44:47], v[84:87]
    ds_read_b64_tr_b16 a[38:39], v19 offset:8960
    v_mfma_f32_16x16x32_bf16 v[88:91], a[24:27], a[44:47], v[88:91]
    v_mfma_f32_16x16x32_bf16 v[92:95], a[28:31], a[44:47], v[92:95]
    s_waitcnt lgkmcnt(4)
    v_mfma_f32_16x16x32_bf16 v[96:99], a[48:51], a[16:19], v[96:99]
    ds_read_b64_tr_b16 a[40:41], v19 offset:21632
    v_mfma_f32_16x16x32_bf16 v[100:103], a[48:51], a[20:23], v[100:103]
    ds_read_b64_tr_b16 a[42:43], v19 offset:23424
    v_mfma_f32_16x16x32_bf16 v[104:107], a[48:51], a[24:27], v[104:107]
    v_mfma_f32_16x16x32_bf16 v[108:111], a[48:51], a[28:31], v[108:111]
    s_waitcnt lgkmcnt(4)
    v_mfma_f32_16x16x32_bf16 v[112:115], a[32:35], a[16:19], v[112:115]
    ds_read_b64_tr_b16 a[44:45], v19 offset:7200
    v_mfma_f32_16x16x32_bf16 v[116:119], a[32:35], a[20:23], v[116:119]
    ds_read_b64_tr_b16 a[46:47], v19 offset:8992
    v_mfma_f32_16x16x32_bf16 v[120:123], a[32:35], a[24:27], v[120:123]
    ds_read_b64_tr_b16 a[48:49], v19 offset:21664
    v_mfma_f32_16x16x32_bf16 v[124:127], a[32:35], a[28:31], v[124:127]
    ds_read_b64_tr_b16 a[50:51], v19 offset:23456
    s_waitcnt lgkmcnt(6)
    v_mfma_f32_16x16x32_bf16 v[128:131], a[36:39], a[16:19], v[128:131]
    v_mfma_f32_16x16x32_bf16 v[132:135], a[36:39], a[20:23], v[132:135]
    v_mfma_f32_16x16x32_bf16 v[136:139], a[36:39], a[24:27], v[136:139]
    v_mfma_f32_16x16x32_bf16 v[140:143], a[36:39], a[28:31], v[140:143]
    s_waitcnt lgkmcnt(0) vmcnt(1)
    s_barrier
    buffer_store_byte v24, v23, s[48:51], 0 offen sc1
    v_mfma_f32_16x16x32_bf16 v[144:147], a[40:43], a[16:19], v[144:147]
    ds_read_b64_tr_b16 a[32:33], v17 offset:64
    v_mfma_f32_16x16x32_bf16 v[148:151], a[40:43], a[20:23], v[148:151]
    ds_read_b64_tr_b16 a[34:35], v17 offset:1600
    v_mfma_f32_16x16x32_bf16 v[152:155], a[40:43], a[24:27], v[152:155]
    ds_read_b128 a[0:3], v13 offset:0
    s_mov_b32 m0, s32
    s_nop 0
    buffer_load_dwordx4 v2, s[8:11], s28 offen offset:0 lds
    v_mfma_f32_16x16x32_bf16 v[156:159], a[40:43], a[28:31], v[156:159]
    ds_read_b128 a[4:7], v13 offset:2048
    s_waitcnt lgkmcnt(6)
    v_mfma_f32_16x16x32_bf16 v[160:163], a[44:47], a[16:19], v[160:163]
    ds_read_b64_tr_b16 a[36:37], v18 offset:64
    v_mfma_f32_16x16x32_bf16 v[164:167], a[44:47], a[20:23], v[164:167]
    ds_read_b64_tr_b16 a[38:39], v18 offset:1600
    v_mfma_f32_16x16x32_bf16 v[168:171], a[44:47], a[24:27], v[168:171]
    ds_read_b128 a[8:11], v13 offset:4096
    buffer_load_dwordx4 v3, s[8:11], s28 offen offset:1024 lds
    v_mfma_f32_16x16x32_bf16 v[172:175], a[44:47], a[28:31], v[172:175]
    ds_read_b128 a[12:15], v13 offset:6144
    s_waitcnt lgkmcnt(8)
    v_mfma_f32_16x16x32_bf16 v[176:179], a[48:51], a[16:19], v[176:179]
    ds_read_b64_tr_b16 a[40:41], v17 offset:128
    v_mfma_f32_16x16x32_bf16 v[180:183], a[48:51], a[20:23], v[180:183]
    ds_read_b64_tr_b16 a[42:43], v17 offset:1664
    v_mfma_f32_16x16x32_bf16 v[184:187], a[48:51], a[24:27], v[184:187]
    buffer_load_dwordx4 v4, s[8:11], s28 offen offset:2048 lds
    v_mfma_f32_16x16x32_bf16 v[188:191], a[48:51], a[28:31], v[188:191]
    s_mov_b32 s27, 0
L_k1_loop0:
    s_waitcnt lgkmcnt(2)
    v_mfma_f32_16x16x32_bf16 v[32:35], a[32:35], a[0:3], v[32:35]
    ds_read_b64_tr_b16 a[44:45], v18 offset:128
    v_mfma_f32_16x16x32_bf16 v[36:39], a[32:35], a[4:7], v[36:39]
    ds_read_b64_tr_b16 a[46:47], v18 offset:1664
    v_mfma_f32_16x16x32_bf16 v[40:43], a[32:35], a[8:11], v[40:43]
    buffer_load_dwordx4 v5, s[8:11], s28 offen offset:3072 lds
    v_mfma_f32_16x16x32_bf16 v[44:47], a[32:35], a[12:15], v[44:47]
    s_waitcnt lgkmcnt(6)
    v_mfma_f32_16x16x32_bf16 v[48:51], a[36:39], a[0:3], v[48:51]
    ds_read_b64_tr_b16 a[48:49], v17 offset:0
    v_mfma_f32_16x16x32_bf16 v[52:55], a[36:39], a[4:7], v[52:55]
    ds_read_b64_tr_b16 a[50:51], v17 offset:1536
    v_mfma_f32_16x16x32_bf16 v[56:59], a[36:39], a[8:11], v[56:59]
    ds_read_b128 a[16:19], v14 offset:0
    s_mov_b32 m0, s33
    s_nop 0
    buffer_load_dwordx4 v6, s[8:11], s28 offen offset:0 lds
    v_mfma_f32_16x16x32_bf16 v[60:63], a[36:39], a[12:15], v[60:63]
    s_waitcnt lgkmcnt(5)
    v_mfma_f32_16x16x32_bf16 v[64:67], a[0:3], a[40:43], v[64:67]
    ds_read_b64_tr_b16 a[32:33], v18 offset:0
    v_mfma_f32_16x16x32_bf16 v[68:71], a[4:7], a[40:43], v[68:71]
    ds_read_b64_tr_b16 a[34:35], v18 offset:1536
    v_mfma_f32_16x16x32_bf16 v[72:75], a[8:11], a[40:43], v[72:75]
    buffer_load_dwordx4 v7, s[8:11], s28 offen offset:1024 lds
    v_mfma_f32_16x16x32_bf16 v[76:79], a[12:15], a[40:43], v[76:79]
    s_waitcnt lgkmcnt(5)
    v_mfma_f32_16x16x32_bf16 v[80:83], a[0:3], a[44:47], v[80:83]
    ds_read_b64_tr_b16 a[36:37], v20 offset:0
    v_mfma_f32_16x16x32_bf16 v[84:87], a[4:7], a[44:47], v[84:87]
    ds_read_b64_tr_b16 a[38:39], v20 offset:1792
    v_mfma_f32_16x16x32_bf16 v[88:91], a[8:11], a[44:47], v[88:91]
    ds_read_b128 a[20:23], v14 offset:2048
    s_mov_b32 m0, s34
    s_nop 0
    buffer_load_dwordx4 v8, s[12:15], s29 offen offset:0 lds
    v_mfma_f32_16x16x32_bf16 v[92:95], a[12:15], a[44:47], v[92:95]
    s_waitcnt lgkmcnt(6)
    v_mfma_f32_16x16x32_bf16 v[96:99], a[48:51], a[0:3], v[96:99]
    ds_read_b64_tr_b16 a[40:41], v20 offset:14464
    v_mfma_f32_16x16x32_bf16 v[100:103], a[48:51], a[4:7], v[100:103]
    ds_read_b64_tr_b16 a[42:43], v20 offset:16256
    v_mfma_f32_16x16x32_bf16 v[104:107], a[48:51], a[8:11], v[104:107]
    buffer_load_dwordx4 v9, s[12:15], s29 offen offset:1024 lds
    v_mfma_f32_16x16x32_bf16 v[108:111], a[48:51], a[12:15], v[108:111]
    s_waitcnt lgkmcnt(5)
    v_mfma_f32_16x16x32_bf16 v[112:115], a[32:35], a[0:3], v[112:115]
    ds_read_b64_tr_b16 a[44:45], v20 offset:32
    v_mfma_f32_16x16x32_bf16 v[116:119], a[32:35], a[4:7], v[116:119]
    ds_read_b64_tr_b16 a[46:47], v20 offset:1824
    v_mfma_f32_16x16x32_bf16 v[120:123], a[32:35], a[8:11], v[120:123]
    ds_read_b128 a[24:27], v14 offset:4096
    buffer_load_dwordx4 v10, s[12:15], s29 offen offset:2048 lds
    s_add_u32 s28, s28, 128
    s_add_u32 s29, s29, 393216
    v_mfma_f32_16x16x32_bf16 v[124:127], a[32:35], a[12:15], v[124:127]
    s_waitcnt lgkmcnt(6)
    v_mfma_f32_16x16x32_bf16 v[128:131], a[36:39], a[0:3], v[128:131]
    ds_read_b64_tr_b16 a[48:49], v20 offset:14496
    v_mfma_f32_16x16x32_bf16 v[132:135], a[36:39], a[4:7], v[132:135]
    ds_read_b64_tr_b16 a[50:51], v20 offset:16288
    v_mfma_f32_16x16x32_bf16 v[136:139], a[36:39], a[8:11], v[136:139]
    v_mfma_f32_16x16x32_bf16 v[140:143], a[36:39], a[12:15], v[140:143]
    s_waitcnt lgkmcnt(5)
    v_mfma_f32_16x16x32_bf16 v[144:147], a[40:43], a[0:3], v[144:147]
    ds_read_b64_tr_b16 a[32:33], v17 offset:6208
    v_mfma_f32_16x16x32_bf16 v[148:151], a[40:43], a[4:7], v[148:151]
    ds_read_b64_tr_b16 a[34:35], v17 offset:7744
    v_mfma_f32_16x16x32_bf16 v[152:155], a[40:43], a[8:11], v[152:155]
    ds_read_b128 a[28:31], v14 offset:6144
    v_mfma_f32_16x16x32_bf16 v[156:159], a[40:43], a[12:15], v[156:159]
    s_waitcnt lgkmcnt(6)
    v_mfma_f32_16x16x32_bf16 v[160:163], a[44:47], a[0:3], v[160:163]
    ds_read_b64_tr_b16 a[36:37], v18 offset:6208
    v_mfma_f32_16x16x32_bf16 v[164:167], a[44:47], a[4:7], v[164:167]
    ds_read_b64_tr_b16 a[38:39], v18 offset:7744
    v_mfma_f32_16x16x32_bf16 v[168:171], a[44:47], a[8:11], v[168:171]
    v_mfma_f32_16x16x32_bf16 v[172:175], a[44:47], a[12:15], v[172:175]
    s_waitcnt lgkmcnt(5)
    v_mfma_f32_16x16x32_bf16 v[176:179], a[48:51], a[0:3], v[176:179]
    ds_read_b64_tr_b16 a[40:41], v17 offset:6272
    v_mfma_f32_16x16x32_bf16 v[180:183], a[48:51], a[4:7], v[180:183]
    ds_read_b64_tr_b16 a[42:43], v17 offset:7808
    v_mfma_f32_16x16x32_bf16 v[184:187], a[48:51], a[8:11], v[184:187]
    v_mfma_f32_16x16x32_bf16 v[188:191], a[48:51], a[12:15], v[188:191]
    s_waitcnt lgkmcnt(4)
    v_mfma_f32_16x16x32_bf16 v[32:35], a[32:35], a[16:19], v[32:35]
    ds_read_b64_tr_b16 a[44:45], v18 offset:6272
    v_mfma_f32_16x16x32_bf16 v[36:39], a[32:35], a[20:23], v[36:39]
    ds_read_b64_tr_b16 a[46:47], v18 offset:7808
    v_mfma_f32_16x16x32_bf16 v[40:43], a[32:35], a[24:27], v[40:43]
    v_mfma_f32_16x16x32_bf16 v[44:47], a[32:35], a[28:31], v[44:47]
    s_waitcnt lgkmcnt(4)
    v_mfma_f32_16x16x32_bf16 v[48:51], a[36:39], a[16:19], v[48:51]
    ds_read_b64_tr_b16 a[48:49], v17 offset:6144
    v_mfma_f32_16x16x32_bf16 v[52:55], a[36:39], a[20:23], v[52:55]
    ds_read_b64_tr_b16 a[50:51], v17 offset:7680
    v_mfma_f32_16x16x32_bf16 v[56:59], a[36:39], a[24:27], v[56:59]
    v_mfma_f32_16x16x32_bf16 v[60:63], a[36:39], a[28:31], v[60:63]
    s_waitcnt lgkmcnt(4)
    v_mfma_f32_16x16x32_bf16 v[64:67], a[16:19], a[40:43], v[64:67]
    ds_read_b64_tr_b16 a[32:33], v18 offset:6144
    v_mfma_f32_16x16x32_bf16 v[68:71], a[20:23], a[40:43], v[68:71]
    ds_read_b64_tr_b16 a[34:35], v18 offset:7680
    v_mfma_f32_16x16x32_bf16 v[72:75], a[24:27], a[40:43], v[72:75]
    v_mfma_f32_16x16x32_bf16 v[76:79], a[28:31], a[40:43], v[76:79]
    s_waitcnt lgkmcnt(4)
    v_mfma_f32_16x16x32_bf16 v[80:83], a[16:19], a[44:47], v[80:83]
    ds_read_b64_tr_b16 a[36:37], v20 offset:7168
    v_mfma_f32_16x16x32_bf16 v[84:87], a[20:23], a[44:47], v[84:87]
    ds_read_b64_tr_b16 a[38:39], v20 offset:8960
    v_mfma_f32_16x16x32_bf16 v[88:91], a[24:27], a[44:47], v[88:91]
    v_mfma_f32_16x16x32_bf16 v[92:95], a[28:31], a[44:47], v[92:95]
    s_waitcnt lgkmcnt(4)
    v_mfma_f32_16x16x32_bf16 v[96:99], a[48:51], a[16:19], v[96:99]
    ds_read_b64_tr_b16 a[40:41], v20 offset:21632
    v_mfma_f32_16x16x32_bf16 v[100:103], a[48:51], a[20:23], v[100:103]
    ds_read_b64_tr_b16 a[42:43], v20 offset:23424
    v_mfma_f32_16x16x32_bf16 v[104:107], a[48:51], a[24:27], v[104:107]
    v_mfma_f32_16x16x32_bf16 v[108:111], a[48:51], a[28:31], v[108:111]
    s_waitcnt lgkmcnt(4)
    v_mfma_f32_16x16x32_bf16 v[112:115], a[32:35], a[16:19], v[112:115]
    ds_read_b64_tr_b16 a[44:45], v20 offset:7200
    v_mfma_f32_16x16x32_bf16 v[116:119], a[32:35], a[20:23], v[116:119]
    ds_read_b64_tr_b16 a[46:47], v20 offset:8992
    v_mfma_f32_16x16x32_bf16 v[120:123], a[32:35], a[24:27], v[120:123]
    ds_read_b64_tr_b16 a[48:49], v20 offset:21664
    v_mfma_f32_16x16x32_bf16 v[124:127], a[32:35], a[28:31], v[124:127]
    ds_read_b64_tr_b16 a[50:51], v20 offset:23456
    s_waitcnt lgkmcnt(6)
    v_mfma_f32_16x16x32_bf16 v[128:131], a[36:39], a[16:19], v[128:131]
    v_mfma_f32_16x16x32_bf16 v[132:135], a[36:39], a[20:23], v[132:135]
    v_mfma_f32_16x16x32_bf16 v[136:139], a[36:39], a[24:27], v[136:139]
    v_mfma_f32_16x16x32_bf16 v[140:143], a[36:39], a[28:31], v[140:143]
    s_waitcnt lgkmcnt(0) vmcnt(0)
    s_barrier
    v_mfma_f32_16x16x32_bf16 v[144:147], a[40:43], a[16:19], v[144:147]
    ds_read_b64_tr_b16 a[32:33], v15 offset:64
    v_mfma_f32_16x16x32_bf16 v[148:151], a[40:43], a[20:23], v[148:151]
    ds_read_b64_tr_b16 a[34:35], v15 offset:1600
    v_mfma_f32_16x16x32_bf16 v[152:155], a[40:43], a[24:27], v[152:155]
    ds_read_b128 a[0:3], v11 offset:0
    s_add_u32 m0, s32, 73984
    s_nop 0
    buffer_load_dwordx4 v2, s[8:11], s28 offen offset:0 lds
    v_mfma_f32_16x16x32_bf16 v[156:159], a[40:43], a[28:31], v[156:159]
    ds_read_b128 a[4:7], v11 offset:2048
    s_waitcnt lgkmcnt(6)
    v_mfma_f32_16x16x32_bf16 v[160:163], a[44:47], a[16:19], v[160:163]
    ds_read_b64_tr_b16 a[36:37], v16 offset:64
    v_mfma_f32_16x16x32_bf16 v[164:167], a[44:47], a[20:23], v[164:167]
    ds_read_b64_tr_b16 a[38:39], v16 offset:1600
    v_mfma_f32_16x16x32_bf16 v[168:171], a[44:47], a[24:27], v[168:171]
    ds_read_b128 a[8:11], v11 offset:4096
    buffer_load_dwordx4 v3, s[8:11], s28 offen offset:1024 lds
    v_mfma_f32_16x16x32_bf16 v[172:175], a[44:47], a[28:31], v[172:175]
    ds_read_b128 a[12:15], v11 offset:6144
    s_waitcnt lgkmcnt(8)
    v_mfma_f32_16x16x32_bf16 v[176:179], a[48:51], a[16:19], v[176:179]
    ds_read_b64_tr_b16 a[40:41], v15 offset:128
    v_mfma_f32_16x16x32_bf16 v[180:183], a[48:51], a[20:23], v[180:183]
    ds_read_b64_tr_b16 a[42:43], v15 offset:1664
    v_mfma_f32_16x16x32_bf16 v[184:187], a[48:51], a[24:27], v[184:187]
    buffer_load_dwordx4 v4, s[8:11], s28 offen offset:2048 lds
    v_mfma_f32_16x16x32_bf16 v[188:191], a[48:51], a[28:31], v[188:191]
    s_waitcnt lgkmcnt(2)
    v_mfma_f32_16x16x32_bf16 v[32:35], a[32:35], a[0:3], v[32:35]
    ds_read_b64_tr_b16 a[44:45], v16 offset:128
    v_mfma_f32_16x16x32_bf16 v[36:39], a[32:35], a[4:7], v[36:39]
    ds_read_b64_tr_b16 a[46:47], v16 offset:1664
    v_mfma_f32_16x16x32_bf16 v[40:43], a[32:35], a[8:11], v[40:43]
    buffer_load_dwordx4 v5, s[8:11], s28 offen offset:3072 lds
    v_mfma_f32_16x16x32_bf16 v[44:47], a[32:35], a[12:15], v[44:47]
    s_waitcnt lgkmcnt(6)
    v_mfma_f32_16x16x32_bf16 v[48:51], a[36:39], a[0:3], v[48:51]
    ds_read_b64_tr_b16 a[48:49], v15 offset:0
    v_mfma_f32_16x16x32_bf16 v[52:55], a[36:39], a[4:7], v[52:55]
    ds_read_b64_tr_b16 a[50:51], v15 offset:1536
    v_mfma_f32_16x16x32_bf16 v[56:59], a[36:39], a[8:11], v[56:59]
    ds_read_b128 a[16:19], v12 offset:0
    s_add_u32 m0, s33, 73984
    s_nop 0
    buffer_load_dwordx4 v6, s[8:11], s28 offen offset:0 lds
    v_mfma_f32_16x16x32_bf16 v[60:63], a[36:39], a[12:15], v[60:63]
    s_waitcnt lgkmcnt(5)
    v_mfma_f32_16x16x32_bf16 v[64:67], a[0:3], a[40:43], v[64:67]
    ds_read_b64_tr_b16 a[32:33], v16 offset:0
    v_mfma_f32_16x16x32_bf16 v[68:71], a[4:7], a[40:43], v[68:71]
    ds_read_b64_tr_b16 a[34:35], v16 offset:1536
    v_mfma_f32_16x16x32_bf16 v[72:75], a[8:11], a[40:43], v[72:75]
    buffer_load_dwordx4 v7, s[8:11], s28 offen offset:1024 lds
    v_mfma_f32_16x16x32_bf16 v[76:79], a[12:15], a[40:43], v[76:79]
    s_waitcnt lgkmcnt(5)
    v_mfma_f32_16x16x32_bf16 v[80:83], a[0:3], a[44:47], v[80:83]
    ds_read_b64_tr_b16 a[36:37], v19 offset:0
    v_mfma_f32_16x16x32_bf16 v[84:87], a[4:7], a[44:47], v[84:87]
    ds_read_b64_tr_b16 a[38:39], v19 offset:1792
    v_mfma_f32_16x16x32_bf16 v[88:91], a[8:11], a[44:47], v[88:91]
    ds_read_b128 a[20:23], v12 offset:2048
    s_add_u32 m0, s34, 73984
    s_nop 0
    buffer_load_dwordx4 v8, s[12:15], s29 offen offset:0 lds
    v_mfma_f32_16x16x32_bf16 v[92:95], a[12:15], a[44:47], v[92:95]
    s_waitcnt lgkmcnt(6)
    v_mfma_f32_16x16x32_bf16 v[96:99], a[48:51], a[0:3], v[96:99]
    ds_read_b64_tr_b16 a[40:41], v19 offset:14464
    v_mfma_f32_16x16x32_bf16 v[100:103], a[48:51], a[4:7], v[100:103]
    ds_read_b64_tr_b16 a[42:43], v19 offset:16256
    v_mfma_f32_16x16x32_bf16 v[104:107], a[48:51], a[8:11], v[104:107]
    buffer_load_dwordx4 v9, s[12:15], s29 offen offset:1024 lds
    v_mfma_f32_16x16x32_bf16 v[108:111], a[48:51], a[12:15], v[108:111]
    s_waitcnt lgkmcnt(5)
    v_mfma_f32_16x16x32_bf16 v[112:115], a[32:35], a[0:3], v[112:115]
    ds_read_b64_tr_b16 a[44:45], v19 offset:32
    v_mfma_f32_16x16x32_bf16 v[116:119], a[32:35], a[4:7], v[116:119]
    ds_read_b64_tr_b16 a[46:47], v19 offset:1824
    v_mfma_f32_16x16x32_bf16 v[120:123], a[32:35], a[8:11], v[120:123]
    ds_read_b128 a[24:27], v12 offset:4096
    buffer_load_dwordx4 v10, s[12:15], s29 offen offset:2048 lds
    s_add_u32 s28, s28, 128
    s_add_u32 s29, s29, 393216
    v_mfma_f32_16x16x32_bf16 v[124:127], a[32:35], a[12:15], v[124:127]
    s_waitcnt lgkmcnt(6)
    v_mfma_f32_16x16x32_bf16 v[128:131], a[36:39], a[0:3], v[128:131]
    ds_read_b64_tr_b16 a[48:49], v19 offset:14496
    v_mfma_f32_16x16x32_bf16 v[132:135], a[36:39], a[4:7], v[132:135]
    ds_read_b64_tr_b16 a[50:51], v19 offset:16288
    v_mfma_f32_16x16x32_bf16 v[136:139], a[36:39], a[8:11], v[136:139]
    v_mfma_f32_16x16x32_bf16 v[140:143], a[36:39], a[12:15], v[140:143]
    s_waitcnt lgkmcnt(5)
    v_mfma_f32_16x16x32_bf16 v[144:147], a[40:43], a[0:3], v[144:147]
    ds_read_b64_tr_b16 a[32:33], v15 offset:6208
    v_mfma_f32_16x16x32_bf16 v[148:151], a[40:43], a[4:7], v[148:151]
    ds_read_b64_tr_b16 a[34:35], v15 offset:7744
    v_mfma_f32_16x16x32_bf16 v[152:155], a[40:43], a[8:11], v[152:155]
    ds_read_b128 a[28:31], v12 offset:6144
    v_mfma_f32_16x16x32_bf16 v[156:159], a[40:43], a[12:15], v[156:159]
    s_waitcnt lgkmcnt(6)
    v_mfma_f32_16x16x32_bf16 v[160:163], a[44:47], a[0:3], v[160:163]
    ds_read_b64_tr_b16 a[36:37], v16 offset:6208
    v_mfma_f32_16x16x32_bf16 v[164:167], a[44:47], a[4:7], v[164:167]
    ds_read_b64_tr_b16 a[38:39], v16 offset:7744
    v_mfma_f32_16x16x32_bf16 v[168:171], a[44:47], a[8:11], v[168:171]
    v_mfma_f32_16x16x32_bf16 v[172:175], a[44:47], a[12:15], v[172:175]
    s_waitcnt lgkmcnt(5)
    v_mfma_f32_16x16x32_bf16 v[176:179], a[48:51], a[0:3], v[176:179]
    ds_read_b64_tr_b16 a[40:41], v15 offset:6272
    v_mfma_f32_16x16x32_bf16 v[180:183], a[48:51], a[4:7], v[180:183]
    ds_read_b64_tr_b16 a[42:43], v15 offset:7808
    v_mfma_f32_16x16x32_bf16 v[184:187], a[48:51], a[8:11], v[184:187]
    v_mfma_f32_16x16x32_bf16 v[188:191], a[48:51], a[12:15], v[188:191]
    s_waitcnt lgkmcnt(4)
    v_mfma_f32_16x16x32_bf16 v[32:35], a[32:35], a[16:19], v[32:35]
    ds_read_b64_tr_b16 a[44:45], v16 offset:6272
    v_mfma_f32_16x16x32_bf16 v[36:39], a[32:35], a[20:23], v[36:39]
    ds_read_b64_tr_b16 a[46:47], v16 offset:7808
    v_mfma_f32_16x16x32_bf16 v[40:43], a[32:35], a[24:27], v[40:43]
    v_mfma_f32_16x16x32_bf16 v[44:47], a[32:35], a[28:31], v[44:47]
    s_waitcnt lgkmcnt(4)
    v_mfma_f32_16x16x32_bf16 v[48:51], a[36:39], a[16:19], v[48:51]
    ds_read_b64_tr_b16 a[48:49], v15 offset:6144
    v_mfma_f32_16x16x32_bf16 v[52:55], a[36:39], a[20:23], v[52:55]
    ds_read_b64_tr_b16 a[50:51], v15 offset:7680
    v_mfma_f32_16x16x32_bf16 v[56:59], a[36:39], a[24:27], v[56:59]
    v_mfma_f32_16x16x32_bf16 v[60:63], a[36:39], a[28:31], v[60:63]
    s_waitcnt lgkmcnt(4)
    v_mfma_f32_16x16x32_bf16 v[64:67], a[16:19], a[40:43], v[64:67]
    ds_read_b64_tr_b16 a[32:33], v16 offset:6144
    v_mfma_f32_16x16x32_bf16 v[68:71], a[20:23], a[40:43], v[68:71]
    ds_read_b64_tr_b16 a[34:35], v16 offset:7680
    v_mfma_f32_16x16x32_bf16 v[72:75], a[24:27], a[40:43], v[72:75]
    v_mfma_f32_16x16x32_bf16 v[76:79], a[28:31], a[40:43], v[76:79]
    s_waitcnt lgkmcnt(4)
    v_mfma_f32_16x16x32_bf16 v[80:83], a[16:19], a[44:47], v[80:83]
    ds_read_b64_tr_b16 a[36:37], v19 offset:7168
    v_mfma_f32_16x16x32_bf16 v[84:87], a[20:23], a[44:47], v[84:87]
    ds_read_b64_tr_b16 a[38:39], v19 offset:8960
    v_mfma_f32_16x16x32_bf16 v[88:91], a[24:27], a[44:47], v[88:91]
    v_mfma_f32_16x16x32_bf16 v[92:95], a[28:31], a[44:47], v[92:95]
    s_waitcnt lgkmcnt(4)
    v_mfma_f32_16x16x32_bf16 v[96:99], a[48:51], a[16:19], v[96:99]
    ds_read_b64_tr_b16 a[40:41], v19 offset:21632
    v_mfma_f32_16x16x32_bf16 v[100:103], a[48:51], a[20:23], v[100:103]
    ds_read_b64_tr_b16 a[42:43], v19 offset:23424
    v_mfma_f32_16x16x32_bf16 v[104:107], a[48:51], a[24:27], v[104:107]
    v_mfma_f32_16x16x32_bf16 v[108:111], a[48:51], a[28:31], v[108:111]
    s_waitcnt lgkmcnt(4)
    v_mfma_f32_16x16x32_bf16 v[112:115], a[32:35], a[16:19], v[112:115]
    ds_read_b64_tr_b16 a[44:45], v19 offset:7200
    v_mfma_f32_16x16x32_bf16 v[116:119], a[32:35], a[20:23], v[116:119]
    ds_read_b64_tr_b16 a[46:47], v19 offset:8992
    v_mfma_f32_16x16x32_bf16 v[120:123], a[32:35], a[24:27], v[120:123]
    ds_read_b64_tr_b16 a[48:49], v19 offset:21664
    v_mfma_f32_16x16x32_bf16 v[124:127], a[32:35], a[28:31], v[124:127]
    ds_read_b64_tr_b16 a[50:51], v19 offset:23456
    s_waitcnt lgkmcnt(6)
    v_mfma_f32_16x16x32_bf16 v[128:131], a[36:39], a[16:19], v[128:131]
    v_mfma_f32_16x16x32_bf16 v[132:135], a[36:39], a[20:23], v[132:135]
    v_mfma_f32_16x16x32_bf16 v[136:139], a[36:39], a[24:27], v[136:139]
    v_mfma_f32_16x16x32_bf16 v[140:143], a[36:39], a[28:31], v[140:143]
    s_waitcnt lgkmcnt(0) vmcnt(0)
    s_barrier
    v_mfma_f32_16x16x32_bf16 v[144:147], a[40:43], a[16:19], v[144:147]
    ds_read_b64_tr_b16 a[32:33], v17 offset:64
    v_mfma_f32_16x16x32_bf16 v[148:151], a[40:43], a[20:23], v[148:151]
    ds_read_b64_tr_b16 a[34:35], v17 offset:1600
    v_mfma_f32_16x16x32_bf16 v[152:155], a[40:43], a[24:27], v[152:155]
    ds_read_b128 a[0:3], v13 offset:0
    s_mov_b32 m0, s32
    s_nop 0
    buffer_load_dwordx4 v2, s[8:11], s28 offen offset:0 lds
    v_mfma_f32_16x16x32_bf16 v[156:159], a[40:43], a[28:31], v[156:159]
    ds_read_b128 a[4:7], v13 offset:2048
    s_waitcnt lgkmcnt(6)
    v_mfma_f32_16x16x32_bf16 v[160:163], a[44:47], a[16:19], v[160:163]
    ds_read_b64_tr_b16 a[36:37], v18 offset:64
    v_mfma_f32_16x16x32_bf16 v[164:167], a[44:47], a[20:23], v[164:167]
    ds_read_b64_tr_b16 a[38:39], v18 offset:1600
    v_mfma_f32_16x16x32_bf16 v[168:171], a[44:47], a[24:27], v[168:171]
    ds_read_b128 a[8:11], v13 offset:4096
    buffer_load_dwordx4 v3, s[8:11], s28 offen offset:1024 lds
    v_mfma_f32_16x16x32_bf16 v[172:175], a[44:47], a[28:31], v[172:175]
    ds_read_b128 a[12:15], v13 offset:6144
    s_waitcnt lgkmcnt(8)
    v_mfma_f32_16x16x32_bf16 v[176:179], a[48:51], a[16:19], v[176:179]
    ds_read_b64_tr_b16 a[40:41], v17 offset:128
    v_mfma_f32_16x16x32_bf16 v[180:183], a[48:51], a[20:23], v[180:183]
    ds_read_b64_tr_b16 a[42:43], v17 offset:1664
    v_mfma_f32_16x16x32_bf16 v[184:187], a[48:51], a[24:27], v[184:187]
    buffer_load_dwordx4 v4, s[8:11], s28 offen offset:2048 lds
    v_mfma_f32_16x16x32_bf16 v[188:191], a[48:51], a[28:31], v[188:191]
    s_add_u32 s27, s27, 1
    s_cmp_lt_u32 s27, 6
    s_cbranch_scc1 L_k1_loop0
    s_waitcnt lgkmcnt(2)
    v_mfma_f32_16x16x32_bf16 v[32:35], a[32:35], a[0:3], v[32:35]
    ds_read_b64_tr_b16 a[44:45], v18 offset:128
    v_mfma_f32_16x16x32_bf16 v[36:39], a[32:35], a[4:7], v[36:39]
    ds_read_b64_tr_b16 a[46:47], v18 offset:1664
    v_mfma_f32_16x16x32_bf16 v[40:43], a[32:35], a[8:11], v[40:43]
    buffer_load_dwordx4 v5, s[8:11], s28 offen offset:3072 lds
    v_mfma_f32_16x16x32_bf16 v[44:47], a[32:35], a[12:15], v[44:47]
    s_waitcnt lgkmcnt(6)
    v_mfma_f32_16x16x32_bf16 v[48:51], a[36:39], a[0:3], v[48:51]
    ds_read_b64_tr_b16 a[48:49], v17 offset:0
    v_mfma_f32_16x16x32_bf16 v[52:55], a[36:39], a[4:7], v[52:55]
    ds_read_b64_tr_b16 a[50:51], v17 offset:1536
    v_mfma_f32_16x16x32_bf16 v[56:59], a[36:39], a[8:11], v[56:59]
    ds_read_b128 a[16:19], v14 offset:0
    s_mov_b32 m0, s33
    s_nop 0
    buffer_load_dwordx4 v6, s[8:11], s28 offen offset:0 lds
    v_mfma_f32_16x16x32_bf16 v[60:63], a[36:39], a[12:15], v[60:63]
    s_waitcnt lgkmcnt(5)
    v_mfma_f32_16x16x32_bf16 v[64:67], a[0:3], a[40:43], v[64:67]
    ds_read_b64_tr_b16 a[32:33], v18 offset:0
    v_mfma_f32_16x16x32_bf16 v[68:71], a[4:7], a[40:43], v[68:71]
    ds_read_b64_tr_b16 a[34:35], v18 offset:1536
    v_mfma_f32_16x16x32_bf16 v[72:75], a[8:11], a[40:43], v[72:75]
    buffer_load_dwordx4 v7, s[8:11], s28 offen offset:1024 lds
    v_mfma_f32_16x16x32_bf16 v[76:79], a[12:15], a[40:43], v[76:79]
    s_waitcnt lgkmcnt(5)
    v_mfma_f32_16x16x32_bf16 v[80:83], a[0:3], a[44:47], v[80:83]
    ds_read_b64_tr_b16 a[36:37], v20 offset:0
    v_mfma_f32_16x16x32_bf16 v[84:87], a[4:7], a[44:47], v[84:87]
    ds_read_b64_tr_b16 a[38:39], v20 offset:1792
    v_mfma_f32_16x16x32_bf16 v[88:91], a[8:11], a[44:47], v[88:91]
    ds_read_b128 a[20:23], v14 offset:2048
    s_mov_b32 m0, s34
    s_nop 0
    buffer_load_dwordx4 v8, s[12:15], s29 offen offset:0 lds
    v_mfma_f32_16x16x32_bf16 v[92:95], a[12:15], a[44:47], v[92:95]
    s_waitcnt lgkmcnt(6)
    v_mfma_f32_16x16x32_bf16 v[96:99], a[48:51], a[0:3], v[96:99]
    ds_read_b64_tr_b16 a[40:41], v20 offset:14464
    v_mfma_f32_16x16x32_bf16 v[100:103], a[48:51], a[4:7], v[100:103]
    ds_read_b64_tr_b16 a[42:43], v20 offset:16256
    v_mfma_f32_16x16x32_bf16 v[104:107], a[48:51], a[8:11], v[104:107]
    buffer_load_dwordx4 v9, s[12:15], s29 offen offset:1024 lds
    v_mfma_f32_16x16x32_bf16 v[108:111], a[48:51], a[12:15], v[108:111]
    s_waitcnt lgkmcnt(5)
    v_mfma_f32_16x16x32_bf16 v[112:115], a[32:35], a[0:3], v[112:115]
    ds_read_b64_tr_b16 a[44:45], v20 offset:32
    v_mfma_f32_16x16x32_bf16 v[116:119], a[32:35], a[4:7], v[116:119]
    ds_read_b64_tr_b16 a[46:47], v20 offset:1824
    v_mfma_f32_16x16x32_bf16 v[120:123], a[32:35], a[8:11], v[120:123]
    ds_read_b128 a[24:27], v14 offset:4096
    buffer_load_dwordx4 v10, s[12:15], s29 offen offset:2048 lds
    s_add_u32 s28, s28, 128
    s_add_u32 s29, s29, 393216
    v_mfma_f32_16x16x32_bf16 v[124:127], a[32:35], a[12:15], v[124:127]
    s_waitcnt lgkmcnt(6)
    v_mfma_f32_16x16x32_bf16 v[128:131], a[36:39], a[0:3], v[128:131]
    ds_read_b64_tr_b16 a[48:49], v20 offset:14496
    v_mfma_f32_16x16x32_bf16 v[132:135], a[36:39], a[4:7], v[132:135]
    ds_read_b64_tr_b16 a[50:51], v20 offset:16288
    v_mfma_f32_16x16x32_bf16 v[136:139], a[36:39], a[8:11], v[136:139]
    s_mov_b32 s72, s4
    s_mov_b32 s73, s5
    s_mov_b32 s74, 2097152
    v_mfma_f32_16x16x32_bf16 v[140:143], a[36:39], a[12:15], v[140:143]
    s_waitcnt lgkmcnt(5)
    v_mfma_f32_16x16x32_bf16 v[144:147], a[40:43], a[0:3], v[144:147]
    ds_read_b64_tr_b16 a[32:33], v17 offset:6208
    v_mfma_f32_16x16x32_bf16 v[148:151], a[40:43], a[4:7], v[148:151]
    ds_read_b64_tr_b16 a[34:35], v17 offset:7744
    v_mfma_f32_16x16x32_bf16 v[152:155], a[40:43], a[8:11], v[152:155]
    ds_read_b128 a[28:31], v14 offset:6144
    s_mov_b32 s75, 0x20000
    s_lshr_b32 s3, s2, 3
    s_lshl_b32 s3, s3, 2
    v_mfma_f32_16x16x32_bf16 v[156:159], a[40:43], a[12:15], v[156:159]
    s_waitcnt lgkmcnt(6)
    v_mfma_f32_16x16x32_bf16 v[160:163], a[44:47], a[0:3], v[160:163]
    ds_read_b64_tr_b16 a[36:37], v18 offset:6208
    v_mfma_f32_16x16x32_bf16 v[164:167], a[44:47], a[4:7], v[164:167]
    ds_read_b64_tr_b16 a[38:39], v18 offset:7744
    v_mfma_f32_16x16x32_bf16 v[168:171], a[44:47], a[8:11], v[168:171]
    s_add_u32 s3, s3, s26
    s_lshl_b32 s3, s3, 14
    s_bfe_u32 s6, s2, 0x10002
    v_mfma_f32_16x16x32_bf16 v[172:175], a[44:47], a[12:15], v[172:175]
    s_waitcnt lgkmcnt(5)
    v_mfma_f32_16x16x32_bf16 v[176:179], a[48:51], a[0:3], v[176:179]
    ds_read_b64_tr_b16 a[40:41], v17 offset:6272
    v_mfma_f32_16x16x32_bf16 v[180:183], a[48:51], a[4:7], v[180:183]
    ds_read_b64_tr_b16 a[42:43], v17 offset:7808
    v_mfma_f32_16x16x32_bf16 v[184:187], a[48:51], a[8:11], v[184:187]
    s_lshl_b32 s6, s6, 10
    s_add_u32 s3, s3, s6
    v_lshrrev_b32 v25, 3, v1
    v_mfma_f32_16x16x32_bf16 v[188:191], a[48:51], a[12:15], v[188:191]
    s_waitcnt lgkmcnt(4)
    v_mfma_f32_16x16x32_bf16 v[32:35], a[32:35], a[16:19], v[32:35]
    ds_read_b64_tr_b16 a[44:45], v18 offset:6272
    v_mfma_f32_16x16x32_bf16 v[36:39], a[32:35], a[20:23], v[36:39]
    ds_read_b64_tr_b16 a[46:47], v18 offset:7808
    v_mfma_f32_16x16x32_bf16 v[40:43], a[32:35], a[24:27], v[40:43]
    v_lshlrev_b32 v25, 11, v25
    v_and_b32 v26, 7, v1
    v_lshl_add_u32 v25, v26, 7, v25
    v_mfma_f32_16x16x32_bf16 v[44:47], a[32:35], a[28:31], v[44:47]
    s_waitcnt lgkmcnt(4)
    v_mfma_f32_16x16x32_bf16 v[48:51], a[36:39], a[16:19], v[48:51]
    ds_read_b64_tr_b16 a[48:49], v17 offset:6144
    v_mfma_f32_16x16x32_bf16 v[52:55], a[36:39], a[20:23], v[52:55]
    ds_read_b64_tr_b16 a[50:51], v17 offset:7680
    v_mfma_f32_16x16x32_bf16 v[56:59], a[36:39], a[24:27], v[56:59]
    buffer_load_dword v26, v25, s[72:75], s3 offen
    v_mfma_f32_16x16x32_bf16 v[60:63], a[36:39], a[28:31], v[60:63]
    s_waitcnt lgkmcnt(4)
    v_mfma_f32_16x16x32_bf16 v[64:67], a[16:19], a[40:43], v[64:67]
    ds_read_b64_tr_b16 a[32:33], v18 offset:6144
    v_mfma_f32_16x16x32_bf16 v[68:71], a[20:23], a[40:43], v[68:71]
    ds_read_b64_tr_b16 a[34:35], v18 offset:7680
    v_mfma_f32_16x16x32_bf16 v[72:75], a[24:27], a[40:43], v[72:75]
    v_mfma_f32_16x16x32_bf16 v[76:79], a[28:31], a[40:43], v[76:79]
    s_waitcnt lgkmcnt(4)
    v_mfma_f32_16x16x32_bf16 v[80:83], a[16:19], a[44:47], v[80:83]
    ds_read_b64_tr_b16 a[36:37], v20 offset:7168
    v_mfma_f32_16x16x32_bf16 v[84:87], a[20:23], a[44:47], v[84:87]
    ds_read_b64_tr_b16 a[38:39], v20 offset:8960
    v_mfma_f32_16x16x32_bf16 v[88:91], a[24:27], a[44:47], v[88:91]
    v_mfma_f32_16x16x32_bf16 v[92:95], a[28:31], a[44:47], v[92:95]
    s_waitcnt lgkmcnt(4)
    v_mfma_f32_16x16x32_bf16 v[96:99], a[48:51], a[16:19], v[96:99]
    ds_read_b64_tr_b16 a[40:41], v20 offset:21632
    v_mfma_f32_16x16x32_bf16 v[100:103], a[48:51], a[20:23], v[100:103]
    ds_read_b64_tr_b16 a[42:43], v20 offset:23424
    v_mfma_f32_16x16x32_bf16 v[104:107], a[48:51], a[24:27], v[104:107]
    v_mfma_f32_16x16x32_bf16 v[108:111], a[48:51], a[28:31], v[108:111]
    s_waitcnt lgkmcnt(4)
    v_mfma_f32_16x16x32_bf16 v[112:115], a[32:35], a[16:19], v[112:115]
    ds_read_b64_tr_b16 a[44:45], v20 offset:7200
    v_mfma_f32_16x16x32_bf16 v[116:119], a[32:35], a[20:23], v[116:119]
    ds_read_b64_tr_b16 a[46:47], v20 offset:8992
    v_mfma_f32_16x16x32_bf16 v[120:123], a[32:35], a[24:27], v[120:123]
    ds_read_b64_tr_b16 a[48:49], v20 offset:21664
    v_mfma_f32_16x16x32_bf16 v[124:127], a[32:35], a[28:31], v[124:127]
    ds_read_b64_tr_b16 a[50:51], v20 offset:23456
    s_waitcnt lgkmcnt(6)
    v_mfma_f32_16x16x32_bf16 v[128:131], a[36:39], a[16:19], v[128:131]
    v_mfma_f32_16x16x32_bf16 v[132:135], a[36:39], a[20:23], v[132:135]
    v_mfma_f32_16x16x32_bf16 v[136:139], a[36:39], a[24:27], v[136:139]
    v_mfma_f32_16x16x32_bf16 v[140:143], a[36:39], a[28:31], v[140:143]
    s_waitcnt lgkmcnt(0) vmcnt(1)
    s_barrier
    v_mfma_f32_16x16x32_bf16 v[144:147], a[40:43], a[16:19], v[144:147]
    ds_read_b64_tr_b16 a[32:33], v15 offset:64
    v_mfma_f32_16x16x32_bf16 v[148:151], a[40:43], a[20:23], v[148:151]
    ds_read_b64_tr_b16 a[34:35], v15 offset:1600
    v_mfma_f32_16x16x32_bf16 v[152:155], a[40:43], a[24:27], v[152:155]
    ds_read_b128 a[0:3], v11 offset:0
    s_add_u32 m0, s32, 73984
    s_nop 0
    buffer_load_dwordx4 v2, s[8:11], s28 offen offset:0 lds
    v_mfma_f32_16x16x32_bf16 v[156:159], a[40:43], a[28:31], v[156:159]
    ds_read_b128 a[4:7], v11 offset:2048
    s_waitcnt lgkmcnt(6)
    v_mfma_f32_16x16x32_bf16 v[160:163], a[44:47], a[16:19], v[160:163]
    ds_read_b64_tr_b16 a[36:37], v16 offset:64
    v_mfma_f32_16x16x32_bf16 v[164:167], a[44:47], a[20:23], v[164:167]
    ds_read_b64_tr_b16 a[38:39], v16 offset:1600
    v_mfma_f32_16x16x32_bf16 v[168:171], a[44:47], a[24:27], v[168:171]
    ds_read_b128 a[8:11], v11 offset:4096
    buffer_load_dwordx4 v3, s[8:11], s28 offen offset:1024 lds
    v_mfma_f32_16x16x32_bf16 v[172:175], a[44:47], a[28:31], v[172:175]
    ds_read_b128 a[12:15], v11 offset:6144
    s_waitcnt lgkmcnt(8)
    v_mfma_f32_16x16x32_bf16 v[176:179], a[48:51], a[16:19], v[176:179]
    ds_read_b64_tr_b16 a[40:41], v15 offset:128
    v_mfma_f32_16x16x32_bf16 v[180:183], a[48:51], a[20:23], v[180:183]
    ds_read_b64_tr_b16 a[42:43], v15 offset:1664
    v_mfma_f32_16x16x32_bf16 v[184:187], a[48:51], a[24:27], v[184:187]
    buffer_load_dwordx4 v4, s[8:11], s28 offen offset:2048 lds
    v_mfma_f32_16x16x32_bf16 v[188:191], a[48:51], a[28:31], v[188:191]
    s_waitcnt lgkmcnt(2)
    v_mfma_f32_16x16x32_bf16 v[32:35], a[32:35], a[0:3], v[32:35]
    ds_read_b64_tr_b16 a[44:45], v16 offset:128
    v_mfma_f32_16x16x32_bf16 v[36:39], a[32:35], a[4:7], v[36:39]
    ds_read_b64_tr_b16 a[46:47], v16 offset:1664
    v_mfma_f32_16x16x32_bf16 v[40:43], a[32:35], a[8:11], v[40:43]
    buffer_load_dwordx4 v5, s[8:11], s28 offen offset:3072 lds
    v_mfma_f32_16x16x32_bf16 v[44:47], a[32:35], a[12:15], v[44:47]
    s_waitcnt lgkmcnt(6)
    v_mfma_f32_16x16x32_bf16 v[48:51], a[36:39], a[0:3], v[48:51]
    ds_read_b64_tr_b16 a[48:49], v15 offset:0
    v_mfma_f32_16x16x32_bf16 v[52:55], a[36:39], a[4:7], v[52:55]
    ds_read_b64_tr_b16 a[50:51], v15 offset:1536
    v_mfma_f32_16x16x32_bf16 v[56:59], a[36:39], a[8:11], v[56:59]
    ds_read_b128 a[16:19], v12 offset:0
    s_add_u32 m0, s33, 73984
    s_nop 0
    buffer_load_dwordx4 v6, s[8:11], s28 offen offset:0 lds
    v_mfma_f32_16x16x32_bf16 v[60:63], a[36:39], a[12:15], v[60:63]
    s_waitcnt lgkmcnt(5)
    v_mfma_f32_16x16x32_bf16 v[64:67], a[0:3], a[40:43], v[64:67]
    ds_read_b64_tr_b16 a[32:33], v16 offset:0
    v_mfma_f32_16x16x32_bf16 v[68:71], a[4:7], a[40:43], v[68:71]
    ds_read_b64_tr_b16 a[34:35], v16 offset:1536
    v_mfma_f32_16x16x32_bf16 v[72:75], a[8:11], a[40:43], v[72:75]
    buffer_load_dwordx4 v7, s[8:11], s28 offen offset:1024 lds
    v_mfma_f32_16x16x32_bf16 v[76:79], a[12:15], a[40:43], v[76:79]
    s_waitcnt lgkmcnt(5)
    v_mfma_f32_16x16x32_bf16 v[80:83], a[0:3], a[44:47], v[80:83]
    ds_read_b64_tr_b16 a[36:37], v19 offset:0
    v_mfma_f32_16x16x32_bf16 v[84:87], a[4:7], a[44:47], v[84:87]
    ds_read_b64_tr_b16 a[38:39], v19 offset:1792
    v_mfma_f32_16x16x32_bf16 v[88:91], a[8:11], a[44:47], v[88:91]
    ds_read_b128 a[20:23], v12 offset:2048
    s_add_u32 m0, s34, 73984
    s_nop 0
    buffer_load_dwordx4 v8, s[12:15], s29 offen offset:0 lds
    v_mfma_f32_16x16x32_bf16 v[92:95], a[12:15], a[44:47], v[92:95]
    s_waitcnt lgkmcnt(6)
    v_mfma_f32_16x16x32_bf16 v[96:99], a[48:51], a[0:3], v[96:99]
    ds_read_b64_tr_b16 a[40:41], v19 offset:14464
    v_mfma_f32_16x16x32_bf16 v[100:103], a[48:51], a[4:7], v[100:103]
    ds_read_b64_tr_b16 a[42:43], v19 offset:16256
    v_mfma_f32_16x16x32_bf16 v[104:107], a[48:51], a[8:11], v[104:107]
    buffer_load_dwordx4 v9, s[12:15], s29 offen offset:1024 lds
    v_mfma_f32_16x16x32_bf16 v[108:111], a[48:51], a[12:15], v[108:111]
    s_waitcnt lgkmcnt(5)
    v_mfma_f32_16x16x32_bf16 v[112:115], a[32:35], a[0:3], v[112:115]
    ds_read_b64_tr_b16 a[44:45], v19 offset:32
    v_mfma_f32_16x16x32_bf16 v[116:119], a[32:35], a[4:7], v[116:119]
    ds_read_b64_tr_b16 a[46:47], v19 offset:1824
    v_mfma_f32_16x16x32_bf16 v[120:123], a[32:35], a[8:11], v[120:123]
    ds_read_b128 a[24:27], v12 offset:4096
    buffer_load_dwordx4 v10, s[12:15], s29 offen offset:2048 lds
    s_add_u32 s28, s28, 128
    s_add_u32 s29, s29, 393216
    v_mfma_f32_16x16x32_bf16 v[124:127], a[32:35], a[12:15], v[124:127]
    s_waitcnt lgkmcnt(6)
    v_mfma_f32_16x16x32_bf16 v[128:131], a[36:39], a[0:3], v[128:131]
    ds_read_b64_tr_b16 a[48:49], v19 offset:14496
    v_mfma_f32_16x16x32_bf16 v[132:135], a[36:39], a[4:7], v[132:135]
    ds_read_b64_tr_b16 a[50:51], v19 offset:16288
    v_mfma_f32_16x16x32_bf16 v[136:139], a[36:39], a[8:11], v[136:139]
    s_and_b32 s54, s2, 1
    s_xor_b32 s54, s54, 1
    s_bfe_u32 s52, s2, 0x30003
    s_bfe_u32 s3, s2, 0x10001
    v_mfma_f32_16x16x32_bf16 v[140:143], a[36:39], a[12:15], v[140:143]
    s_waitcnt lgkmcnt(5)
    v_mfma_f32_16x16x32_bf16 v[144:147], a[40:43], a[0:3], v[144:147]
    ds_read_b64_tr_b16 a[32:33], v15 offset:6208
    v_mfma_f32_16x16x32_bf16 v[148:151], a[40:43], a[4:7], v[148:151]
    ds_read_b64_tr_b16 a[34:35], v15 offset:7744
    v_mfma_f32_16x16x32_bf16 v[152:155], a[40:43], a[8:11], v[152:155]
    ds_read_b128 a[28:31], v12 offset:6144
    s_lshl_b32 s3, s3, 3
    s_add_u32 s52, s52, s3
    s_lshr_b32 s53, s2, 6
    s_bfe_u32 s3, s2, 0x10002
    v_mfma_f32_16x16x32_bf16 v[156:159], a[40:43], a[12:15], v[156:159]
    s_waitcnt lgkmcnt(6)
    v_mfma_f32_16x16x32_bf16 v[160:163], a[44:47], a[0:3], v[160:163]
    ds_read_b64_tr_b16 a[36:37], v16 offset:6208
    v_mfma_f32_16x16x32_bf16 v[164:167], a[44:47], a[4:7], v[164:167]
    ds_read_b64_tr_b16 a[38:39], v16 offset:7744
    v_mfma_f32_16x16x32_bf16 v[168:171], a[44:47], a[8:11], v[168:171]
    s_lshl_b32 s3, s3, 2
    s_add_u32 s53, s53, s3
    s_lshl_b32 s3, s52, 3
    s_add_u32 s3, s3, s53
    v_mfma_f32_16x16x32_bf16 v[172:175], a[44:47], a[12:15], v[172:175]
    s_waitcnt lgkmcnt(5)
    v_mfma_f32_16x16x32_bf16 v[176:179], a[48:51], a[0:3], v[176:179]
    ds_read_b64_tr_b16 a[40:41], v15 offset:6272
    v_mfma_f32_16x16x32_bf16 v[180:183], a[48:51], a[4:7], v[180:183]
    ds_read_b64_tr_b16 a[42:43], v15 offset:7808
    v_mfma_f32_16x16x32_bf16 v[184:187], a[48:51], a[8:11], v[184:187]
    s_lshl_b32 s3, s3, 1
    s_add_u32 s3, s3, s54
    s_lshl_b32 s3, s3, 2
    s_add_u32 s3, s3, s26
    v_mfma_f32_16x16x32_bf16 v[188:191], a[48:51], a[12:15], v[188:191]
    s_waitcnt lgkmcnt(4)
    v_mfma_f32_16x16x32_bf16 v[32:35], a[32:35], a[16:19], v[32:35]
    ds_read_b64_tr_b16 a[44:45], v16 offset:6272
    v_mfma_f32_16x16x32_bf16 v[36:39], a[32:35], a[20:23], v[36:39]
    ds_read_b64_tr_b16 a[46:47], v16 offset:7808
    v_mfma_f32_16x16x32_bf16 v[40:43], a[32:35], a[24:27], v[40:43]
    s_lshl_b32 s55, s3, 6
    s_add_u32 s55, s55, 21495808
    v_lshrrev_b32 v27, 4, v1
    v_and_b32 v28, 15, v1
    v_mfma_f32_16x16x32_bf16 v[44:47], a[32:35], a[28:31], v[44:47]
    s_waitcnt lgkmcnt(4)
    v_mfma_f32_16x16x32_bf16 v[48:51], a[36:39], a[16:19], v[48:51]
    ds_read_b64_tr_b16 a[48:49], v15 offset:6144
    v_mfma_f32_16x16x32_bf16 v[52:55], a[36:39], a[20:23], v[52:55]
    ds_read_b64_tr_b16 a[50:51], v15 offset:7680
    v_mfma_f32_16x16x32_bf16 v[56:59], a[36:39], a[24:27], v[56:59]
    v_lshlrev_b32 v29, 1, v27
    v_xor_b32 v28, v28, v29
    s_lshl_b32 s3, s26, 4
    v_add_u32 v27, s3, v27
    v_mfma_f32_16x16x32_bf16 v[60:63], a[36:39], a[28:31], v[60:63]
    s_waitcnt lgkmcnt(4)
    v_mfma_f32_16x16x32_bf16 v[64:67], a[16:19], a[40:43], v[64:67]
    ds_read_b64_tr_b16 a[32:33], v16 offset:6144
    v_mfma_f32_16x16x32_bf16 v[68:71], a[20:23], a[40:43], v[68:71]
    ds_read_b64_tr_b16 a[34:35], v16 offset:7680
    v_mfma_f32_16x16x32_bf16 v[72:75], a[24:27], a[40:43], v[72:75]
    v_lshlrev_b32 v27, 11, v27
    v_lshl_add_u32 v27, v28, 4, v27
    v_xor_b32 v28, 128, v27
    v_add_u32 v5, 0, v27
    v_mfma_f32_16x16x32_bf16 v[76:79], a[28:31], a[40:43], v[76:79]
    s_waitcnt lgkmcnt(4)
    v_mfma_f32_16x16x32_bf16 v[80:83], a[16:19], a[44:47], v[80:83]
    ds_read_b64_tr_b16 a[36:37], v19 offset:7168
    v_mfma_f32_16x16x32_bf16 v[84:87], a[20:23], a[44:47], v[84:87]
    ds_read_b64_tr_b16 a[38:39], v19 offset:8960
    v_mfma_f32_16x16x32_bf16 v[88:91], a[24:27], a[44:47], v[88:91]
    v_add_u32 v6, 7168, v27
    v_add_u32 v7, 14336, v28
    v_add_u32 v8, 21504, v28
    s_lshl_b32 s33, s26, 12
    v_mfma_f32_16x16x32_bf16 v[92:95], a[28:31], a[44:47], v[92:95]
    s_waitcnt lgkmcnt(4)
    v_mfma_f32_16x16x32_bf16 v[96:99], a[48:51], a[16:19], v[96:99]
    ds_read_b64_tr_b16 a[40:41], v19 offset:21632
    v_mfma_f32_16x16x32_bf16 v[100:103], a[48:51], a[20:23], v[100:103]
    ds_read_b64_tr_b16 a[42:43], v19 offset:23424
    v_mfma_f32_16x16x32_bf16 v[104:107], a[48:51], a[24:27], v[104:107]
    s_add_u32 s32, s33, 65536
    s_mul_i32 s3, s54, 4194304
    s_lshl_b32 s6, s53, 8
    s_add_u32 s3, s3, s6
    v_mfma_f32_16x16x32_bf16 v[108:111], a[48:51], a[28:31], v[108:111]
    s_waitcnt lgkmcnt(4)
    v_mfma_f32_16x16x32_bf16 v[112:115], a[32:35], a[16:19], v[112:115]
    ds_read_b64_tr_b16 a[44:45], v19 offset:7200
    v_mfma_f32_16x16x32_bf16 v[116:119], a[32:35], a[20:23], v[116:119]
    ds_read_b64_tr_b16 a[46:47], v19 offset:8992
    v_mfma_f32_16x16x32_bf16 v[120:123], a[32:35], a[24:27], v[120:123]
    ds_read_b64_tr_b16 a[48:49], v19 offset:21664
    s_add_u32 s12, s40, s3
    s_addc_u32 s13, s41, 0
    s_sub_u32 s14, 7340032, s3
    s_mov_b32 s15, 0x20000
    v_mfma_f32_16x16x32_bf16 v[124:127], a[32:35], a[28:31], v[124:127]
    ds_read_b64_tr_b16 a[50:51], v19 offset:23456
    s_waitcnt lgkmcnt(6)
    v_mfma_f32_16x16x32_bf16 v[128:131], a[36:39], a[16:19], v[128:131]
    v_mfma_f32_16x16x32_bf16 v[132:135], a[36:39], a[20:23], v[132:135]
    v_mfma_f32_16x16x32_bf16 v[136:139], a[36:39], a[24:27], v[136:139]
    s_mov_b32 s29, 0
    v_mfma_f32_16x16x32_bf16 v[140:143], a[36:39], a[28:31], v[140:143]
    s_waitcnt lgkmcnt(0) vmcnt(0)
    s_barrier
    v_mfma_f32_16x16x32_bf16 v[144:147], a[40:43], a[16:19], v[144:147]
    ds_read_b64_tr_b16 a[32:33], v17 offset:64
    v_mfma_f32_16x16x32_bf16 v[148:151], a[40:43], a[20:23], v[148:151]
    ds_read_b64_tr_b16 a[34:35], v17 offset:1600
    v_mfma_f32_16x16x32_bf16 v[152:155], a[40:43], a[24:27], v[152:155]
    ds_read_b128 a[0:3], v13 offset:0
    s_mov_b32 m0, s33
    s_nop 0
    buffer_load_dwordx4 v5, s[12:15], s29 offen offset:0 lds
    v_mfma_f32_16x16x32_bf16 v[156:159], a[40:43], a[28:31], v[156:159]
    ds_read_b128 a[4:7], v13 offset:2048
    s_waitcnt lgkmcnt(6)
    v_mfma_f32_16x16x32_bf16 v[160:163], a[44:47], a[16:19], v[160:163]
    ds_read_b64_tr_b16 a[36:37], v18 offset:64
    v_mfma_f32_16x16x32_bf16 v[164:167], a[44:47], a[20:23], v[164:167]
    ds_read_b64_tr_b16 a[38:39], v18 offset:1600
    v_mfma_f32_16x16x32_bf16 v[168:171], a[44:47], a[24:27], v[168:171]
    ds_read_b128 a[8:11], v13 offset:4096
    buffer_load_dwordx4 v6, s[12:15], s29 offen offset:1024 lds
    v_mfma_f32_16x16x32_bf16 v[172:175], a[44:47], a[28:31], v[172:175]
    ds_read_b128 a[12:15], v13 offset:6144
    s_waitcnt lgkmcnt(8)
    v_mfma_f32_16x16x32_bf16 v[176:179], a[48:51], a[16:19], v[176:179]
    ds_read_b64_tr_b16 a[40:41], v17 offset:128
    v_mfma_f32_16x16x32_bf16 v[180:183], a[48:51], a[20:23], v[180:183]
    ds_read_b64_tr_b16 a[42:43], v17 offset:1664
    v_mfma_f32_16x16x32_bf16 v[184:187], a[48:51], a[24:27], v[184:187]
    buffer_load_dwordx4 v7, s[12:15], s29 offen offset:2048 lds
    v_mfma_f32_16x16x32_bf16 v[188:191], a[48:51], a[28:31], v[188:191]
    s_waitcnt lgkmcnt(2)
    v_mfma_f32_16x16x32_bf16 v[32:35], a[32:35], a[0:3], v[32:35]
    ds_read_b64_tr_b16 a[44:45], v18 offset:128
    v_mfma_f32_16x16x32_bf16 v[36:39], a[32:35], a[4:7], v[36:39]
    ds_read_b64_tr_b16 a[46:47], v18 offset:1664
    v_mfma_f32_16x16x32_bf16 v[40:43], a[32:35], a[8:11], v[40:43]
    buffer_load_dwordx4 v8, s[12:15], s29 offen offset:3072 lds
    s_add_u32 s29, s29, 131072
    v_mfma_f32_16x16x32_bf16 v[44:47], a[32:35], a[12:15], v[44:47]
    s_add_u32 m0, s33, 16384
    s_nop 0
    buffer_load_dwordx4 v5, s[12:15], s29 offen offset:0 lds
    s_waitcnt lgkmcnt(6)
    v_mfma_f32_16x16x32_bf16 v[48:51], a[36:39], a[0:3], v[48:51]
    ds_read_b64_tr_b16 a[48:49], v17 offset:0
    v_mfma_f32_16x16x32_bf16 v[52:55], a[36:39], a[4:7], v[52:55]
    ds_read_b64_tr_b16 a[50:51], v17 offset:1536
    v_mfma_f32_16x16x32_bf16 v[56:59], a[36:39], a[8:11], v[56:59]
    ds_read_b128 a[16:19], v14 offset:0
    buffer_load_dwordx4 v6, s[12:15], s29 offen offset:1024 lds
    v_mfma_f32_16x16x32_bf16 v[60:63], a[36:39], a[12:15], v[60:63]
    buffer_load_dwordx4 v7, s[12:15], s29 offen offset:2048 lds
    s_waitcnt lgkmcnt(5)
    v_mfma_f32_16x16x32_bf16 v[64:67], a[0:3], a[40:43], v[64:67]
    ds_read_b64_tr_b16 a[32:33], v18 offset:0
    v_mfma_f32_16x16x32_bf16 v[68:71], a[4:7], a[40:43], v[68:71]
    ds_read_b64_tr_b16 a[34:35], v18 offset:1536
    v_mfma_f32_16x16x32_bf16 v[72:75], a[8:11], a[40:43], v[72:75]
    buffer_load_dwordx4 v8, s[12:15], s29 offen offset:3072 lds
    s_add_u32 s29, s29, 131072
    v_mfma_f32_16x16x32_bf16 v[76:79], a[12:15], a[40:43], v[76:79]
    s_add_u32 m0, s33, 32768
    s_nop 0
    buffer_load_dwordx4 v5, s[12:15], s29 offen offset:0 lds
    s_waitcnt lgkmcnt(5)
    v_mfma_f32_16x16x32_bf16 v[80:83], a[0:3], a[44:47], v[80:83]
    ds_read_b64_tr_b16 a[36:37], v20 offset:0
    v_mfma_f32_16x16x32_bf16 v[84:87], a[4:7], a[44:47], v[84:87]
    ds_read_b64_tr_b16 a[38:39], v20 offset:1792
    v_mfma_f32_16x16x32_bf16 v[88:91], a[8:11], a[44:47], v[88:91]
    ds_read_b128 a[20:23], v14 offset:2048
    buffer_load_dwordx4 v6, s[12:15], s29 offen offset:1024 lds
    v_mfma_f32_16x16x32_bf16 v[92:95], a[12:15], a[44:47], v[92:95]
    buffer_load_dwordx4 v7, s[12:15], s29 offen offset:2048 lds
    s_waitcnt lgkmcnt(6)
    v_mfma_f32_16x16x32_bf16 v[96:99], a[48:51], a[0:3], v[96:99]
    ds_read_b64_tr_b16 a[40:41], v20 offset:14464
    v_mfma_f32_16x16x32_bf16 v[100:103], a[48:51], a[4:7], v[100:103]
    ds_read_b64_tr_b16 a[42:43], v20 offset:16256
    v_mfma_f32_16x16x32_bf16 v[104:107], a[48:51], a[8:11], v[104:107]
    buffer_load_dwordx4 v8, s[12:15], s29 offen offset:3072 lds
    s_add_u32 s29, s29, 131072
    v_mfma_f32_16x16x32_bf16 v[108:111], a[48:51], a[12:15], v[108:111]
    s_waitcnt lgkmcnt(5)
    v_mfma_f32_16x16x32_bf16 v[112:115], a[32:35], a[0:3], v[112:115]
    ds_read_b64_tr_b16 a[44:45], v20 offset:32
    v_mfma_f32_16x16x32_bf16 v[116:119], a[32:35], a[4:7], v[116:119]
    ds_read_b64_tr_b16 a[46:47], v20 offset:1824
    v_mfma_f32_16x16x32_bf16 v[120:123], a[32:35], a[8:11], v[120:123]
    ds_read_b128 a[24:27], v14 offset:4096
    s_add_u32 m0, s33, 49152
    s_nop 0
    buffer_load_dwordx4 v5, s[12:15], s29 offen offset:0 lds
    v_mfma_f32_16x16x32_bf16 v[124:127], a[32:35], a[12:15], v[124:127]
    s_waitcnt lgkmcnt(6)
    v_mfma_f32_16x16x32_bf16 v[128:131], a[36:39], a[0:3], v[128:131]
    ds_read_b64_tr_b16 a[48:49], v20 offset:14496
    v_mfma_f32_16x16x32_bf16 v[132:135], a[36:39], a[4:7], v[132:135]
    ds_read_b64_tr_b16 a[50:51], v20 offset:16288
    v_mfma_f32_16x16x32_bf16 v[136:139], a[36:39], a[8:11], v[136:139]
    buffer_load_dwordx4 v6, s[12:15], s29 offen offset:1024 lds
    v_mfma_f32_16x16x32_bf16 v[140:143], a[36:39], a[12:15], v[140:143]
    s_waitcnt lgkmcnt(5)
    v_mfma_f32_16x16x32_bf16 v[144:147], a[40:43], a[0:3], v[144:147]
    ds_read_b64_tr_b16 a[32:33], v17 offset:6208
    v_mfma_f32_16x16x32_bf16 v[148:151], a[40:43], a[4:7], v[148:151]
    ds_read_b64_tr_b16 a[34:35], v17 offset:7744
    v_mfma_f32_16x16x32_bf16 v[152:155], a[40:43], a[8:11], v[152:155]
    ds_read_b128 a[28:31], v14 offset:6144
    buffer_load_dwordx4 v7, s[12:15], s29 offen offset:2048 lds
    v_mfma_f32_16x16x32_bf16 v[156:159], a[40:43], a[12:15], v[156:159]
    s_waitcnt lgkmcnt(6)
    v_mfma_f32_16x16x32_bf16 v[160:163], a[44:47], a[0:3], v[160:163]
    ds_read_b64_tr_b16 a[36:37], v18 offset:6208
    v_mfma_f32_16x16x32_bf16 v[164:167], a[44:47], a[4:7], v[164:167]
    ds_read_b64_tr_b16 a[38:39], v18 offset:7744
    v_mfma_f32_16x16x32_bf16 v[168:171], a[44:47], a[8:11], v[168:171]
    buffer_load_dwordx4 v8, s[12:15], s29 offen offset:3072 lds
    s_add_u32 s29, s29, 131072
    v_mfma_f32_16x16x32_bf16 v[172:175], a[44:47], a[12:15], v[172:175]
    s_waitcnt lgkmcnt(5)
    v_mfma_f32_16x16x32_bf16 v[176:179], a[48:51], a[0:3], v[176:179]
    ds_read_b64_tr_b16 a[40:41], v17 offset:6272
    v_mfma_f32_16x16x32_bf16 v[180:183], a[48:51], a[4:7], v[180:183]
    ds_read_b64_tr_b16 a[42:43], v17 offset:7808
    v_mfma_f32_16x16x32_bf16 v[184:187], a[48:51], a[8:11], v[184:187]
    s_mov_b32 s19, s65
    s_lshl_b32 s6, s53, 8
    s_add_u32 s16, s4, s6
    s_addc_u32 s17, s5, 0
    s_sub_u32 s18, 2097152, s6
    v_mfma_f32_16x16x32_bf16 v[188:191], a[48:51], a[12:15], v[188:191]
    s_waitcnt lgkmcnt(4)
    v_mfma_f32_16x16x32_bf16 v[32:35], a[32:35], a[16:19], v[32:35]
    ds_read_b64_tr_b16 a[44:45], v18 offset:6272
    v_mfma_f32_16x16x32_bf16 v[36:39], a[32:35], a[20:23], v[36:39]
    ds_read_b64_tr_b16 a[46:47], v18 offset:7808
    v_mfma_f32_16x16x32_bf16 v[40:43], a[32:35], a[24:27], v[40:43]
    v_lshlrev_b32 v9, 4, v1
    s_mul_i32 s3, s26, 294912
    v_add_u32 v2, s3, v9
    v_add_u32 v3, 145408, v2
    s_mov_b32 s28, 8192
    v_mfma_f32_16x16x32_bf16 v[44:47], a[32:35], a[28:31], v[44:47]
    s_waitcnt lgkmcnt(4)
    v_mfma_f32_16x16x32_bf16 v[48:51], a[36:39], a[16:19], v[48:51]
    ds_read_b64_tr_b16 a[48:49], v17 offset:6144
    v_mfma_f32_16x16x32_bf16 v[52:55], a[36:39], a[20:23], v[52:55]
    ds_read_b64_tr_b16 a[50:51], v17 offset:7680
    v_mfma_f32_16x16x32_bf16 v[56:59], a[36:39], a[24:27], v[56:59]
    s_mov_b32 s30, 4
    s_mov_b32 s29, 524288
    s_cmp_eq_u32 s54, 0
    s_cselect_b32 s31, 32, 24
    s_cselect_b32 s34, 1048576, 0
    s_mov_b32 s36, 49152
    s_cselect_b32 s36, 131072, s36
    v_mfma_f32_16x16x32_bf16 v[60:63], a[36:39], a[28:31], v[60:63]
    s_waitcnt lgkmcnt(4)
    v_mfma_f32_16x16x32_bf16 v[64:67], a[16:19], a[40:43], v[64:67]
    ds_read_b64_tr_b16 a[32:33], v18 offset:6144
    v_mfma_f32_16x16x32_bf16 v[68:71], a[20:23], a[40:43], v[68:71]
    ds_read_b64_tr_b16 a[34:35], v18 offset:7680
    v_mfma_f32_16x16x32_bf16 v[72:75], a[24:27], a[40:43], v[72:75]
    s_mul_i32 s3, s52, 1179648
    s_mul_i32 s6, s54, 65536
    s_add_u32 s3, s3, s6
    s_add_u32 s8, s58, s3
    s_addc_u32 s9, s59, 0
    v_mfma_f32_16x16x32_bf16 v[76:79], a[28:31], a[40:43], v[76:79]
    s_waitcnt lgkmcnt(4)
    v_mfma_f32_16x16x32_bf16 v[80:83], a[16:19], a[44:47], v[80:83]
    ds_read_b64_tr_b16 a[36:37], v20 offset:7168
    v_mfma_f32_16x16x32_bf16 v[84:87], a[20:23], a[44:47], v[84:87]
    ds_read_b64_tr_b16 a[38:39], v20 offset:8960
    v_mfma_f32_16x16x32_bf16 v[88:91], a[24:27], a[44:47], v[88:91]
    s_sub_u32 s10, 18874368, s3
    s_mov_b32 s11, 0x20000
    s_lshr_b32 s3, s26, 1
    s_lshl_b32 s3, s3, 1
    s_add_u32 s3, s3, s54
    v_mfma_f32_16x16x32_bf16 v[92:95], a[28:31], a[44:47], v[92:95]
    s_waitcnt lgkmcnt(4)
    v_mfma_f32_16x16x32_bf16 v[96:99], a[48:51], a[16:19], v[96:99]
    ds_read_b64_tr_b16 a[40:41], v20 offset:21632
    v_mfma_f32_16x16x32_bf16 v[100:103], a[48:51], a[20:23], v[100:103]
    ds_read_b64_tr_b16 a[42:43], v20 offset:23424
    v_mfma_f32_16x16x32_bf16 v[104:107], a[48:51], a[24:27], v[104:107]
    s_lshl_b32 s3, s3, 1
    s_and_b32 s6, s26, 1
    s_add_u32 s3, s3, s6
    s_lshl_b32 s35, s3, 11
    s_add_u32 s35, s35, 65536
    v_mfma_f32_16x16x32_bf16 v[108:111], a[48:51], a[28:31], v[108:111]
    s_waitcnt lgkmcnt(4)
    v_mfma_f32_16x16x32_bf16 v[112:115], a[32:35], a[16:19], v[112:115]
    ds_read_b64_tr_b16 a[44:45], v20 offset:7200
    v_mfma_f32_16x16x32_bf16 v[116:119], a[32:35], a[20:23], v[116:119]
    ds_read_b64_tr_b16 a[46:47], v20 offset:8992
    v_mfma_f32_16x16x32_bf16 v[120:123], a[32:35], a[24:27], v[120:123]
    ds_read_b64_tr_b16 a[48:49], v20 offset:21664
    s_mul_i32 s3, s3, 147456
    v_add_u32 v4, s3, v9
    v_lshlrev_b32 v10, 2, v1
    s_lshl_b32 s47, s52, 8
    s_add_u32 s47, s47, 21594112
    v_mfma_f32_16x16x32_bf16 v[124:127], a[32:35], a[28:31], v[124:127]
    ds_read_b64_tr_b16 a[50:51], v20 offset:23456
    s_waitcnt lgkmcnt(6)
    v_mfma_f32_16x16x32_bf16 v[128:131], a[36:39], a[16:19], v[128:131]
    v_mfma_f32_16x16x32_bf16 v[132:135], a[36:39], a[20:23], v[132:135]
    v_mfma_f32_16x16x32_bf16 v[136:139], a[36:39], a[24:27], v[136:139]
    s_mov_b32 s46, 0x01010101
    v_mfma_f32_16x16x32_bf16 v[140:143], a[36:39], a[28:31], v[140:143]
    s_waitcnt lgkmcnt(4)
    v_mfma_f32_16x16x32_bf16 v[144:147], a[40:43], a[16:19], v[144:147]
    v_mfma_f32_16x16x32_bf16 v[148:151], a[40:43], a[20:23], v[148:151]
    v_mfma_f32_16x16x32_bf16 v[152:155], a[40:43], a[24:27], v[152:155]
    v_mfma_f32_16x16x32_bf16 v[156:159], a[40:43], a[28:31], v[156:159]
    s_waitcnt lgkmcnt(2)
    v_mfma_f32_16x16x32_bf16 v[160:163], a[44:47], a[16:19], v[160:163]
    v_mfma_f32_16x16x32_bf16 v[164:167], a[44:47], a[20:23], v[164:167]
    v_mfma_f32_16x16x32_bf16 v[168:171], a[44:47], a[24:27], v[168:171]
    v_mfma_f32_16x16x32_bf16 v[172:175], a[44:47], a[28:31], v[172:175]
    s_waitcnt lgkmcnt(0)
    v_mfma_f32_16x16x32_bf16 v[176:179], a[48:51], a[16:19], v[176:179]
    v_mfma_f32_16x16x32_bf16 v[180:183], a[48:51], a[20:23], v[180:183]
    v_mfma_f32_16x16x32_bf16 v[184:187], a[48:51], a[24:27], v[184:187]
    v_mfma_f32_16x16x32_bf16 v[188:191], a[48:51], a[28:31], v[188:191]
    v_bfe_u32 v24, v1, 2, 2
    v_lshrrev_b32 v25, 4, v1
    v_lshl_add_u32 v24, v25, 2, v24
    v_lshlrev_b32 v24, 6, v24
    v_and_b32 v25, 3, v1
    v_lshl_add_u32 v24, v25, 3, v24
    v_add_u32 v24, 147968, v24
    ds_read_b64_tr_b16 v[16:17], v24 offset:0
    ds_read_b64_tr_b16 v[18:19], v24 offset:1024
    ds_read_b64_tr_b16 v[20:21], v24 offset:32
    ds_read_b64_tr_b16 v[22:23], v24 offset:1056
    v_and_b32 v11, 15, v1
    v_lshlrev_b32 v11, 4, v11
    v_lshrrev_b32 v12, 5, v1
    v_lshl_add_u32 v11, v12, 8, v11
    v_bfe_u32 v12, v1, 4, 1
    v_lshl_add_u32 v11, v12, 9, v11
    s_lshl_b32 s3, s24, 4
    s_lshl_b32 s62, s26, 2
    s_add_u32 s62, s62, s3
    s_mul_i32 s62, s62, 147456
    s_mul_i32 s3, s25, 7
    s_add_u32 s3, s3, 1
    s_lshr_b32 s3, s3, 1
    s_lshl_b32 s3, s3, 10
    s_add_u32 s63, s62, s3
    s_add_u32 s64, s63, 147456
    s_add_u32 s65, s63, 294912
    s_add_u32 s66, s63, 442368
    buffer_load_dword v14, v10, s[48:51], 0 offen sc1
    s_setprio 3
    v_pk_mul_f32 v[128:129], v[128:129], s[38:39]
    v_pk_mul_f32 v[130:131], v[130:131], s[38:39]
    v_pk_mul_f32 v[132:133], v[132:133], s[38:39]
    v_pk_mul_f32 v[134:135], v[134:135], s[38:39]
    v_pk_mul_f32 v[136:137], v[136:137], s[38:39]
    v_pk_mul_f32 v[138:139], v[138:139], s[38:39]
    v_pk_mul_f32 v[140:141], v[140:141], s[38:39]
    v_pk_mul_f32 v[142:143], v[142:143], s[38:39]
    v_exp_f32 v128, -v128
    v_exp_f32 v129, -v129
    v_exp_f32 v130, -v130
    v_exp_f32 v131, -v131
    v_exp_f32 v132, -v132
    v_exp_f32 v133, -v133
    v_exp_f32 v134, -v134
    v_exp_f32 v135, -v135
    v_exp_f32 v136, -v136
    v_exp_f32 v137, -v137
    v_exp_f32 v138, -v138
    v_exp_f32 v139, -v139
    v_exp_f32 v140, -v140
    v_exp_f32 v141, -v141
    v_exp_f32 v142, -v142
    v_exp_f32 v143, -v143
    v_pk_add_f32 v[128:129], v[128:129], 1.0 op_sel_hi:[1,0]
    v_pk_add_f32 v[130:131], v[130:131], 1.0 op_sel_hi:[1,0]
    v_pk_add_f32 v[132:133], v[132:133], 1.0 op_sel_hi:[1,0]
    v_pk_add_f32 v[134:135], v[134:135], 1.0 op_sel_hi:[1,0]
    v_pk_add_f32 v[136:137], v[136:137], 1.0 op_sel_hi:[1,0]
    v_pk_add_f32 v[138:139], v[138:139], 1.0 op_sel_hi:[1,0]
    v_pk_add_f32 v[140:141], v[140:141], 1.0 op_sel_hi:[1,0]
    v_pk_add_f32 v[142:143], v[142:143], 1.0 op_sel_hi:[1,0]
    v_rcp_f32 v128, v128
    v_rcp_f32 v129, v129
    v_rcp_f32 v130, v130
    v_rcp_f32 v131, v131
    v_rcp_f32 v132, v132
    v_rcp_f32 v133, v133
    v_rcp_f32 v134, v134
    v_rcp_f32 v135, v135
    v_rcp_f32 v136, v136
    v_rcp_f32 v137, v137
    v_rcp_f32 v138, v138
    v_rcp_f32 v139, v139
    v_rcp_f32 v140, v140
    v_rcp_f32 v141, v141
    v_rcp_f32 v142, v142
    v_rcp_f32 v143, v143
    v_pk_mul_f32 v[128:129], v[128:129], v[144:145]
    v_pk_mul_f32 v[130:131], v[130:131], v[146:147]
    v_pk_mul_f32 v[132:133], v[132:133], v[148:149]
    v_pk_mul_f32 v[134:135], v[134:135], v[150:151]
    v_pk_mul_f32 v[136:137], v[136:137], v[152:153]
    v_pk_mul_f32 v[138:139], v[138:139], v[154:155]
    v_pk_mul_f32 v[140:141], v[140:141], v[156:157]
    v_pk_mul_f32 v[142:143], v[142:143], v[158:159]
    v_pk_mul_f32 v[160:161], v[160:161], s[38:39]
    v_pk_mul_f32 v[162:163], v[162:163], s[38:39]
    v_pk_mul_f32 v[164:165], v[164:165], s[38:39]
    v_pk_mul_f32 v[166:167], v[166:167], s[38:39]
    v_pk_mul_f32 v[168:169], v[168:169], s[38:39]
    v_pk_mul_f32 v[170:171], v[170:171], s[38:39]
    v_pk_mul_f32 v[172:173], v[172:173], s[38:39]
    v_pk_mul_f32 v[174:175], v[174:175], s[38:39]
    v_exp_f32 v160, -v160
    v_exp_f32 v161, -v161
    v_exp_f32 v162, -v162
    v_exp_f32 v163, -v163
    v_exp_f32 v164, -v164
    v_exp_f32 v165, -v165
    v_exp_f32 v166, -v166
    v_exp_f32 v167, -v167
    v_exp_f32 v168, -v168
    v_exp_f32 v169, -v169
    v_exp_f32 v170, -v170
    v_exp_f32 v171, -v171
    v_exp_f32 v172, -v172
    v_exp_f32 v173, -v173
    v_exp_f32 v174, -v174
    v_exp_f32 v175, -v175
    v_pk_add_f32 v[160:161], v[160:161], 1.0 op_sel_hi:[1,0]
    v_pk_add_f32 v[162:163], v[162:163], 1.0 op_sel_hi:[1,0]
    v_pk_add_f32 v[164:165], v[164:165], 1.0 op_sel_hi:[1,0]
    v_pk_add_f32 v[166:167], v[166:167], 1.0 op_sel_hi:[1,0]
    v_pk_add_f32 v[168:169], v[168:169], 1.0 op_sel_hi:[1,0]
    v_pk_add_f32 v[170:171], v[170:171], 1.0 op_sel_hi:[1,0]
    v_pk_add_f32 v[172:173], v[172:173], 1.0 op_sel_hi:[1,0]
    v_pk_add_f32 v[174:175], v[174:175], 1.0 op_sel_hi:[1,0]
    v_rcp_f32 v160, v160
    v_rcp_f32 v161, v161
    v_rcp_f32 v162, v162
    v_rcp_f32 v163, v163
    v_rcp_f32 v164, v164
    v_rcp_f32 v165, v165
    v_rcp_f32 v166, v166
    v_rcp_f32 v167, v167
    v_rcp_f32 v168, v168
    v_rcp_f32 v169, v169
    v_rcp_f32 v170, v170
    v_rcp_f32 v171, v171
    v_rcp_f32 v172, v172
    v_rcp_f32 v173, v173
    v_rcp_f32 v174, v174
    v_rcp_f32 v175, v175
    v_pk_mul_f32 v[160:161], v[160:161], v[176:177]
    v_pk_mul_f32 v[162:163], v[162:163], v[178:179]
    v_pk_mul_f32 v[164:165], v[164:165], v[180:181]
    v_pk_mul_f32 v[166:167], v[166:167], v[182:183]
    v_pk_mul_f32 v[168:169], v[168:169], v[184:185]
    v_pk_mul_f32 v[170:171], v[170:171], v[186:187]
    v_pk_mul_f32 v[172:173], v[172:173], v[188:189]
    v_pk_mul_f32 v[174:175], v[174:175], v[190:191]
    v_cvt_pk_bf16_f32 v144, v128, v129
    v_cvt_pk_bf16_f32 v145, v130, v131
    v_cvt_pk_bf16_f32 v146, v160, v161
    v_cvt_pk_bf16_f32 v147, v162, v163
    v_cvt_pk_bf16_f32 v148, v132, v133
    v_cvt_pk_bf16_f32 v149, v134, v135
    v_cvt_pk_bf16_f32 v150, v164, v165
    v_cvt_pk_bf16_f32 v151, v166, v167
    v_cvt_pk_bf16_f32 v152, v136, v137
    v_cvt_pk_bf16_f32 v153, v138, v139
    v_cvt_pk_bf16_f32 v154, v168, v169
    v_cvt_pk_bf16_f32 v155, v170, v171
    v_cvt_pk_bf16_f32 v156, v140, v141
    v_cvt_pk_bf16_f32 v157, v142, v143
    v_cvt_pk_bf16_f32 v158, v172, v173
    v_cvt_pk_bf16_f32 v159, v174, v175
    v_permlane16_swap_b32 v144, v146
    v_permlane16_swap_b32 v145, v147
    v_permlane16_swap_b32 v148, v150
    v_permlane16_swap_b32 v149, v151
    v_permlane16_swap_b32 v152, v154
    v_permlane16_swap_b32 v153, v155
    v_permlane16_swap_b32 v156, v158
    v_permlane16_swap_b32 v157, v159
    buffer_store_dwordx4 v[144:147], v11, s[20:23], s63 offen offset:0 sc1
    buffer_store_dwordx4 v[148:151], v11, s[20:23], s64 offen offset:0 sc1
    buffer_store_dwordx4 v[152:155], v11, s[20:23], s65 offen offset:0 sc1
    buffer_store_dwordx4 v[156:159], v11, s[20:23], s66 offen offset:0 sc1
    s_setprio 0
    s_waitcnt lgkmcnt(0)
    v_cvt_pk_bf16_f32 v176, v32, v33
    v_cvt_pk_bf16_f32 v177, v34, v35
    v_cvt_pk_bf16_f32 v178, v48, v49
    v_cvt_pk_bf16_f32 v179, v50, v51
    v_cvt_pk_bf16_f32 v180, v36, v37
    v_cvt_pk_bf16_f32 v181, v38, v39
    v_cvt_pk_bf16_f32 v182, v52, v53
    v_cvt_pk_bf16_f32 v183, v54, v55
    v_cvt_pk_bf16_f32 v184, v40, v41
    v_cvt_pk_bf16_f32 v185, v42, v43
    v_cvt_pk_bf16_f32 v186, v56, v57
    v_cvt_pk_bf16_f32 v187, v58, v59
    v_cvt_pk_bf16_f32 v188, v44, v45
    v_cvt_pk_bf16_f32 v189, v46, v47
    v_cvt_pk_bf16_f32 v190, v60, v61
    v_cvt_pk_bf16_f32 v191, v62, v63
    v_mfma_f32_16x16x32_bf16 v[32:35], v[16:19], v[176:179], 0
    v_mfma_f32_16x16x32_bf16 v[48:51], v[20:23], v[176:179], 0
    v_mfma_f32_16x16x32_bf16 v[36:39], v[16:19], v[180:183], 0
    v_mfma_f32_16x16x32_bf16 v[52:55], v[20:23], v[180:183], 0
    v_mfma_f32_16x16x32_bf16 v[40:43], v[16:19], v[184:187], 0
    v_mfma_f32_16x16x32_bf16 v[56:59], v[20:23], v[184:187], 0
    v_mfma_f32_16x16x32_bf16 v[44:47], v[16:19], v[188:191], 0
    v_mfma_f32_16x16x32_bf16 v[60:63], v[20:23], v[188:191], 0
    v_cvt_pk_bf16_f32 v64, v64, v65
    v_cvt_pk_bf16_f32 v65, v66, v67
    v_cvt_pk_bf16_f32 v66, v68, v69
    v_cvt_pk_bf16_f32 v67, v70, v71
    v_cvt_pk_bf16_f32 v68, v72, v73
    v_cvt_pk_bf16_f32 v69, v74, v75
    v_cvt_pk_bf16_f32 v70, v76, v77
    v_cvt_pk_bf16_f32 v71, v78, v79
    v_cvt_pk_bf16_f32 v72, v80, v81
    v_cvt_pk_bf16_f32 v73, v82, v83
    v_cvt_pk_bf16_f32 v74, v84, v85
    v_cvt_pk_bf16_f32 v75, v86, v87
    v_cvt_pk_bf16_f32 v76, v88, v89
    v_cvt_pk_bf16_f32 v77, v90, v91
    v_cvt_pk_bf16_f32 v78, v92, v93
    v_cvt_pk_bf16_f32 v79, v94, v95
    v_max3_f32 v160, v32, v33, v34
    v_min3_f32 v168, v32, v33, v34
    v_max3_f32 v160, v160, v35, v48
    v_min3_f32 v168, v168, v35, v48
    v_max3_f32 v160, v160, v49, v50
    v_min3_f32 v168, v168, v49, v50
    v_max_f32 v160, v160, v51
    v_min_f32 v168, v168, v51
    v_max3_f32 v162, v36, v37, v38
    v_min3_f32 v170, v36, v37, v38
    v_max3_f32 v162, v162, v39, v52
    v_min3_f32 v170, v170, v39, v52
    v_max3_f32 v162, v162, v53, v54
    v_min3_f32 v170, v170, v53, v54
    v_max_f32 v162, v162, v55
    v_min_f32 v170, v170, v55
    v_max3_f32 v164, v40, v41, v42
    v_min3_f32 v172, v40, v41, v42
    v_max3_f32 v164, v164, v43, v56
    v_min3_f32 v172, v172, v43, v56
    v_max3_f32 v164, v164, v57, v58
    v_min3_f32 v172, v172, v57, v58
    v_max_f32 v164, v164, v59
    v_min_f32 v172, v172, v59
    v_max3_f32 v166, v44, v45, v46
    v_min3_f32 v174, v44, v45, v46
    v_max3_f32 v166, v166, v47, v60
    v_min3_f32 v174, v174, v47, v60
    v_max3_f32 v166, v166, v61, v62
    v_min3_f32 v174, v174, v61, v62
    v_max_f32 v166, v166, v63
    v_min_f32 v174, v174, v63
    v_permlane32_swap_b32 v160, v162
    v_permlane32_swap_b32 v168, v170
    v_permlane32_swap_b32 v164, v166
    v_permlane32_swap_b32 v172, v174
    v_max_f32 v160, v160, v162
    v_min_f32 v168, v168, v170
    v_max_f32 v164, v164, v166
    v_min_f32 v172, v172, v174
    s_nop 0
    v_permlane16_swap_b32 v160, v164
    v_permlane16_swap_b32 v168, v172
    v_max_f32 v160, v160, v164
    v_min_f32 v168, v168, v172
    v_mov_b32 v164, v160
    v_mov_b32 v172, v168
    s_nop 0
    v_permlane16_swap_b32 v160, v164
    v_permlane16_swap_b32 v168, v172
    v_mov_b32 v162, v160
    v_mov_b32 v170, v168
    v_mov_b32 v166, v164
    v_mov_b32 v174, v172
    v_permlane32_swap_b32 v160, v162
    v_permlane32_swap_b32 v168, v170
    v_permlane32_swap_b32 v164, v166
    v_permlane32_swap_b32 v172, v174
    v_mul_f32 v160, s38, v160
    v_mul_f32 v162, s38, v162
    v_mul_f32 v164, s38, v164
    v_mul_f32 v166, s38, v166
    v_mul_f32 v168, s38, v168
    v_mul_f32 v170, s38, v170
    v_mul_f32 v172, s38, v172
    v_mul_f32 v174, s38, v174
    s_waitcnt vmcnt(0)
    v_mov_b32 v12, s77
    v_mov_b32 v13, 1
    s_mov_b64 exec, 1
    buffer_store_dword v13, v12, s[20:23], 0 offen sc1
    s_mov_b64 exec, -1
    v_bfe_u32 v161, v1, 2, 2
    v_lshrrev_b32 v163, 4, v1
    v_and_b32 v165, 3, v1
    v_lshl_add_u32 v167, v163, 2, v161
    s_lshl_b32 s7, s26, 13
    s_add_u32 s7, s7, 131072
    v_and_b32 v169, 15, v1
    v_lshlrev_b32 v169, 7, v169
    v_xor_b32 v171, v163, v165
    v_lshl_add_u32 v169, v171, 3, v169
    v_add_u32 v169, s7, v169
    v_xor_b32 v171, 0, v161
    v_lshl_add_u32 v128, v171, 5, v169
    v_xor_b32 v171, 1, v161
    v_lshl_add_u32 v129, v171, 5, v169
    v_xor_b32 v171, 2, v161
    v_lshl_add_u32 v130, v171, 5, v169
    v_xor_b32 v171, 3, v161
    v_lshl_add_u32 v131, v171, 5, v169
    v_lshlrev_b32 v169, 7, v167
    v_xor_b32 v171, v165, v161
    v_lshl_add_u32 v169, v171, 3, v169
    v_add_u32 v169, s7, v169
    v_xor_b32 v171, 0, v163
    v_lshl_add_u32 v132, v171, 5, v169
    v_xor_b32 v171, 1, v163
    v_lshl_add_u32 v133, v171, 5, v169
    v_xor_b32 v171, 2, v163
    v_lshl_add_u32 v134, v171, 5, v169
    v_xor_b32 v171, 3, v163
    v_lshl_add_u32 v135, v171, 5, v169
    v_pk_fma_f32 v[176:177], v[32:33], s[38:39], v[168:169] op_sel_hi:[1,1,0] neg_lo:[1,0,0] neg_hi:[1,0,0]
    v_pk_fma_f32 v[32:33], v[32:33], s[38:39], v[160:161] op_sel_hi:[1,1,0] neg_lo:[0,0,1] neg_hi:[0,0,1]
    v_pk_fma_f32 v[178:179], v[34:35], s[38:39], v[168:169] op_sel_hi:[1,1,0] neg_lo:[1,0,0] neg_hi:[1,0,0]
    v_pk_fma_f32 v[34:35], v[34:35], s[38:39], v[160:161] op_sel_hi:[1,1,0] neg_lo:[0,0,1] neg_hi:[0,0,1]
    v_pk_fma_f32 v[180:181], v[48:49], s[38:39], v[168:169] op_sel_hi:[1,1,0] neg_lo:[1,0,0] neg_hi:[1,0,0]
    v_pk_fma_f32 v[48:49], v[48:49], s[38:39], v[160:161] op_sel_hi:[1,1,0] neg_lo:[0,0,1] neg_hi:[0,0,1]
    v_pk_fma_f32 v[182:183], v[50:51], s[38:39], v[168:169] op_sel_hi:[1,1,0] neg_lo:[1,0,0] neg_hi:[1,0,0]
    v_pk_fma_f32 v[50:51], v[50:51], s[38:39], v[160:161] op_sel_hi:[1,1,0] neg_lo:[0,0,1] neg_hi:[0,0,1]
    v_exp_f32 v32, v32
    v_exp_f32 v176, v176
    v_exp_f32 v33, v33
    v_exp_f32 v177, v177
    v_exp_f32 v34, v34
    v_exp_f32 v178, v178
    v_exp_f32 v35, v35
    v_exp_f32 v179, v179
    v_exp_f32 v48, v48
    v_exp_f32 v180, v180
    v_exp_f32 v49, v49
    v_exp_f32 v181, v181
    v_exp_f32 v50, v50
    v_exp_f32 v182, v182
    v_exp_f32 v51, v51
    v_exp_f32 v183, v183
    v_pk_fma_f32 v[184:185], v[36:37], s[38:39], v[170:171] op_sel_hi:[1,1,0] neg_lo:[1,0,0] neg_hi:[1,0,0]
    v_pk_fma_f32 v[36:37], v[36:37], s[38:39], v[162:163] op_sel_hi:[1,1,0] neg_lo:[0,0,1] neg_hi:[0,0,1]
    v_pk_fma_f32 v[186:187], v[38:39], s[38:39], v[170:171] op_sel_hi:[1,1,0] neg_lo:[1,0,0] neg_hi:[1,0,0]
    v_pk_fma_f32 v[38:39], v[38:39], s[38:39], v[162:163] op_sel_hi:[1,1,0] neg_lo:[0,0,1] neg_hi:[0,0,1]
    v_pk_fma_f32 v[188:189], v[52:53], s[38:39], v[170:171] op_sel_hi:[1,1,0] neg_lo:[1,0,0] neg_hi:[1,0,0]
    v_pk_fma_f32 v[52:53], v[52:53], s[38:39], v[162:163] op_sel_hi:[1,1,0] neg_lo:[0,0,1] neg_hi:[0,0,1]
    v_pk_fma_f32 v[190:191], v[54:55], s[38:39], v[170:171] op_sel_hi:[1,1,0] neg_lo:[1,0,0] neg_hi:[1,0,0]
    v_pk_fma_f32 v[54:55], v[54:55], s[38:39], v[162:163] op_sel_hi:[1,1,0] neg_lo:[0,0,1] neg_hi:[0,0,1]
    v_exp_f32 v36, v36
    v_exp_f32 v184, v184
    v_exp_f32 v37, v37
    v_exp_f32 v185, v185
    v_exp_f32 v38, v38
    v_exp_f32 v186, v186
    v_exp_f32 v39, v39
    v_exp_f32 v187, v187
    v_exp_f32 v52, v52
    v_exp_f32 v188, v188
    v_exp_f32 v53, v53
    v_exp_f32 v189, v189
    v_exp_f32 v54, v54
    v_exp_f32 v190, v190
    v_exp_f32 v55, v55
    v_exp_f32 v191, v191
    v_pk_fma_f32 v[80:81], v[40:41], s[38:39], v[172:173] op_sel_hi:[1,1,0] neg_lo:[1,0,0] neg_hi:[1,0,0]
    v_pk_fma_f32 v[40:41], v[40:41], s[38:39], v[164:165] op_sel_hi:[1,1,0] neg_lo:[0,0,1] neg_hi:[0,0,1]
    v_pk_fma_f32 v[82:83], v[42:43], s[38:39], v[172:173] op_sel_hi:[1,1,0] neg_lo:[1,0,0] neg_hi:[1,0,0]
    v_pk_fma_f32 v[42:43], v[42:43], s[38:39], v[164:165] op_sel_hi:[1,1,0] neg_lo:[0,0,1] neg_hi:[0,0,1]
    v_pk_fma_f32 v[84:85], v[56:57], s[38:39], v[172:173] op_sel_hi:[1,1,0] neg_lo:[1,0,0] neg_hi:[1,0,0]
    v_pk_fma_f32 v[56:57], v[56:57], s[38:39], v[164:165] op_sel_hi:[1,1,0] neg_lo:[0,0,1] neg_hi:[0,0,1]
    v_pk_fma_f32 v[86:87], v[58:59], s[38:39], v[172:173] op_sel_hi:[1,1,0] neg_lo:[1,0,0] neg_hi:[1,0,0]
    v_pk_fma_f32 v[58:59], v[58:59], s[38:39], v[164:165] op_sel_hi:[1,1,0] neg_lo:[0,0,1] neg_hi:[0,0,1]
    v_exp_f32 v40, v40
    v_exp_f32 v80, v80
    v_exp_f32 v41, v41
    v_exp_f32 v81, v81
    v_exp_f32 v42, v42
    v_exp_f32 v82, v82
    v_exp_f32 v43, v43
    v_exp_f32 v83, v83
    v_exp_f32 v56, v56
    v_exp_f32 v84, v84
    v_exp_f32 v57, v57
    v_exp_f32 v85, v85
    v_exp_f32 v58, v58
    v_exp_f32 v86, v86
    v_exp_f32 v59, v59
    v_exp_f32 v87, v87
    v_pk_fma_f32 v[88:89], v[44:45], s[38:39], v[174:175] op_sel_hi:[1,1,0] neg_lo:[1,0,0] neg_hi:[1,0,0]
    v_pk_fma_f32 v[44:45], v[44:45], s[38:39], v[166:167] op_sel_hi:[1,1,0] neg_lo:[0,0,1] neg_hi:[0,0,1]
    v_pk_fma_f32 v[90:91], v[46:47], s[38:39], v[174:175] op_sel_hi:[1,1,0] neg_lo:[1,0,0] neg_hi:[1,0,0]
    v_pk_fma_f32 v[46:47], v[46:47], s[38:39], v[166:167] op_sel_hi:[1,1,0] neg_lo:[0,0,1] neg_hi:[0,0,1]
    v_pk_fma_f32 v[92:93], v[60:61], s[38:39], v[174:175] op_sel_hi:[1,1,0] neg_lo:[1,0,0] neg_hi:[1,0,0]
    v_pk_fma_f32 v[60:61], v[60:61], s[38:39], v[166:167] op_sel_hi:[1,1,0] neg_lo:[0,0,1] neg_hi:[0,0,1]
    v_pk_fma_f32 v[94:95], v[62:63], s[38:39], v[174:175] op_sel_hi:[1,1,0] neg_lo:[1,0,0] neg_hi:[1,0,0]
    v_pk_fma_f32 v[62:63], v[62:63], s[38:39], v[166:167] op_sel_hi:[1,1,0] neg_lo:[0,0,1] neg_hi:[0,0,1]
    v_exp_f32 v44, v44
    v_exp_f32 v88, v88
    v_exp_f32 v45, v45
    v_exp_f32 v89, v89
    v_exp_f32 v46, v46
    v_exp_f32 v90, v90
    v_exp_f32 v47, v47
    v_exp_f32 v91, v91
    v_exp_f32 v60, v60
    v_exp_f32 v92, v92
    v_exp_f32 v61, v61
    v_exp_f32 v93, v93
    v_exp_f32 v62, v62
    v_exp_f32 v94, v94
    v_exp_f32 v63, v63
    v_exp_f32 v95, v95
    s_mov_b32 s37, 0x40000
L_dpoll:
    v_cmp_eq_u32 vcc, s46, v14
    s_nop 0
    s_cmp_eq_u64 vcc, -1
    s_cbranch_scc1 L_dpoll_ok
    s_sleep 2
    buffer_load_dword v14, v10, s[48:51], 0 offen sc1
    s_sub_u32 s37, s37, 1
    s_waitcnt vmcnt(0)
    s_cbranch_scc0 L_dpoll
L_dpoll_ok:
    v_pk_add_f32 v[136:137], v[32:33], v[34:35]
    v_pk_add_f32 v[138:139], v[176:177], v[178:179]
    v_pk_add_f32 v[136:137], v[136:137], v[48:49]
    v_pk_add_f32 v[138:139], v[138:139], v[180:181]
    v_pk_add_f32 v[136:137], v[136:137], v[50:51]
    v_pk_add_f32 v[138:139], v[138:139], v[182:183]
    v_add_f32 v160, v136, v137
    v_add_f32 v168, v138, v139
    v_pk_add_f32 v[136:137], v[36:37], v[38:39]
    v_pk_add_f32 v[138:139], v[184:185], v[186:187]
    v_pk_add_f32 v[136:137], v[136:137], v[52:53]
    v_pk_add_f32 v[138:139], v[138:139], v[188:189]
    v_pk_add_f32 v[136:137], v[136:137], v[54:55]
    v_pk_add_f32 v[138:139], v[138:139], v[190:191]
    v_add_f32 v162, v136, v137
    v_add_f32 v170, v138, v139
    v_pk_add_f32 v[136:137], v[40:41], v[42:43]
    v_pk_add_f32 v[138:139], v[80:81], v[82:83]
    v_pk_add_f32 v[136:137], v[136:137], v[56:57]
    v_pk_add_f32 v[138:139], v[138:139], v[84:85]
    v_pk_add_f32 v[136:137], v[136:137], v[58:59]
    v_pk_add_f32 v[138:139], v[138:139], v[86:87]
    v_add_f32 v164, v136, v137
    v_add_f32 v172, v138, v139
    v_pk_add_f32 v[136:137], v[44:45], v[46:47]
    v_pk_add_f32 v[138:139], v[88:89], v[90:91]
    v_pk_add_f32 v[136:137], v[136:137], v[60:61]
    v_pk_add_f32 v[138:139], v[138:139], v[92:93]
    v_pk_add_f32 v[136:137], v[136:137], v[62:63]
    v_pk_add_f32 v[138:139], v[138:139], v[94:95]
    v_add_f32 v166, v136, v137
    v_add_f32 v174, v138, v139
    v_permlane32_swap_b32 v160, v162
    v_permlane32_swap_b32 v168, v170
    v_permlane32_swap_b32 v164, v166
    v_permlane32_swap_b32 v172, v174
    v_add_f32 v160, v160, v162
    v_add_f32 v168, v168, v170
    v_add_f32 v164, v164, v166
    v_add_f32 v172, v172, v174
    s_nop 0
    v_permlane16_swap_b32 v160, v164
    v_permlane16_swap_b32 v168, v172
    v_add_f32 v160, v160, v164
    v_add_f32 v168, v168, v172
    v_mov_b32 v164, v160
    v_mov_b32 v172, v168
    s_nop 0
    v_permlane16_swap_b32 v160, v164
    v_permlane16_swap_b32 v168, v172
    v_mov_b32 v162, v160
    v_mov_b32 v170, v168
    v_mov_b32 v166, v164
    v_mov_b32 v174, v172
    v_permlane32_swap_b32 v160, v162
    v_permlane32_swap_b32 v168, v170
    v_permlane32_swap_b32 v164, v166
    v_permlane32_swap_b32 v172, v174
    v_rcp_f32 v160, v160
    v_rcp_f32 v162, v162
    v_rcp_f32 v164, v164
    v_rcp_f32 v166, v166
    v_rcp_f32 v168, v168
    v_rcp_f32 v170, v170
    v_rcp_f32 v172, v172
    v_rcp_f32 v174, v174
    s_barrier
    v_pk_mul_f32 v[32:33], v[32:33], v[160:161] op_sel_hi:[1,0]
    v_pk_mul_f32 v[34:35], v[34:35], v[160:161] op_sel_hi:[1,0]
    v_pk_mul_f32 v[48:49], v[48:49], v[160:161] op_sel_hi:[1,0]
    v_pk_mul_f32 v[50:51], v[50:51], v[160:161] op_sel_hi:[1,0]
    v_pk_mul_f32 v[176:177], v[176:177], v[168:169] op_sel_hi:[1,0]
    v_pk_mul_f32 v[178:179], v[178:179], v[168:169] op_sel_hi:[1,0]
    v_pk_mul_f32 v[180:181], v[180:181], v[168:169] op_sel_hi:[1,0]
    v_pk_mul_f32 v[182:183], v[182:183], v[168:169] op_sel_hi:[1,0]
    v_cvt_pk_bf16_f32 v32, v32, v33
    v_cvt_pk_bf16_f32 v33, v34, v35
    v_cvt_pk_bf16_f32 v48, v48, v49
    v_cvt_pk_bf16_f32 v49, v50, v51
    v_cvt_pk_bf16_f32 v176, v176, v177
    v_cvt_pk_bf16_f32 v177, v178, v179
    v_cvt_pk_bf16_f32 v180, v180, v181
    v_cvt_pk_bf16_f32 v181, v182, v183
    ds_write_b64 v128, v[32:33] offset:0
    ds_write_b64 v129, v[48:49] offset:0
    ds_write_b64 v130, v[176:177] offset:0
    ds_write_b64 v131, v[180:181] offset:0
    v_pk_mul_f32 v[36:37], v[36:37], v[162:163] op_sel_hi:[1,0]
    v_pk_mul_f32 v[38:39], v[38:39], v[162:163] op_sel_hi:[1,0]
    v_pk_mul_f32 v[52:53], v[52:53], v[162:163] op_sel_hi:[1,0]
    v_pk_mul_f32 v[54:55], v[54:55], v[162:163] op_sel_hi:[1,0]
    v_pk_mul_f32 v[184:185], v[184:185], v[170:171] op_sel_hi:[1,0]
    v_pk_mul_f32 v[186:187], v[186:187], v[170:171] op_sel_hi:[1,0]
    v_pk_mul_f32 v[188:189], v[188:189], v[170:171] op_sel_hi:[1,0]
    v_pk_mul_f32 v[190:191], v[190:191], v[170:171] op_sel_hi:[1,0]
    v_cvt_pk_bf16_f32 v36, v36, v37
    v_cvt_pk_bf16_f32 v37, v38, v39
    v_cvt_pk_bf16_f32 v52, v52, v53
    v_cvt_pk_bf16_f32 v53, v54, v55
    v_cvt_pk_bf16_f32 v184, v184, v185
    v_cvt_pk_bf16_f32 v185, v186, v187
    v_cvt_pk_bf16_f32 v188, v188, v189
    v_cvt_pk_bf16_f32 v189, v190, v191
    ds_write_b64 v128, v[36:37] offset:2048
    ds_write_b64 v129, v[52:53] offset:2048
    ds_write_b64 v130, v[184:185] offset:2048
    ds_write_b64 v131, v[188:189] offset:2048
    v_pk_mul_f32 v[40:41], v[40:41], v[164:165] op_sel_hi:[1,0]
    v_pk_mul_f32 v[42:43], v[42:43], v[164:165] op_sel_hi:[1,0]
    v_pk_mul_f32 v[56:57], v[56:57], v[164:165] op_sel_hi:[1,0]
    v_pk_mul_f32 v[58:59], v[58:59], v[164:165] op_sel_hi:[1,0]
    v_pk_mul_f32 v[80:81], v[80:81], v[172:173] op_sel_hi:[1,0]
    v_pk_mul_f32 v[82:83], v[82:83], v[172:173] op_sel_hi:[1,0]
    v_pk_mul_f32 v[84:85], v[84:85], v[172:173] op_sel_hi:[1,0]
    v_pk_mul_f32 v[86:87], v[86:87], v[172:173] op_sel_hi:[1,0]
    v_cvt_pk_bf16_f32 v40, v40, v41
    v_cvt_pk_bf16_f32 v41, v42, v43
    v_cvt_pk_bf16_f32 v56, v56, v57
    v_cvt_pk_bf16_f32 v57, v58, v59
    v_cvt_pk_bf16_f32 v80, v80, v81
    v_cvt_pk_bf16_f32 v81, v82, v83
    v_cvt_pk_bf16_f32 v84, v84, v85
    v_cvt_pk_bf16_f32 v85, v86, v87
    ds_write_b64 v128, v[40:41] offset:4096
    ds_write_b64 v129, v[56:57] offset:4096
    ds_write_b64 v130, v[80:81] offset:4096
    ds_write_b64 v131, v[84:85] offset:4096
    v_pk_mul_f32 v[44:45], v[44:45], v[166:167] op_sel_hi:[1,0]
    v_pk_mul_f32 v[46:47], v[46:47], v[166:167] op_sel_hi:[1,0]
    v_pk_mul_f32 v[60:61], v[60:61], v[166:167] op_sel_hi:[1,0]
    v_pk_mul_f32 v[62:63], v[62:63], v[166:167] op_sel_hi:[1,0]
    v_pk_mul_f32 v[88:89], v[88:89], v[174:175] op_sel_hi:[1,0]
    v_pk_mul_f32 v[90:91], v[90:91], v[174:175] op_sel_hi:[1,0]
    v_pk_mul_f32 v[92:93], v[92:93], v[174:175] op_sel_hi:[1,0]
    v_pk_mul_f32 v[94:95], v[94:95], v[174:175] op_sel_hi:[1,0]
    v_cvt_pk_bf16_f32 v44, v44, v45
    v_cvt_pk_bf16_f32 v45, v46, v47
    v_cvt_pk_bf16_f32 v60, v60, v61
    v_cvt_pk_bf16_f32 v61, v62, v63
    v_cvt_pk_bf16_f32 v88, v88, v89
    v_cvt_pk_bf16_f32 v89, v90, v91
    v_cvt_pk_bf16_f32 v92, v92, v93
    v_cvt_pk_bf16_f32 v93, v94, v95
    ds_write_b64 v128, v[44:45] offset:6144
    ds_write_b64 v129, v[60:61] offset:6144
    ds_write_b64 v130, v[88:89] offset:6144
    ds_write_b64 v131, v[92:93] offset:6144
    v_add_u32 v24, s7, v9
    s_lshl_b32 s3, s26, 11
    v_add_u32 v28, s3, v9
    v_add_u32 v25, 131072, v28
    v_lshl_add_u32 v171, v163, 2, v165
    v_lshlrev_b32 v27, 4, v171
    v_add_u32 v27, 8192, v27
    s_lshl_b32 s3, s26, 10
    s_add_u32 s3, s3, 114688
    v_add_u32 v26, s3, v9
    v_add_u32 v31, 114688, v9
    s_lshr_b32 s3, s26, 1
    s_lshl_b32 s3, s3, 12
    s_and_b32 s6, s26, 1
    s_lshl_b32 s6, s6, 10
    s_add_u32 s3, s3, s6
    v_add_u32 v29, s3, v9
    v_and_b32 v30, 124, v10
    s_lshl_b32 s3, s25, 3
    s_mul_i32 s6, s3, 9216
    s_add_u32 s6, s6, 33554432
    s_mul_i32 s3, s24, 9216
    s_add_u32 s7, s6, s3
    s_waitcnt lgkmcnt(0)
    ds_read_b64_tr_b16 a[0:1], v132 offset:0
    ds_read_b64_tr_b16 a[2:3], v132 offset:2048
    ds_read_b64_tr_b16 a[4:5], v132 offset:4096
    ds_read_b64_tr_b16 a[6:7], v132 offset:6144
    ds_read_b64_tr_b16 a[8:9], v133 offset:0
    ds_read_b64_tr_b16 a[10:11], v133 offset:2048
    ds_read_b64_tr_b16 a[12:13], v133 offset:4096
    ds_read_b64_tr_b16 a[14:15], v133 offset:6144
    ds_read_b64_tr_b16 a[16:17], v134 offset:0
    ds_read_b64_tr_b16 a[18:19], v134 offset:2048
    ds_read_b64_tr_b16 a[20:21], v134 offset:4096
    ds_read_b64_tr_b16 a[22:23], v134 offset:6144
    ds_read_b64_tr_b16 a[24:25], v135 offset:0
    ds_read_b64_tr_b16 a[26:27], v135 offset:2048
    ds_read_b64_tr_b16 a[28:29], v135 offset:4096
    ds_read_b64_tr_b16 a[30:31], v135 offset:6144
    v_mov_b32 v173, 0x3f803f80
    v_cmp_eq_u32 vcc, 0, v165
    s_nop 1
    v_cndmask_b32 v176, 0, v173, vcc
    v_cndmask_b32 v177, 0, v173, vcc
    v_cndmask_b32 v178, 0, v173, vcc
    v_cndmask_b32 v179, 0, v173, vcc
    v_cmp_eq_u32 vcc, 1, v165
    s_nop 1
    v_cndmask_b32 v180, 0, v173, vcc
    v_cndmask_b32 v181, 0, v173, vcc
    v_cndmask_b32 v182, 0, v173, vcc
    v_cndmask_b32 v183, 0, v173, vcc
    v_cmp_eq_u32 vcc, 2, v165
    s_nop 1
    v_cndmask_b32 v184, 0, v173, vcc
    v_cndmask_b32 v185, 0, v173, vcc
    v_cndmask_b32 v186, 0, v173, vcc
    v_cndmask_b32 v187, 0, v173, vcc
    v_cmp_eq_u32 vcc, 3, v165
    s_nop 1
    v_cndmask_b32 v188, 0, v173, vcc
    v_cndmask_b32 v189, 0, v173, vcc
    v_cndmask_b32 v190, 0, v173, vcc
    v_cndmask_b32 v191, 0, v173, vcc
    s_waitcnt lgkmcnt(0)
    v_mfma_f32_16x16x32_bf16 v[32:35], a[0:3], v[64:67], 0
    v_mfma_f32_16x16x32_bf16 v[36:39], a[0:3], v[72:75], 0
    v_mfma_f32_16x16x32_bf16 v[80:83], a[0:3], v[176:179], 0
    v_mfma_f32_16x16x32_bf16 v[32:35], a[4:7], v[68:71], v[32:35]
    v_mfma_f32_16x16x32_bf16 v[36:39], a[4:7], v[76:79], v[36:39]
    v_mfma_f32_16x16x32_bf16 v[80:83], a[4:7], v[176:179], v[80:83]
    v_mfma_f32_16x16x32_bf16 v[40:43], a[8:11], v[64:67], 0
    v_mfma_f32_16x16x32_bf16 v[44:47], a[8:11], v[72:75], 0
    v_mfma_f32_16x16x32_bf16 v[80:83], a[8:11], v[180:183], v[80:83]
    v_mfma_f32_16x16x32_bf16 v[40:43], a[12:15], v[68:71], v[40:43]
    v_mfma_f32_16x16x32_bf16 v[44:47], a[12:15], v[76:79], v[44:47]
    v_mfma_f32_16x16x32_bf16 v[80:83], a[12:15], v[180:183], v[80:83]
    v_mfma_f32_16x16x32_bf16 v[48:51], a[16:19], v[64:67], 0
    v_mfma_f32_16x16x32_bf16 v[52:55], a[16:19], v[72:75], 0
    v_mfma_f32_16x16x32_bf16 v[80:83], a[16:19], v[184:187], v[80:83]
    v_mfma_f32_16x16x32_bf16 v[48:51], a[20:23], v[68:71], v[48:51]
    v_mfma_f32_16x16x32_bf16 v[52:55], a[20:23], v[76:79], v[52:55]
    v_mfma_f32_16x16x32_bf16 v[80:83], a[20:23], v[184:187], v[80:83]
    v_mfma_f32_16x16x32_bf16 v[56:59], a[24:27], v[64:67], 0
    v_mfma_f32_16x16x32_bf16 v[60:63], a[24:27], v[72:75], 0
    v_mfma_f32_16x16x32_bf16 v[80:83], a[24:27], v[188:191], v[80:83]
    v_mfma_f32_16x16x32_bf16 v[56:59], a[28:31], v[68:71], v[56:59]
    v_mfma_f32_16x16x32_bf16 v[60:63], a[28:31], v[76:79], v[60:63]
    v_mfma_f32_16x16x32_bf16 v[80:83], a[28:31], v[188:191], v[80:83]
    v_cvt_pk_bf16_f32 v176, v96, v97
    v_cvt_pk_bf16_f32 v177, v98, v99
    v_cvt_pk_bf16_f32 v178, v112, v113
    v_cvt_pk_bf16_f32 v179, v114, v115
    v_cvt_pk_bf16_f32 v180, v100, v101
    v_cvt_pk_bf16_f32 v181, v102, v103
    v_cvt_pk_bf16_f32 v182, v116, v117
    v_cvt_pk_bf16_f32 v183, v118, v119
    v_cvt_pk_bf16_f32 v184, v104, v105
    v_cvt_pk_bf16_f32 v185, v106, v107
    v_cvt_pk_bf16_f32 v186, v120, v121
    v_cvt_pk_bf16_f32 v187, v122, v123
    v_cvt_pk_bf16_f32 v188, v108, v109
    v_cvt_pk_bf16_f32 v189, v110, v111
    v_cvt_pk_bf16_f32 v190, v124, v125
    v_cvt_pk_bf16_f32 v191, v126, v127
    v_mfma_f32_16x16x32_bf16 v[96:99], v[16:19], v[176:179], 0
    v_mfma_f32_16x16x32_bf16 v[112:115], v[20:23], v[176:179], 0
    v_mfma_f32_16x16x32_bf16 v[100:103], v[16:19], v[180:183], 0
    v_mfma_f32_16x16x32_bf16 v[116:119], v[20:23], v[180:183], 0
    v_mfma_f32_16x16x32_bf16 v[104:107], v[16:19], v[184:187], 0
    v_mfma_f32_16x16x32_bf16 v[120:123], v[20:23], v[184:187], 0
    v_mfma_f32_16x16x32_bf16 v[108:111], v[16:19], v[188:191], 0
    v_mfma_f32_16x16x32_bf16 v[124:127], v[20:23], v[188:191], 0
    ds_write_b128 v24, v[32:35] offset:0
    ds_write_b128 v24, v[36:39] offset:1024
    ds_write_b128 v24, v[40:43] offset:2048
    ds_write_b128 v24, v[44:47] offset:3072
    ds_write_b128 v24, v[48:51] offset:4096
    ds_write_b128 v24, v[52:55] offset:5120
    ds_write_b128 v24, v[56:59] offset:6144
    ds_write_b128 v24, v[60:63] offset:7168
    ds_write_b128 v26, v[80:83]
    s_add_u32 s3, s25, 112
    s_lshl_b32 s3, s3, 10
    s_add_u32 s63, s62, s3
    s_add_u32 s64, s63, 147456
    s_add_u32 s65, s63, 294912
    s_add_u32 s66, s63, 442368
    s_mov_b32 s67, 0x358637bd
    s_waitcnt lgkmcnt(0)
    s_barrier
    ds_read_b128 v[32:35], v25 offset:0
    ds_read_b128 v[36:39], v25 offset:1024
    ds_read_b128 v[64:67], v31 offset:0
    ds_read_b128 v[40:43], v25 offset:8192
    ds_read_b128 v[44:47], v25 offset:9216
    ds_read_b128 v[68:71], v31 offset:1024
    ds_read_b128 v[48:51], v25 offset:16384
    ds_read_b128 v[52:55], v25 offset:17408
    ds_read_b128 v[72:75], v31 offset:2048
    ds_read_b128 v[56:59], v25 offset:24576
    ds_read_b128 v[60:63], v25 offset:25600
    ds_read_b128 v[76:79], v31 offset:3072
    v_max3_f32 v160, v96, v97, v98
    v_min3_f32 v168, v96, v97, v98
    v_max3_f32 v160, v160, v99, v112
    v_min3_f32 v168, v168, v99, v112
    v_max3_f32 v160, v160, v113, v114
    v_min3_f32 v168, v168, v113, v114
    v_max_f32 v160, v160, v115
    v_min_f32 v168, v168, v115
    v_max3_f32 v162, v100, v101, v102
    v_min3_f32 v170, v100, v101, v102
    v_max3_f32 v162, v162, v103, v116
    v_min3_f32 v170, v170, v103, v116
    v_max3_f32 v162, v162, v117, v118
    v_min3_f32 v170, v170, v117, v118
    v_max_f32 v162, v162, v119
    v_min_f32 v170, v170, v119
    v_max3_f32 v164, v104, v105, v106
    v_min3_f32 v172, v104, v105, v106
    v_max3_f32 v164, v164, v107, v120
    v_min3_f32 v172, v172, v107, v120
    v_max3_f32 v164, v164, v121, v122
    v_min3_f32 v172, v172, v121, v122
    v_max_f32 v164, v164, v123
    v_min_f32 v172, v172, v123
    v_max3_f32 v166, v108, v109, v110
    v_min3_f32 v174, v108, v109, v110
    v_max3_f32 v166, v166, v111, v124
    v_min3_f32 v174, v174, v111, v124
    v_max3_f32 v166, v166, v125, v126
    v_min3_f32 v174, v174, v125, v126
    v_max_f32 v166, v166, v127
    v_min_f32 v174, v174, v127
    v_permlane32_swap_b32 v160, v162
    v_permlane32_swap_b32 v168, v170
    v_permlane32_swap_b32 v164, v166
    v_permlane32_swap_b32 v172, v174
    v_max_f32 v160, v160, v162
    v_min_f32 v168, v168, v170
    v_max_f32 v164, v164, v166
    v_min_f32 v172, v172, v174
    s_nop 0
    v_permlane16_swap_b32 v160, v164
    v_permlane16_swap_b32 v168, v172
    v_max_f32 v160, v160, v164
    v_min_f32 v168, v168, v172
    v_mov_b32 v164, v160
    v_mov_b32 v172, v168
    s_nop 0
    v_permlane16_swap_b32 v160, v164
    v_permlane16_swap_b32 v168, v172
    v_mov_b32 v162, v160
    v_mov_b32 v170, v168
    v_mov_b32 v166, v164
    v_mov_b32 v174, v172
    v_permlane32_swap_b32 v160, v162
    v_permlane32_swap_b32 v168, v170
    v_permlane32_swap_b32 v164, v166
    v_permlane32_swap_b32 v172, v174
    v_mul_f32 v160, s38, v160
    v_mul_f32 v162, s38, v162
    v_mul_f32 v164, s38, v164
    v_mul_f32 v166, s38, v166
    v_mul_f32 v168, s38, v168
    v_mul_f32 v170, s38, v170
    v_mul_f32 v172, s38, v172
    v_mul_f32 v174, s38, v174
    s_waitcnt lgkmcnt(0)
    v_pk_add_f32 v[32:33], v[32:33], v[40:41]
    v_pk_add_f32 v[34:35], v[34:35], v[42:43]
    v_pk_add_f32 v[36:37], v[36:37], v[44:45]
    v_pk_add_f32 v[38:39], v[38:39], v[46:47]
    v_pk_add_f32 v[64:65], v[64:65], v[68:69]
    v_pk_add_f32 v[66:67], v[66:67], v[70:71]
    v_pk_add_f32 v[32:33], v[32:33], v[48:49]
    v_pk_add_f32 v[34:35], v[34:35], v[50:51]
    v_pk_add_f32 v[36:37], v[36:37], v[52:53]
    v_pk_add_f32 v[38:39], v[38:39], v[54:55]
    v_pk_add_f32 v[64:65], v[64:65], v[72:73]
    v_pk_add_f32 v[66:67], v[66:67], v[74:75]
    v_pk_add_f32 v[32:33], v[32:33], v[56:57]
    v_pk_add_f32 v[34:35], v[34:35], v[58:59]
    v_pk_add_f32 v[36:37], v[36:37], v[60:61]
    v_pk_add_f32 v[38:39], v[38:39], v[62:63]
    v_pk_add_f32 v[64:65], v[64:65], v[76:77]
    v_pk_add_f32 v[66:67], v[66:67], v[78:79]
    buffer_store_dwordx4 v[64:67], v27, s[20:23], s7 offen sc1
    buffer_store_dwordx4 v[32:35], v28, s[20:23], s7 offen sc1
    buffer_store_dwordx4 v[36:39], v28, s[20:23], s7 offen offset:1024 sc1
    s_mov_b32 s72, s42
    s_mov_b32 s73, s43
    s_mov_b32 s74, 2048
    s_mov_b32 s75, 0x20000
    v_and_b32 v169, 31, v1
    v_lshlrev_b32 v169, 4, v169
    v_lshrrev_b32 v0, 5, v1
    s_lshl_b32 s3, s45, 4
    v_add_u32 v0, s3, v0
    s_lshl_b32 s3, s25, 1
    v_add_u32 v0, s3, v0
    v_lshl_add_u32 v171, v0, 11, v169
    buffer_load_dwordx4 v[48:51], v171, s[68:71], 0 offen offset:0
    buffer_load_dwordx4 v[80:83], v169, s[72:75], 0 offen offset:0
    buffer_load_dwordx4 v[52:55], v171, s[68:71], 0 offen offset:512
    buffer_load_dwordx4 v[84:87], v169, s[72:75], 0 offen offset:512
    buffer_load_dwordx4 v[56:59], v171, s[68:71], 0 offen offset:1024
    buffer_load_dwordx4 v[88:91], v169, s[72:75], 0 offen offset:1024
    buffer_load_dwordx4 v[60:63], v171, s[68:71], 0 offen offset:1536
    buffer_load_dwordx4 v[92:95], v169, s[72:75], 0 offen offset:1536
    v_pk_fma_f32 v[176:177], v[96:97], s[38:39], v[168:169] op_sel_hi:[1,1,0] neg_lo:[1,0,0] neg_hi:[1,0,0]
    v_pk_fma_f32 v[96:97], v[96:97], s[38:39], v[160:161] op_sel_hi:[1,1,0] neg_lo:[0,0,1] neg_hi:[0,0,1]
    v_pk_fma_f32 v[178:179], v[98:99], s[38:39], v[168:169] op_sel_hi:[1,1,0] neg_lo:[1,0,0] neg_hi:[1,0,0]
    v_pk_fma_f32 v[98:99], v[98:99], s[38:39], v[160:161] op_sel_hi:[1,1,0] neg_lo:[0,0,1] neg_hi:[0,0,1]
    v_pk_fma_f32 v[180:181], v[112:113], s[38:39], v[168:169] op_sel_hi:[1,1,0] neg_lo:[1,0,0] neg_hi:[1,0,0]
    v_pk_fma_f32 v[112:113], v[112:113], s[38:39], v[160:161] op_sel_hi:[1,1,0] neg_lo:[0,0,1] neg_hi:[0,0,1]
    v_pk_fma_f32 v[182:183], v[114:115], s[38:39], v[168:169] op_sel_hi:[1,1,0] neg_lo:[1,0,0] neg_hi:[1,0,0]
    v_pk_fma_f32 v[114:115], v[114:115], s[38:39], v[160:161] op_sel_hi:[1,1,0] neg_lo:[0,0,1] neg_hi:[0,0,1]
    v_exp_f32 v96, v96
    v_exp_f32 v176, v176
    v_exp_f32 v97, v97
    v_exp_f32 v177, v177
    v_exp_f32 v98, v98
    v_exp_f32 v178, v178
    v_exp_f32 v99, v99
    v_exp_f32 v179, v179
    v_exp_f32 v112, v112
    v_exp_f32 v180, v180
    v_exp_f32 v113, v113
    v_exp_f32 v181, v181
    v_exp_f32 v114, v114
    v_exp_f32 v182, v182
    v_exp_f32 v115, v115
    v_exp_f32 v183, v183
    v_pk_fma_f32 v[184:185], v[100:101], s[38:39], v[170:171] op_sel_hi:[1,1,0] neg_lo:[1,0,0] neg_hi:[1,0,0]
    v_pk_fma_f32 v[100:101], v[100:101], s[38:39], v[162:163] op_sel_hi:[1,1,0] neg_lo:[0,0,1] neg_hi:[0,0,1]
    v_pk_fma_f32 v[186:187], v[102:103], s[38:39], v[170:171] op_sel_hi:[1,1,0] neg_lo:[1,0,0] neg_hi:[1,0,0]
    v_pk_fma_f32 v[102:103], v[102:103], s[38:39], v[162:163] op_sel_hi:[1,1,0] neg_lo:[0,0,1] neg_hi:[0,0,1]
    v_pk_fma_f32 v[188:189], v[116:117], s[38:39], v[170:171] op_sel_hi:[1,1,0] neg_lo:[1,0,0] neg_hi:[1,0,0]
    v_pk_fma_f32 v[116:117], v[116:117], s[38:39], v[162:163] op_sel_hi:[1,1,0] neg_lo:[0,0,1] neg_hi:[0,0,1]
    v_pk_fma_f32 v[190:191], v[118:119], s[38:39], v[170:171] op_sel_hi:[1,1,0] neg_lo:[1,0,0] neg_hi:[1,0,0]
    v_pk_fma_f32 v[118:119], v[118:119], s[38:39], v[162:163] op_sel_hi:[1,1,0] neg_lo:[0,0,1] neg_hi:[0,0,1]
    v_exp_f32 v100, v100
    v_exp_f32 v184, v184
    v_exp_f32 v101, v101
    v_exp_f32 v185, v185
    v_exp_f32 v102, v102
    v_exp_f32 v186, v186
    v_exp_f32 v103, v103
    v_exp_f32 v187, v187
    v_exp_f32 v116, v116
    v_exp_f32 v188, v188
    v_exp_f32 v117, v117
    v_exp_f32 v189, v189
    v_exp_f32 v118, v118
    v_exp_f32 v190, v190
    v_exp_f32 v119, v119
    v_exp_f32 v191, v191
    v_cvt_pk_bf16_f32 v128, v96, v97
    v_cvt_pk_bf16_f32 v129, v98, v99
    v_cvt_pk_bf16_f32 v132, v176, v177
    v_cvt_pk_bf16_f32 v133, v178, v179
    v_cvt_pk_bf16_f32 v130, v112, v113
    v_cvt_pk_bf16_f32 v131, v114, v115
    v_cvt_pk_bf16_f32 v134, v180, v181
    v_cvt_pk_bf16_f32 v135, v182, v183
    v_cvt_pk_bf16_f32 v136, v100, v101
    v_cvt_pk_bf16_f32 v137, v102, v103
    v_cvt_pk_bf16_f32 v140, v184, v185
    v_cvt_pk_bf16_f32 v141, v186, v187
    v_cvt_pk_bf16_f32 v138, v116, v117
    v_cvt_pk_bf16_f32 v139, v118, v119
    v_cvt_pk_bf16_f32 v142, v188, v189
    v_cvt_pk_bf16_f32 v143, v190, v191
    v_pk_fma_f32 v[176:177], v[104:105], s[38:39], v[172:173] op_sel_hi:[1,1,0] neg_lo:[1,0,0] neg_hi:[1,0,0]
    v_pk_fma_f32 v[104:105], v[104:105], s[38:39], v[164:165] op_sel_hi:[1,1,0] neg_lo:[0,0,1] neg_hi:[0,0,1]
    v_pk_fma_f32 v[178:179], v[106:107], s[38:39], v[172:173] op_sel_hi:[1,1,0] neg_lo:[1,0,0] neg_hi:[1,0,0]
    v_pk_fma_f32 v[106:107], v[106:107], s[38:39], v[164:165] op_sel_hi:[1,1,0] neg_lo:[0,0,1] neg_hi:[0,0,1]
    v_pk_fma_f32 v[180:181], v[120:121], s[38:39], v[172:173] op_sel_hi:[1,1,0] neg_lo:[1,0,0] neg_hi:[1,0,0]
    v_pk_fma_f32 v[120:121], v[120:121], s[38:39], v[164:165] op_sel_hi:[1,1,0] neg_lo:[0,0,1] neg_hi:[0,0,1]
    v_pk_fma_f32 v[182:183], v[122:123], s[38:39], v[172:173] op_sel_hi:[1,1,0] neg_lo:[1,0,0] neg_hi:[1,0,0]
    v_pk_fma_f32 v[122:123], v[122:123], s[38:39], v[164:165] op_sel_hi:[1,1,0] neg_lo:[0,0,1] neg_hi:[0,0,1]
    v_exp_f32 v104, v104
    v_exp_f32 v176, v176
    v_exp_f32 v105, v105
    v_exp_f32 v177, v177
    v_exp_f32 v106, v106
    v_exp_f32 v178, v178
    v_exp_f32 v107, v107
    v_exp_f32 v179, v179
    v_exp_f32 v120, v120
    v_exp_f32 v180, v180
    v_exp_f32 v121, v121
    v_exp_f32 v181, v181
    v_exp_f32 v122, v122
    v_exp_f32 v182, v182
    v_exp_f32 v123, v123
    v_exp_f32 v183, v183
    v_pk_fma_f32 v[184:185], v[108:109], s[38:39], v[174:175] op_sel_hi:[1,1,0] neg_lo:[1,0,0] neg_hi:[1,0,0]
    v_pk_fma_f32 v[108:109], v[108:109], s[38:39], v[166:167] op_sel_hi:[1,1,0] neg_lo:[0,0,1] neg_hi:[0,0,1]
    v_pk_fma_f32 v[186:187], v[110:111], s[38:39], v[174:175] op_sel_hi:[1,1,0] neg_lo:[1,0,0] neg_hi:[1,0,0]
    v_pk_fma_f32 v[110:111], v[110:111], s[38:39], v[166:167] op_sel_hi:[1,1,0] neg_lo:[0,0,1] neg_hi:[0,0,1]
    v_pk_fma_f32 v[188:189], v[124:125], s[38:39], v[174:175] op_sel_hi:[1,1,0] neg_lo:[1,0,0] neg_hi:[1,0,0]
    v_pk_fma_f32 v[124:125], v[124:125], s[38:39], v[166:167] op_sel_hi:[1,1,0] neg_lo:[0,0,1] neg_hi:[0,0,1]
    v_pk_fma_f32 v[190:191], v[126:127], s[38:39], v[174:175] op_sel_hi:[1,1,0] neg_lo:[1,0,0] neg_hi:[1,0,0]
    v_pk_fma_f32 v[126:127], v[126:127], s[38:39], v[166:167] op_sel_hi:[1,1,0] neg_lo:[0,0,1] neg_hi:[0,0,1]
    v_exp_f32 v108, v108
    v_exp_f32 v184, v184
    v_exp_f32 v109, v109
    v_exp_f32 v185, v185
    v_exp_f32 v110, v110
    v_exp_f32 v186, v186
    v_exp_f32 v111, v111
    v_exp_f32 v187, v187
    v_exp_f32 v124, v124
    v_exp_f32 v188, v188
    v_exp_f32 v125, v125
    v_exp_f32 v189, v189
    v_exp_f32 v126, v126
    v_exp_f32 v190, v190
    v_exp_f32 v127, v127
    v_exp_f32 v191, v191
    v_cvt_pk_bf16_f32 v144, v104, v105
    v_cvt_pk_bf16_f32 v145, v106, v107
    v_cvt_pk_bf16_f32 v148, v176, v177
    v_cvt_pk_bf16_f32 v149, v178, v179
    v_cvt_pk_bf16_f32 v146, v120, v121
    v_cvt_pk_bf16_f32 v147, v122, v123
    v_cvt_pk_bf16_f32 v150, v180, v181
    v_cvt_pk_bf16_f32 v151, v182, v183
    v_cvt_pk_bf16_f32 v152, v108, v109
    v_cvt_pk_bf16_f32 v153, v110, v111
    v_cvt_pk_bf16_f32 v156, v184, v185
    v_cvt_pk_bf16_f32 v157, v186, v187
    v_cvt_pk_bf16_f32 v154, v124, v125
    v_cvt_pk_bf16_f32 v155, v126, v127
    v_cvt_pk_bf16_f32 v158, v188, v189
    v_cvt_pk_bf16_f32 v159, v190, v191
    s_waitcnt vmcnt(8)
    v_mov_b32 v12, s45
    v_mov_b32 v13, 1
    s_mov_b64 exec, 1
    buffer_store_dword v13, v12, s[20:23], s44 offen sc1
    s_mov_b64 exec, -1
    s_waitcnt vmcnt(1)
    v_mov_b32 v96, 0
    v_mov_b32 v97, 0
    v_dot2c_f32_bf16 v96, v48, v80
    v_dot2c_f32_bf16 v97, v49, v81
    v_dot2c_f32_bf16 v96, v50, v82
    v_dot2c_f32_bf16 v97, v51, v83
    v_dot2c_f32_bf16 v96, v52, v84
    v_dot2c_f32_bf16 v97, v53, v85
    v_dot2c_f32_bf16 v96, v54, v86
    v_dot2c_f32_bf16 v97, v55, v87
    v_dot2c_f32_bf16 v96, v56, v88
    v_dot2c_f32_bf16 v97, v57, v89
    v_dot2c_f32_bf16 v96, v58, v90
    v_dot2c_f32_bf16 v97, v59, v91
    v_dot2c_f32_bf16 v96, v60, v92
    v_dot2c_f32_bf16 v97, v61, v93
    v_dot2c_f32_bf16 v96, v62, v94
    v_dot2c_f32_bf16 v97, v63, v95
    v_lshlrev_b32 v0, 2, v0
    v_add_u32 v0, 21692416, v0
    s_nop 1
    v_add_f32 v96, v96, v97
    s_nop 1
    v_add_f32_dpp v96, v96, v96 row_ror:8 row_mask:0xf bank_mask:0xf
    s_nop 1
    v_add_f32_dpp v96, v96, v96 row_ror:4 row_mask:0xf bank_mask:0xf
    s_nop 1
    v_add_f32_dpp v96, v96, v96 row_ror:2 row_mask:0xf bank_mask:0xf
    s_nop 1
    v_add_f32_dpp v96, v96, v96 row_ror:1 row_mask:0xf bank_mask:0xf
    v_mov_b32 v97, v96
    s_nop 1
    v_permlane16_swap_b32 v96, v97
    v_add_f32 v96, v96, v97
    v_mul_f32 v96, s38, v96
    v_exp_f32 v96, -v96
    s_nop 0
    v_add_f32 v96, 1.0, v96
    v_rcp_f32 v169, v96
    s_nop 0
    buffer_store_dword v169, v0, s[20:23], 0 offen sc1
    s_setprio 2
    s_barrier
    s_waitcnt lgkmcnt(0)
    s_barrier
    s_mov_b32 m0, s32
    s_nop 0
    buffer_load_dwordx4 v2, s[8:11], s28 offen offset:0 sc1 lds
    buffer_load_dwordx4 v2, s[8:11], s28 offen offset:1024 sc1 lds
    buffer_load_dwordx4 v3, s[8:11], s28 offen offset:2048 sc1 lds
    buffer_load_dwordx4 v3, s[8:11], s28 offen offset:3072 sc1 lds
    s_mov_b32 m0, s33
    s_nop 0
    buffer_load_dwordx4 v5, s[12:15], s29 offen offset:0 lds
    buffer_load_dwordx4 v6, s[12:15], s29 offen offset:1024 lds
    buffer_load_dwordx4 v7, s[12:15], s29 offen offset:2048 lds
    buffer_load_dwordx4 v8, s[12:15], s29 offen offset:3072 lds
    s_add_u32 s28, s28, 2048
    s_add_u32 s29, s29, 131072
    s_add_u32 s30, s30, 1
    s_cmp_eq_u32 s30, s31
    s_cselect_b32 s12, s16, s12
    s_cselect_b32 s13, s17, s13
    s_cselect_b32 s14, s18, s14
    s_cselect_b32 s29, s34, s29
    s_cselect_b32 s28, s36, s28
    s_waitcnt lgkmcnt(0)
    s_barrier
    s_add_u32 m0, s32, 16384
    s_nop 0
    buffer_load_dwordx4 v2, s[8:11], s28 offen offset:0 sc1 lds
    buffer_load_dwordx4 v2, s[8:11], s28 offen offset:1024 sc1 lds
    buffer_load_dwordx4 v3, s[8:11], s28 offen offset:2048 sc1 lds
    buffer_load_dwordx4 v3, s[8:11], s28 offen offset:3072 sc1 lds
    s_add_u32 m0, s33, 16384
    s_nop 0
    buffer_load_dwordx4 v5, s[12:15], s29 offen offset:0 lds
    buffer_load_dwordx4 v6, s[12:15], s29 offen offset:1024 lds
    buffer_load_dwordx4 v7, s[12:15], s29 offen offset:2048 lds
    buffer_load_dwordx4 v8, s[12:15], s29 offen offset:3072 lds
    s_add_u32 s28, s28, 2048
    s_add_u32 s29, s29, 131072
    s_add_u32 s30, s30, 1
    s_cmp_eq_u32 s30, s31
    s_cselect_b32 s12, s16, s12
    s_cselect_b32 s13, s17, s13
    s_cselect_b32 s14, s18, s14
    s_cselect_b32 s29, s34, s29
    s_cselect_b32 s28, s36, s28
    s_waitcnt lgkmcnt(0)
    s_barrier
    s_add_u32 m0, s32, 32768
    s_nop 0
    buffer_load_dwordx4 v2, s[8:11], s28 offen offset:0 sc1 lds
    buffer_load_dwordx4 v2, s[8:11], s28 offen offset:1024 sc1 lds
    buffer_load_dwordx4 v3, s[8:11], s28 offen offset:2048 sc1 lds
    buffer_load_dwordx4 v3, s[8:11], s28 offen offset:3072 sc1 lds
    s_add_u32 m0, s33, 32768
    s_nop 0
    buffer_load_dwordx4 v5, s[12:15], s29 offen offset:0 lds
    buffer_load_dwordx4 v6, s[12:15], s29 offen offset:1024 lds
    buffer_load_dwordx4 v7, s[12:15], s29 offen offset:2048 lds
    buffer_load_dwordx4 v8, s[12:15], s29 offen offset:3072 lds
    s_add_u32 s28, s28, 2048
    s_add_u32 s29, s29, 131072
    s_add_u32 s30, s30, 1
    s_cmp_eq_u32 s30, s31
    s_cselect_b32 s12, s16, s12
    s_cselect_b32 s13, s17, s13
    s_cselect_b32 s14, s18, s14
    s_cselect_b32 s29, s34, s29
    s_cselect_b32 s28, s36, s28
    s_waitcnt lgkmcnt(0) vmcnt(16)
    s_barrier
    s_add_u32 m0, s32, 49152
    s_nop 0
    buffer_load_dwordx4 v2, s[8:11], s28 offen offset:0 sc1 lds
    buffer_load_dwordx4 v2, s[8:11], s28 offen offset:1024 sc1 lds
    buffer_load_dwordx4 v3, s[8:11], s28 offen offset:2048 sc1 lds
    buffer_load_dwordx4 v3, s[8:11], s28 offen offset:3072 sc1 lds
    s_add_u32 m0, s33, 49152
    s_nop 0
    buffer_load_dwordx4 v5, s[12:15], s29 offen offset:0 lds
    buffer_load_dwordx4 v6, s[12:15], s29 offen offset:1024 lds
    buffer_load_dwordx4 v7, s[12:15], s29 offen offset:2048 lds
    buffer_load_dwordx4 v8, s[12:15], s29 offen offset:3072 lds
    s_add_u32 s28, s28, 2048
    s_add_u32 s29, s29, 131072
    s_add_u32 s30, s30, 1
    s_cmp_eq_u32 s30, s31
    s_cselect_b32 s12, s16, s12
    s_cselect_b32 s13, s17, s13
    s_cselect_b32 s14, s18, s14
    s_cselect_b32 s29, s34, s29
    s_cselect_b32 s28, s36, s28
    buffer_load_dwordx4 v[32:35], v29, s[20:23], s6 offen sc1
    buffer_load_dwordx4 v[36:39], v29, s[20:23], s6 offen offset:2048 sc1
    buffer_load_dwordx4 v[40:43], v27, s[20:23], s6 offen sc1
    s_add_u32 s6, s6, 9216
    buffer_load_dwordx4 v[44:47], v29, s[20:23], s6 offen sc1
    buffer_load_dwordx4 v[48:51], v29, s[20:23], s6 offen offset:2048 sc1
    buffer_load_dwordx4 v[52:55], v27, s[20:23], s6 offen sc1
    s_add_u32 s6, s6, 9216
    buffer_load_dwordx4 v[56:59], v29, s[20:23], s6 offen sc1
    buffer_load_dwordx4 v[60:63], v29, s[20:23], s6 offen offset:2048 sc1
    buffer_load_dwordx4 v[64:67], v27, s[20:23], s6 offen sc1
    s_add_u32 s6, s6, 9216
    buffer_load_dwordx4 v[68:71], v29, s[20:23], s6 offen sc1
    buffer_load_dwordx4 v[72:75], v29, s[20:23], s6 offen offset:2048 sc1
    buffer_load_dwordx4 v[76:79], v27, s[20:23], s6 offen sc1
    s_add_u32 s6, s6, 9216
    buffer_load_dwordx4 v[80:83], v29, s[20:23], s6 offen sc1
    buffer_load_dwordx4 v[84:87], v29, s[20:23], s6 offen offset:2048 sc1
    buffer_load_dwordx4 v[88:91], v27, s[20:23], s6 offen sc1
    s_add_u32 s6, s6, 9216
    buffer_load_dwordx4 v[92:95], v29, s[20:23], s6 offen sc1
    buffer_load_dwordx4 v[96:99], v29, s[20:23], s6 offen offset:2048 sc1
    buffer_load_dwordx4 v[100:103], v27, s[20:23], s6 offen sc1
    s_add_u32 s6, s6, 9216
    buffer_load_dwordx4 v[104:107], v29, s[20:23], s6 offen sc1
    buffer_load_dwordx4 v[108:111], v29, s[20:23], s6 offen offset:2048 sc1
    buffer_load_dwordx4 v[112:115], v27, s[20:23], s6 offen sc1
    s_add_u32 s6, s6, 9216
    buffer_load_dwordx4 v[116:119], v29, s[20:23], s6 offen sc1
    buffer_load_dwordx4 v[120:123], v29, s[20:23], s6 offen offset:2048 sc1
    buffer_load_dwordx4 v[124:127], v27, s[20:23], s6 offen sc1
    s_add_u32 s6, s6, 9216
    s_waitcnt lgkmcnt(0) vmcnt(40)
    s_barrier
    s_mov_b32 m0, s32
    s_nop 0
    buffer_load_dwordx4 v2, s[8:11], s28 offen offset:0 sc1 lds
    buffer_load_dwordx4 v2, s[8:11], s28 offen offset:1024 sc1 lds
    buffer_load_dwordx4 v3, s[8:11], s28 offen offset:2048 sc1 lds
    buffer_load_dwordx4 v3, s[8:11], s28 offen offset:3072 sc1 lds
    s_mov_b32 m0, s33
    s_nop 0
    buffer_load_dwordx4 v5, s[12:15], s29 offen offset:0 lds
    buffer_load_dwordx4 v6, s[12:15], s29 offen offset:1024 lds
    buffer_load_dwordx4 v7, s[12:15], s29 offen offset:2048 lds
    buffer_load_dwordx4 v8, s[12:15], s29 offen offset:3072 lds
    s_add_u32 s28, s28, 2048
    s_add_u32 s29, s29, 131072
    s_add_u32 s30, s30, 1
    s_cmp_eq_u32 s30, s31
    s_cselect_b32 s12, s16, s12
    s_cselect_b32 s13, s17, s13
    s_cselect_b32 s14, s18, s14
    s_cselect_b32 s29, s34, s29
    s_cselect_b32 s28, s36, s28
    s_waitcnt lgkmcnt(0) vmcnt(40)
    s_barrier
    s_add_u32 m0, s32, 16384
    s_nop 0
    buffer_load_dwordx4 v2, s[8:11], s28 offen offset:0 sc1 lds
    buffer_load_dwordx4 v2, s[8:11], s28 offen offset:1024 sc1 lds
    buffer_load_dwordx4 v3, s[8:11], s28 offen offset:2048 sc1 lds
    buffer_load_dwordx4 v3, s[8:11], s28 offen offset:3072 sc1 lds
    s_add_u32 m0, s33, 16384
    s_nop 0
    buffer_load_dwordx4 v5, s[12:15], s29 offen offset:0 lds
    buffer_load_dwordx4 v6, s[12:15], s29 offen offset:1024 lds
    buffer_load_dwordx4 v7, s[12:15], s29 offen offset:2048 lds
    buffer_load_dwordx4 v8, s[12:15], s29 offen offset:3072 lds
    s_add_u32 s28, s28, 2048
    s_add_u32 s29, s29, 131072
    s_add_u32 s30, s30, 1
    s_cmp_eq_u32 s30, s31
    s_cselect_b32 s12, s16, s12
    s_cselect_b32 s13, s17, s13
    s_cselect_b32 s14, s18, s14
    s_cselect_b32 s29, s34, s29
    s_cselect_b32 s28, s36, s28
    s_waitcnt lgkmcnt(0) vmcnt(16)
    s_barrier
    s_add_u32 m0, s32, 32768
    s_nop 0
    buffer_load_dwordx4 v2, s[8:11], s28 offen offset:0 sc1 lds
    v_pk_add_f32 v[32:33], v[32:33], v[44:45]
    v_pk_add_f32 v[34:35], v[34:35], v[46:47]
    v_pk_add_f32 v[36:37], v[36:37], v[48:49]
    v_pk_add_f32 v[38:39], v[38:39], v[50:51]
    v_pk_add_f32 v[40:41], v[40:41], v[52:53]
    v_pk_add_f32 v[42:43], v[42:43], v[54:55]
    v_pk_add_f32 v[32:33], v[32:33], v[56:57]
    v_pk_add_f32 v[34:35], v[34:35], v[58:59]
    buffer_load_dwordx4 v2, s[8:11], s28 offen offset:1024 sc1 lds
    v_pk_add_f32 v[36:37], v[36:37], v[60:61]
    v_pk_add_f32 v[38:39], v[38:39], v[62:63]
    v_pk_add_f32 v[40:41], v[40:41], v[64:65]
    v_pk_add_f32 v[42:43], v[42:43], v[66:67]
    v_pk_add_f32 v[32:33], v[32:33], v[68:69]
    v_pk_add_f32 v[34:35], v[34:35], v[70:71]
    v_pk_add_f32 v[36:37], v[36:37], v[72:73]
    v_pk_add_f32 v[38:39], v[38:39], v[74:75]
    buffer_load_dwordx4 v3, s[8:11], s28 offen offset:2048 sc1 lds
    v_pk_add_f32 v[40:41], v[40:41], v[76:77]
    v_pk_add_f32 v[42:43], v[42:43], v[78:79]
    v_pk_add_f32 v[32:33], v[32:33], v[80:81]
    v_pk_add_f32 v[34:35], v[34:35], v[82:83]
    v_pk_add_f32 v[36:37], v[36:37], v[84:85]
    v_pk_add_f32 v[38:39], v[38:39], v[86:87]
    v_pk_add_f32 v[40:41], v[40:41], v[88:89]
    v_pk_add_f32 v[42:43], v[42:43], v[90:91]
    buffer_load_dwordx4 v3, s[8:11], s28 offen offset:3072 sc1 lds
    v_pk_add_f32 v[32:33], v[32:33], v[92:93]
    v_pk_add_f32 v[34:35], v[34:35], v[94:95]
    v_pk_add_f32 v[36:37], v[36:37], v[96:97]
    v_pk_add_f32 v[38:39], v[38:39], v[98:99]
    v_pk_add_f32 v[40:41], v[40:41], v[100:101]
    v_pk_add_f32 v[42:43], v[42:43], v[102:103]
    v_pk_add_f32 v[32:33], v[32:33], v[104:105]
    v_pk_add_f32 v[34:35], v[34:35], v[106:107]
    s_add_u32 m0, s33, 32768
    s_nop 0
    buffer_load_dwordx4 v5, s[12:15], s29 offen offset:0 lds
    v_pk_add_f32 v[36:37], v[36:37], v[108:109]
    v_pk_add_f32 v[38:39], v[38:39], v[110:111]
    v_pk_add_f32 v[40:41], v[40:41], v[112:113]
    v_pk_add_f32 v[42:43], v[42:43], v[114:115]
    v_pk_add_f32 v[32:33], v[32:33], v[116:117]
    v_pk_add_f32 v[34:35], v[34:35], v[118:119]
    v_pk_add_f32 v[36:37], v[36:37], v[120:121]
    v_pk_add_f32 v[38:39], v[38:39], v[122:123]
    buffer_load_dwordx4 v6, s[12:15], s29 offen offset:1024 lds
    v_pk_add_f32 v[40:41], v[40:41], v[124:125]
    v_pk_add_f32 v[42:43], v[42:43], v[126:127]
    v_cvt_pk_bf16_f32 v44, v32, v33
    v_cvt_pk_bf16_f32 v45, v34, v35
    v_cvt_pk_bf16_f32 v46, v36, v37
    v_cvt_pk_bf16_f32 v47, v38, v39
    s_lshl_b32 s3, s26, 10
    v_add_u32 v25, 131072, v9
    v_add_u32 v24, s3, v25
    buffer_load_dwordx4 v7, s[12:15], s29 offen offset:2048 lds
    ds_write_b128 v24, v[44:47]
    v_mov_b32_dpp v48, v40 quad_perm:[0,0,0,0] row_mask:0xf bank_mask:0xf
    v_mov_b32_dpp v49, v41 quad_perm:[0,0,0,0] row_mask:0xf bank_mask:0xf
    v_mov_b32_dpp v50, v42 quad_perm:[0,0,0,0] row_mask:0xf bank_mask:0xf
    v_mov_b32_dpp v51, v43 quad_perm:[0,0,0,0] row_mask:0xf bank_mask:0xf
    v_mov_b32_dpp v52, v40 quad_perm:[1,1,1,1] row_mask:0xf bank_mask:0xf
    v_mov_b32_dpp v53, v41 quad_perm:[1,1,1,1] row_mask:0xf bank_mask:0xf
    v_mov_b32_dpp v54, v42 quad_perm:[1,1,1,1] row_mask:0xf bank_mask:0xf
    buffer_load_dwordx4 v8, s[12:15], s29 offen offset:3072 lds
    v_mov_b32_dpp v55, v43 quad_perm:[1,1,1,1] row_mask:0xf bank_mask:0xf
    v_mov_b32_dpp v56, v40 quad_perm:[2,2,2,2] row_mask:0xf bank_mask:0xf
    v_mov_b32_dpp v57, v41 quad_perm:[2,2,2,2] row_mask:0xf bank_mask:0xf
    v_mov_b32_dpp v58, v42 quad_perm:[2,2,2,2] row_mask:0xf bank_mask:0xf
    v_mov_b32_dpp v59, v43 quad_perm:[2,2,2,2] row_mask:0xf bank_mask:0xf
    v_mov_b32_dpp v60, v40 quad_perm:[3,3,3,3] row_mask:0xf bank_mask:0xf
    v_mov_b32_dpp v61, v41 quad_perm:[3,3,3,3] row_mask:0xf bank_mask:0xf
    v_mov_b32_dpp v62, v42 quad_perm:[3,3,3,3] row_mask:0xf bank_mask:0xf
    s_add_u32 s28, s28, 2048
    s_add_u32 s29, s29, 131072
    s_add_u32 s30, s30, 1
    s_cmp_eq_u32 s30, s31
    s_cselect_b32 s12, s16, s12
    s_cselect_b32 s13, s17, s13
    s_cselect_b32 s14, s18, s14
    s_cselect_b32 s29, s34, s29
    s_cselect_b32 s28, s36, s28
    v_mov_b32_dpp v63, v43 quad_perm:[3,3,3,3] row_mask:0xf bank_mask:0xf
    v_cvt_pk_bf16_f32 v80, v48, v49
    v_cvt_pk_bf16_f32 v81, v50, v51
    v_cvt_pk_bf16_f32 v82, v52, v53
    v_cvt_pk_bf16_f32 v83, v54, v55
    v_cvt_pk_bf16_f32 v84, v56, v57
    v_cvt_pk_bf16_f32 v85, v58, v59
    v_cvt_pk_bf16_f32 v86, v60, v61
    s_waitcnt lgkmcnt(0) vmcnt(16)
    s_barrier
    s_add_u32 m0, s32, 49152
    s_nop 0
    buffer_load_dwordx4 v2, s[8:11], s28 offen offset:0 sc1 lds
    v_cvt_pk_bf16_f32 v87, v62, v63
    v_and_b32 v48, 3, v1
    v_mov_b32 v49, 0x3f803f80
    v_cmp_eq_u32 vcc, 1, v48
    s_nop 1
    v_cndmask_b32 v49, 0, v49, vcc
    v_cmp_eq_u32 vcc, 0, v48
    s_nop 1
    v_cndmask_b32 v80, v49, v80, vcc
    v_cndmask_b32 v81, v49, v81, vcc
    v_cndmask_b32 v82, v49, v82, vcc
    v_cndmask_b32 v83, v49, v83, vcc
    v_cndmask_b32 v84, v49, v84, vcc
    v_cndmask_b32 v85, v49, v85, vcc
    v_cndmask_b32 v86, v49, v86, vcc
    v_cndmask_b32 v87, v49, v87, vcc
    buffer_load_dwordx4 v2, s[8:11], s28 offen offset:1024 sc1 lds
    v_mfma_f32_16x16x32_bf16 v[120:123], v[80:83], v[128:131], 0
    v_mfma_f32_16x16x32_bf16 v[124:127], v[84:87], v[132:135], 0
    v_mfma_f32_16x16x32_bf16 v[160:163], v[80:83], v[136:139], 0
    v_mfma_f32_16x16x32_bf16 v[164:167], v[84:87], v[140:143], 0
    buffer_load_dwordx4 v3, s[8:11], s28 offen offset:2048 sc1 lds
    v_mfma_f32_16x16x32_bf16 v[168:171], v[80:83], v[144:147], 0
    v_mfma_f32_16x16x32_bf16 v[172:175], v[84:87], v[148:151], 0
    v_mfma_f32_16x16x32_bf16 v[176:179], v[80:83], v[152:155], 0
    v_mfma_f32_16x16x32_bf16 v[180:183], v[84:87], v[156:159], 0
    buffer_load_dwordx4 v3, s[8:11], s28 offen offset:3072 sc1 lds
    v_rcp_f32 v121, v121
    v_rcp_f32 v125, v125
    v_rcp_f32 v161, v161
    v_rcp_f32 v165, v165
    s_add_u32 m0, s33, 49152
    s_nop 0
    buffer_load_dwordx4 v5, s[12:15], s29 offen offset:0 lds
    v_rcp_f32 v169, v169
    v_rcp_f32 v173, v173
    v_rcp_f32 v177, v177
    v_rcp_f32 v181, v181
    buffer_load_dwordx4 v6, s[12:15], s29 offen offset:1024 lds
    v_fma_f32 v122, v120, v121, s67
    v_fma_f32 v162, v160, v161, s67
    v_fma_f32 v170, v168, v169, s67
    v_fma_f32 v178, v176, v177, s67
    v_fma_f32 v122, v124, v125, v122
    v_fma_f32 v162, v164, v165, v162
    v_fma_f32 v170, v172, v173, v170
    v_fma_f32 v178, v180, v181, v178
    buffer_load_dwordx4 v7, s[12:15], s29 offen offset:2048 lds
    v_rcp_f32 v122, v122
    v_rcp_f32 v162, v162
    v_rcp_f32 v170, v170
    v_rcp_f32 v178, v178
    buffer_load_dwordx4 v8, s[12:15], s29 offen offset:3072 lds
    v_mul_f32 v120, v121, v122
    v_mul_f32 v124, v125, v122
    v_mul_f32 v160, v161, v162
    v_mul_f32 v164, v165, v162
    v_mul_f32 v168, v169, v170
    v_mul_f32 v172, v173, v170
    v_mul_f32 v176, v177, v178
    v_mul_f32 v180, v181, v178
    s_add_u32 s28, s28, 2048
    s_add_u32 s29, s29, 131072
    s_add_u32 s30, s30, 1
    s_cmp_eq_u32 s30, s31
    s_cselect_b32 s12, s16, s12
    s_cselect_b32 s13, s17, s13
    s_cselect_b32 s14, s18, s14
    s_cselect_b32 s29, s34, s29
    s_cselect_b32 s28, s36, s28
    ds_read_b128 v[64:67], v25 offset:0
    ds_read_b128 v[68:71], v25 offset:1024
    ds_read_b128 v[72:75], v25 offset:2048
    ds_read_b128 v[76:79], v25 offset:3072
    s_waitcnt lgkmcnt(0)
    v_mfma_f32_16x16x32_bf16 v[32:35], v[64:67], v[128:131], 0
    v_mfma_f32_16x16x32_bf16 v[36:39], v[68:71], v[128:131], 0
    s_waitcnt lgkmcnt(0) vmcnt(16)
    s_barrier
    s_mov_b32 m0, s32
    s_nop 0
    buffer_load_dwordx4 v2, s[8:11], s28 offen offset:0 sc1 lds
    v_mfma_f32_16x16x32_bf16 v[40:43], v[72:75], v[132:135], 0
    v_mfma_f32_16x16x32_bf16 v[44:47], v[76:79], v[132:135], 0
    v_mfma_f32_16x16x32_bf16 v[48:51], v[64:67], v[136:139], 0
    v_mfma_f32_16x16x32_bf16 v[52:55], v[68:71], v[136:139], 0
    buffer_load_dwordx4 v2, s[8:11], s28 offen offset:1024 sc1 lds
    v_mfma_f32_16x16x32_bf16 v[56:59], v[72:75], v[140:143], 0
    v_mfma_f32_16x16x32_bf16 v[60:63], v[76:79], v[140:143], 0
    v_mfma_f32_16x16x32_bf16 v[88:91], v[64:67], v[144:147], 0
    v_mfma_f32_16x16x32_bf16 v[92:95], v[68:71], v[144:147], 0
    buffer_load_dwordx4 v3, s[8:11], s28 offen offset:2048 sc1 lds
    v_mfma_f32_16x16x32_bf16 v[96:99], v[72:75], v[148:151], 0
    v_mfma_f32_16x16x32_bf16 v[100:103], v[76:79], v[148:151], 0
    v_mfma_f32_16x16x32_bf16 v[104:107], v[64:67], v[152:155], 0
    v_mfma_f32_16x16x32_bf16 v[108:111], v[68:71], v[152:155], 0
    buffer_load_dwordx4 v3, s[8:11], s28 offen offset:3072 sc1 lds
    v_mfma_f32_16x16x32_bf16 v[112:115], v[72:75], v[156:159], 0
    v_mfma_f32_16x16x32_bf16 v[116:119], v[76:79], v[156:159], 0
    v_pk_mul_f32 v[32:33], v[32:33], v[120:121] op_sel_hi:[1,0]
    v_pk_mul_f32 v[34:35], v[34:35], v[120:121] op_sel_hi:[1,0]
    v_pk_mul_f32 v[36:37], v[36:37], v[120:121] op_sel_hi:[1,0]
    v_pk_mul_f32 v[38:39], v[38:39], v[120:121] op_sel_hi:[1,0]
    s_mov_b32 m0, s33
    s_nop 0
    buffer_load_dwordx4 v5, s[12:15], s29 offen offset:0 lds
    v_pk_fma_f32 v[32:33], v[40:41], v[124:125], v[32:33] op_sel_hi:[1,0,1]
    v_pk_fma_f32 v[34:35], v[42:43], v[124:125], v[34:35] op_sel_hi:[1,0,1]
    v_pk_fma_f32 v[36:37], v[44:45], v[124:125], v[36:37] op_sel_hi:[1,0,1]
    v_pk_fma_f32 v[38:39], v[46:47], v[124:125], v[38:39] op_sel_hi:[1,0,1]
    v_cvt_pk_bf16_f32 v40, v32, v33
    v_cvt_pk_bf16_f32 v41, v34, v35
    v_cvt_pk_bf16_f32 v42, v36, v37
    v_cvt_pk_bf16_f32 v43, v38, v39
    buffer_load_dwordx4 v6, s[12:15], s29 offen offset:1024 lds
    v_pk_mul_f32 v[48:49], v[48:49], v[160:161] op_sel_hi:[1,0]
    v_pk_mul_f32 v[50:51], v[50:51], v[160:161] op_sel_hi:[1,0]
    v_pk_mul_f32 v[52:53], v[52:53], v[160:161] op_sel_hi:[1,0]
    v_pk_mul_f32 v[54:55], v[54:55], v[160:161] op_sel_hi:[1,0]
    v_pk_fma_f32 v[48:49], v[56:57], v[164:165], v[48:49] op_sel_hi:[1,0,1]
    v_pk_fma_f32 v[50:51], v[58:59], v[164:165], v[50:51] op_sel_hi:[1,0,1]
    v_pk_fma_f32 v[52:53], v[60:61], v[164:165], v[52:53] op_sel_hi:[1,0,1]
    v_pk_fma_f32 v[54:55], v[62:63], v[164:165], v[54:55] op_sel_hi:[1,0,1]
    buffer_load_dwordx4 v7, s[12:15], s29 offen offset:2048 lds
    v_cvt_pk_bf16_f32 v56, v48, v49
    v_cvt_pk_bf16_f32 v57, v50, v51
    v_cvt_pk_bf16_f32 v58, v52, v53
    v_cvt_pk_bf16_f32 v59, v54, v55
    v_pk_mul_f32 v[88:89], v[88:89], v[168:169] op_sel_hi:[1,0]
    v_pk_mul_f32 v[90:91], v[90:91], v[168:169] op_sel_hi:[1,0]
    v_pk_mul_f32 v[92:93], v[92:93], v[168:169] op_sel_hi:[1,0]
    v_pk_mul_f32 v[94:95], v[94:95], v[168:169] op_sel_hi:[1,0]
    buffer_load_dwordx4 v8, s[12:15], s29 offen offset:3072 lds
    v_pk_fma_f32 v[88:89], v[96:97], v[172:173], v[88:89] op_sel_hi:[1,0,1]
    v_pk_fma_f32 v[90:91], v[98:99], v[172:173], v[90:91] op_sel_hi:[1,0,1]
    v_pk_fma_f32 v[92:93], v[100:101], v[172:173], v[92:93] op_sel_hi:[1,0,1]
    v_pk_fma_f32 v[94:95], v[102:103], v[172:173], v[94:95] op_sel_hi:[1,0,1]
    v_cvt_pk_bf16_f32 v96, v88, v89
    v_cvt_pk_bf16_f32 v97, v90, v91
    v_cvt_pk_bf16_f32 v98, v92, v93
    v_cvt_pk_bf16_f32 v99, v94, v95
    s_add_u32 s28, s28, 2048
    s_add_u32 s29, s29, 131072
    s_add_u32 s30, s30, 1
    s_cmp_eq_u32 s30, s31
    s_cselect_b32 s12, s16, s12
    s_cselect_b32 s13, s17, s13
    s_cselect_b32 s14, s18, s14
    s_cselect_b32 s29, s34, s29
    s_cselect_b32 s28, s36, s28
    v_pk_mul_f32 v[104:105], v[104:105], v[176:177] op_sel_hi:[1,0]
    v_pk_mul_f32 v[106:107], v[106:107], v[176:177] op_sel_hi:[1,0]
    v_pk_mul_f32 v[108:109], v[108:109], v[176:177] op_sel_hi:[1,0]
    v_pk_mul_f32 v[110:111], v[110:111], v[176:177] op_sel_hi:[1,0]
    v_pk_fma_f32 v[104:105], v[112:113], v[180:181], v[104:105] op_sel_hi:[1,0,1]
    v_pk_fma_f32 v[106:107], v[114:115], v[180:181], v[106:107] op_sel_hi:[1,0,1]
    v_pk_fma_f32 v[108:109], v[116:117], v[180:181], v[108:109] op_sel_hi:[1,0,1]
    v_pk_fma_f32 v[110:111], v[118:119], v[180:181], v[110:111] op_sel_hi:[1,0,1]
    s_waitcnt lgkmcnt(0) vmcnt(16)
    s_barrier
    s_add_u32 m0, s32, 16384
    s_nop 0
    buffer_load_dwordx4 v2, s[8:11], s28 offen offset:0 sc1 lds
    v_cvt_pk_bf16_f32 v112, v104, v105
    v_cvt_pk_bf16_f32 v113, v106, v107
    v_cvt_pk_bf16_f32 v114, v108, v109
    v_cvt_pk_bf16_f32 v115, v110, v111
    v_permlane16_swap_b32 v40, v42
    v_permlane16_swap_b32 v41, v43
    v_permlane16_swap_b32 v56, v58
    v_permlane16_swap_b32 v57, v59
    buffer_load_dwordx4 v2, s[8:11], s28 offen offset:1024 sc1 lds
    buffer_load_dwordx4 v3, s[8:11], s28 offen offset:2048 sc1 lds
    buffer_load_dwordx4 v3, s[8:11], s28 offen offset:3072 sc1 lds
    s_add_u32 m0, s33, 16384
    s_nop 0
    buffer_load_dwordx4 v5, s[12:15], s29 offen offset:0 lds
    buffer_load_dwordx4 v6, s[12:15], s29 offen offset:1024 lds
    buffer_load_dwordx4 v7, s[12:15], s29 offen offset:2048 lds
    buffer_load_dwordx4 v8, s[12:15], s29 offen offset:3072 lds
    s_add_u32 s28, s28, 2048
    s_add_u32 s29, s29, 131072
    s_add_u32 s30, s30, 1
    s_cmp_eq_u32 s30, s31
    s_cselect_b32 s12, s16, s12
    s_cselect_b32 s13, s17, s13
    s_cselect_b32 s14, s18, s14
    s_cselect_b32 s29, s34, s29
    s_cselect_b32 s28, s36, s28
    v_permlane16_swap_b32 v96, v98
    v_permlane16_swap_b32 v97, v99
    v_permlane16_swap_b32 v112, v114
    v_permlane16_swap_b32 v113, v115
    buffer_store_dwordx4 v[40:43], v11, s[20:23], s63 offen sc1
    buffer_store_dwordx4 v[56:59], v11, s[20:23], s64 offen sc1
    buffer_store_dwordx4 v[96:99], v11, s[20:23], s65 offen sc1
    buffer_store_dwordx4 v[112:115], v11, s[20:23], s66 offen sc1
    s_waitcnt lgkmcnt(0) vmcnt(20)
    s_barrier
    s_add_u32 m0, s32, 32768
    s_nop 0
    buffer_load_dwordx4 v2, s[8:11], s28 offen offset:0 sc1 lds
    buffer_load_dwordx4 v2, s[8:11], s28 offen offset:1024 sc1 lds
    buffer_load_dwordx4 v3, s[8:11], s28 offen offset:2048 sc1 lds
    buffer_load_dwordx4 v3, s[8:11], s28 offen offset:3072 sc1 lds
    s_add_u32 m0, s33, 32768
    s_nop 0
    buffer_load_dwordx4 v5, s[12:15], s29 offen offset:0 lds
    buffer_load_dwordx4 v6, s[12:15], s29 offen offset:1024 lds
    buffer_load_dwordx4 v7, s[12:15], s29 offen offset:2048 lds
    buffer_load_dwordx4 v8, s[12:15], s29 offen offset:3072 lds
    s_add_u32 s28, s28, 2048
    s_add_u32 s29, s29, 131072
    s_add_u32 s30, s30, 1
    s_cmp_eq_u32 s30, s31
    s_cselect_b32 s12, s16, s12
    s_cselect_b32 s13, s17, s13
    s_cselect_b32 s14, s18, s14
    s_cselect_b32 s29, s34, s29
    s_cselect_b32 s28, s36, s28
    s_waitcnt lgkmcnt(0) vmcnt(20)
    s_barrier
    s_add_u32 m0, s32, 49152
    s_nop 0
    buffer_load_dwordx4 v2, s[8:11], s28 offen offset:0 sc1 lds
    buffer_load_dwordx4 v2, s[8:11], s28 offen offset:1024 sc1 lds
    buffer_load_dwordx4 v3, s[8:11], s28 offen offset:2048 sc1 lds
    buffer_load_dwordx4 v3, s[8:11], s28 offen offset:3072 sc1 lds
    s_add_u32 m0, s33, 49152
    s_nop 0
    buffer_load_dwordx4 v5, s[12:15], s29 offen offset:0 lds
    buffer_load_dwordx4 v6, s[12:15], s29 offen offset:1024 lds
    buffer_load_dwordx4 v7, s[12:15], s29 offen offset:2048 lds
    buffer_load_dwordx4 v8, s[12:15], s29 offen offset:3072 lds
    s_add_u32 s28, s28, 2048
    s_add_u32 s29, s29, 131072
    s_add_u32 s30, s30, 1
    s_cmp_eq_u32 s30, s31
    s_cselect_b32 s12, s16, s12
    s_cselect_b32 s13, s17, s13
    s_cselect_b32 s14, s18, s14
    s_cselect_b32 s29, s34, s29
    s_cselect_b32 s28, s36, s28
    s_waitcnt lgkmcnt(0) vmcnt(20)
    s_barrier
    s_mov_b32 m0, s32
    s_nop 0
    buffer_load_dwordx4 v2, s[8:11], s28 offen offset:0 sc1 lds
    buffer_load_dwordx4 v2, s[8:11], s28 offen offset:1024 sc1 lds
    buffer_load_dwordx4 v3, s[8:11], s28 offen offset:2048 sc1 lds
    buffer_load_dwordx4 v3, s[8:11], s28 offen offset:3072 sc1 lds
    s_mov_b32 m0, s33
    s_nop 0
    buffer_load_dwordx4 v5, s[12:15], s29 offen offset:0 lds
    buffer_load_dwordx4 v6, s[12:15], s29 offen offset:1024 lds
    buffer_load_dwordx4 v7, s[12:15], s29 offen offset:2048 lds
    buffer_load_dwordx4 v8, s[12:15], s29 offen offset:3072 lds
    s_add_u32 s28, s28, 2048
    s_add_u32 s29, s29, 131072
    s_add_u32 s30, s30, 1
    s_cmp_eq_u32 s30, s31
    s_cselect_b32 s12, s16, s12
    s_cselect_b32 s13, s17, s13
    s_cselect_b32 s14, s18, s14
    s_cselect_b32 s29, s34, s29
    s_cselect_b32 s28, s36, s28
    s_waitcnt lgkmcnt(0) vmcnt(16)
    s_barrier
    s_add_u32 m0, s32, 16384
    s_nop 0
    buffer_load_dwordx4 v2, s[8:11], s28 offen offset:0 sc1 lds
    buffer_load_dwordx4 v2, s[8:11], s28 offen offset:1024 sc1 lds
    buffer_load_dwordx4 v3, s[8:11], s28 offen offset:2048 sc1 lds
    buffer_load_dwordx4 v3, s[8:11], s28 offen offset:3072 sc1 lds
    s_add_u32 m0, s33, 16384
    s_nop 0
    buffer_load_dwordx4 v5, s[12:15], s29 offen offset:0 lds
    buffer_load_dwordx4 v6, s[12:15], s29 offen offset:1024 lds
    buffer_load_dwordx4 v7, s[12:15], s29 offen offset:2048 lds
    buffer_load_dwordx4 v8, s[12:15], s29 offen offset:3072 lds
    s_add_u32 s28, s28, 2048
    s_add_u32 s29, s29, 131072
    s_add_u32 s30, s30, 1
    s_cmp_eq_u32 s30, s31
    s_cselect_b32 s12, s16, s12
    s_cselect_b32 s13, s17, s13
    s_cselect_b32 s14, s18, s14
    s_cselect_b32 s29, s34, s29
    s_cselect_b32 s28, s36, s28
    v_mov_b32 v12, s19
    v_mov_b32 v13, 1
    s_mov_b64 exec, 1
    buffer_store_dword v13, v12, s[20:23], 0 offen sc1
    s_mov_b64 exec, -1
    s_waitcnt lgkmcnt(0) vmcnt(17)
    s_barrier
    s_add_u32 m0, s32, 32768
    s_nop 0
    buffer_load_dwordx4 v2, s[8:11], s28 offen offset:0 sc1 lds
    buffer_load_dwordx4 v2, s[8:11], s28 offen offset:1024 sc1 lds
    buffer_load_dwordx4 v3, s[8:11], s28 offen offset:2048 sc1 lds
    buffer_load_dwordx4 v3, s[8:11], s28 offen offset:3072 sc1 lds
    s_add_u32 m0, s33, 32768
    s_nop 0
    buffer_load_dwordx4 v5, s[12:15], s29 offen offset:0 lds
    buffer_load_dwordx4 v6, s[12:15], s29 offen offset:1024 lds
    buffer_load_dwordx4 v7, s[12:15], s29 offen offset:2048 lds
    buffer_load_dwordx4 v8, s[12:15], s29 offen offset:3072 lds
    s_add_u32 s28, s28, 2048
    s_add_u32 s29, s29, 131072
    s_add_u32 s30, s30, 1
    s_cmp_eq_u32 s30, s31
    s_cselect_b32 s12, s16, s12
    s_cselect_b32 s13, s17, s13
    s_cselect_b32 s14, s18, s14
    s_cselect_b32 s29, s34, s29
    s_cselect_b32 s28, s36, s28
    s_waitcnt lgkmcnt(0) vmcnt(17)
    s_barrier
    s_add_u32 m0, s32, 49152
    s_nop 0
    buffer_load_dwordx4 v2, s[8:11], s28 offen offset:0 sc1 lds
    buffer_load_dwordx4 v2, s[8:11], s28 offen offset:1024 sc1 lds
    buffer_load_dwordx4 v3, s[8:11], s28 offen offset:2048 sc1 lds
    buffer_load_dwordx4 v3, s[8:11], s28 offen offset:3072 sc1 lds
    s_add_u32 m0, s33, 49152
    s_nop 0
    buffer_load_dwordx4 v5, s[12:15], s29 offen offset:0 lds
    buffer_load_dwordx4 v6, s[12:15], s29 offen offset:1024 lds
    buffer_load_dwordx4 v7, s[12:15], s29 offen offset:2048 lds
    buffer_load_dwordx4 v8, s[12:15], s29 offen offset:3072 lds
    s_add_u32 s28, s28, 2048
    s_add_u32 s29, s29, 131072
    s_add_u32 s30, s30, 1
    s_cmp_eq_u32 s30, s31
    s_cselect_b32 s12, s16, s12
    s_cselect_b32 s13, s17, s13
    s_cselect_b32 s14, s18, s14
    s_cselect_b32 s29, s34, s29
    s_cselect_b32 s28, s36, s28
    s_waitcnt lgkmcnt(0) vmcnt(17)
    s_barrier
    s_mov_b32 m0, s32
    s_nop 0
    buffer_load_dwordx4 v2, s[8:11], s28 offen offset:0 sc1 lds
    buffer_load_dwordx4 v2, s[8:11], s28 offen offset:1024 sc1 lds
    buffer_load_dwordx4 v3, s[8:11], s28 offen offset:2048 sc1 lds
    buffer_load_dwordx4 v3, s[8:11], s28 offen offset:3072 sc1 lds
    s_mov_b32 m0, s33
    s_nop 0
    buffer_load_dwordx4 v5, s[12:15], s29 offen offset:0 lds
    buffer_load_dwordx4 v6, s[12:15], s29 offen offset:1024 lds
    buffer_load_dwordx4 v7, s[12:15], s29 offen offset:2048 lds
    buffer_load_dwordx4 v8, s[12:15], s29 offen offset:3072 lds
    s_add_u32 s28, s28, 2048
    s_add_u32 s29, s29, 131072
    s_add_u32 s30, s30, 1
    s_cmp_eq_u32 s30, s31
    s_cselect_b32 s12, s16, s12
    s_cselect_b32 s13, s17, s13
    s_cselect_b32 s14, s18, s14
    s_cselect_b32 s29, s34, s29
    s_cselect_b32 s28, s36, s28
    s_waitcnt lgkmcnt(0) vmcnt(16)
    s_barrier
    s_add_u32 m0, s32, 16384
    s_nop 0
    buffer_load_dwordx4 v2, s[8:11], s28 offen offset:0 sc1 lds
    buffer_load_dwordx4 v2, s[8:11], s28 offen offset:1024 sc1 lds
    buffer_load_dwordx4 v3, s[8:11], s28 offen offset:2048 sc1 lds
    buffer_load_dwordx4 v3, s[8:11], s28 offen offset:3072 sc1 lds
    s_add_u32 m0, s33, 16384
    s_nop 0
    buffer_load_dwordx4 v5, s[12:15], s29 offen offset:0 lds
    buffer_load_dwordx4 v6, s[12:15], s29 offen offset:1024 lds
    buffer_load_dwordx4 v7, s[12:15], s29 offen offset:2048 lds
    buffer_load_dwordx4 v8, s[12:15], s29 offen offset:3072 lds
    s_add_u32 s28, s28, 2048
    s_add_u32 s29, s29, 131072
    s_add_u32 s30, s30, 1
    s_cmp_eq_u32 s30, s31
    s_cselect_b32 s12, s16, s12
    s_cselect_b32 s13, s17, s13
    s_cselect_b32 s14, s18, s14
    s_cselect_b32 s29, s34, s29
    s_cselect_b32 s28, s36, s28
    s_waitcnt lgkmcnt(0) vmcnt(16)
    s_barrier
    s_add_u32 m0, s32, 32768
    s_nop 0
    buffer_load_dwordx4 v2, s[8:11], s28 offen offset:0 sc1 lds
    buffer_load_dwordx4 v2, s[8:11], s28 offen offset:1024 sc1 lds
    buffer_load_dwordx4 v3, s[8:11], s28 offen offset:2048 sc1 lds
    buffer_load_dwordx4 v3, s[8:11], s28 offen offset:3072 sc1 lds
    s_add_u32 m0, s33, 32768
    s_nop 0
    buffer_load_dwordx4 v5, s[12:15], s29 offen offset:0 lds
    buffer_load_dwordx4 v6, s[12:15], s29 offen offset:1024 lds
    buffer_load_dwordx4 v7, s[12:15], s29 offen offset:2048 lds
    buffer_load_dwordx4 v8, s[12:15], s29 offen offset:3072 lds
    s_add_u32 s28, s28, 2048
    s_add_u32 s29, s29, 131072
    s_add_u32 s30, s30, 1
    s_cmp_eq_u32 s30, s31
    s_cselect_b32 s12, s16, s12
    s_cselect_b32 s13, s17, s13
    s_cselect_b32 s14, s18, s14
    s_cselect_b32 s29, s34, s29
    s_cselect_b32 s28, s36, s28
    s_waitcnt lgkmcnt(0) vmcnt(16)
    s_barrier
    s_add_u32 m0, s32, 49152
    s_nop 0
    buffer_load_dwordx4 v2, s[8:11], s28 offen offset:0 sc1 lds
    buffer_load_dwordx4 v2, s[8:11], s28 offen offset:1024 sc1 lds
    buffer_load_dwordx4 v3, s[8:11], s28 offen offset:2048 sc1 lds
    buffer_load_dwordx4 v3, s[8:11], s28 offen offset:3072 sc1 lds
    s_add_u32 m0, s33, 49152
    s_nop 0
    buffer_load_dwordx4 v5, s[12:15], s29 offen offset:0 lds
    buffer_load_dwordx4 v6, s[12:15], s29 offen offset:1024 lds
    buffer_load_dwordx4 v7, s[12:15], s29 offen offset:2048 lds
    buffer_load_dwordx4 v8, s[12:15], s29 offen offset:3072 lds
    s_add_u32 s28, s28, 2048
    s_add_u32 s29, s29, 131072
    s_add_u32 s30, s30, 1
    s_cmp_eq_u32 s30, s31
    s_cselect_b32 s12, s16, s12
    s_cselect_b32 s13, s17, s13
    s_cselect_b32 s14, s18, s14
    s_cselect_b32 s29, s34, s29
    s_cselect_b32 s28, s36, s28
    s_waitcnt lgkmcnt(0) vmcnt(16)
    s_barrier
    s_mov_b32 m0, s32
    s_nop 0
    buffer_load_dwordx4 v2, s[8:11], s28 offen offset:0 sc1 lds
    buffer_load_dwordx4 v2, s[8:11], s28 offen offset:1024 sc1 lds
    buffer_load_dwordx4 v3, s[8:11], s28 offen offset:2048 sc1 lds
    buffer_load_dwordx4 v3, s[8:11], s28 offen offset:3072 sc1 lds
    s_mov_b32 m0, s33
    s_nop 0
    buffer_load_dwordx4 v5, s[12:15], s29 offen offset:0 lds
    buffer_load_dwordx4 v6, s[12:15], s29 offen offset:1024 lds
    buffer_load_dwordx4 v7, s[12:15], s29 offen offset:2048 lds
    buffer_load_dwordx4 v8, s[12:15], s29 offen offset:3072 lds
    s_add_u32 s28, s28, 2048
    s_add_u32 s29, s29, 131072
    s_add_u32 s30, s30, 1
    s_cmp_eq_u32 s30, s31
    s_cselect_b32 s12, s16, s12
    s_cselect_b32 s13, s17, s13
    s_cselect_b32 s14, s18, s14
    s_cselect_b32 s29, s34, s29
    s_cselect_b32 s28, s36, s28
    s_waitcnt lgkmcnt(0) vmcnt(16)
    s_barrier
    s_add_u32 m0, s32, 16384
    s_nop 0
    buffer_load_dwordx4 v2, s[8:11], s28 offen offset:0 sc1 lds
    buffer_load_dwordx4 v2, s[8:11], s28 offen offset:1024 sc1 lds
    buffer_load_dwordx4 v3, s[8:11], s28 offen offset:2048 sc1 lds
    buffer_load_dwordx4 v3, s[8:11], s28 offen offset:3072 sc1 lds
    s_add_u32 m0, s33, 16384
    s_nop 0
    buffer_load_dwordx4 v5, s[12:15], s29 offen offset:0 lds
    buffer_load_dwordx4 v6, s[12:15], s29 offen offset:1024 lds
    buffer_load_dwordx4 v7, s[12:15], s29 offen offset:2048 lds
    buffer_load_dwordx4 v8, s[12:15], s29 offen offset:3072 lds
    s_add_u32 s28, s28, 2048
    s_add_u32 s29, s29, 131072
    s_add_u32 s30, s30, 1
    s_cmp_eq_u32 s30, s31
    s_cselect_b32 s12, s16, s12
    s_cselect_b32 s13, s17, s13
    s_cselect_b32 s14, s18, s14
    s_cselect_b32 s29, s34, s29
    s_cselect_b32 s28, s36, s28
    s_waitcnt lgkmcnt(0) vmcnt(16)
    s_barrier
    s_add_u32 m0, s32, 32768
    s_nop 0
    buffer_load_dwordx4 v2, s[8:11], s28 offen offset:0 sc1 lds
    buffer_load_dwordx4 v2, s[8:11], s28 offen offset:1024 sc1 lds
    buffer_load_dwordx4 v3, s[8:11], s28 offen offset:2048 sc1 lds
    buffer_load_dwordx4 v3, s[8:11], s28 offen offset:3072 sc1 lds
    s_add_u32 m0, s33, 32768
    s_nop 0
    buffer_load_dwordx4 v5, s[12:15], s29 offen offset:0 lds
    buffer_load_dwordx4 v6, s[12:15], s29 offen offset:1024 lds
    buffer_load_dwordx4 v7, s[12:15], s29 offen offset:2048 lds
    buffer_load_dwordx4 v8, s[12:15], s29 offen offset:3072 lds
    s_add_u32 s28, s28, 2048
    s_add_u32 s29, s29, 131072
    s_add_u32 s30, s30, 1
    s_cmp_eq_u32 s30, s31
    s_cselect_b32 s12, s16, s12
    s_cselect_b32 s13, s17, s13
    s_cselect_b32 s14, s18, s14
    s_cselect_b32 s29, s34, s29
    s_cselect_b32 s28, s36, s28
    s_waitcnt lgkmcnt(0) vmcnt(16)
    s_barrier
    s_add_u32 m0, s32, 49152
    s_nop 0
    buffer_load_dwordx4 v2, s[8:11], s28 offen offset:0 sc1 lds
    buffer_load_dwordx4 v2, s[8:11], s28 offen offset:1024 sc1 lds
    buffer_load_dwordx4 v3, s[8:11], s28 offen offset:2048 sc1 lds
    buffer_load_dwordx4 v3, s[8:11], s28 offen offset:3072 sc1 lds
    s_add_u32 m0, s33, 49152
    s_nop 0
    buffer_load_dwordx4 v5, s[12:15], s29 offen offset:0 lds
    buffer_load_dwordx4 v6, s[12:15], s29 offen offset:1024 lds
    buffer_load_dwordx4 v7, s[12:15], s29 offen offset:2048 lds
    buffer_load_dwordx4 v8, s[12:15], s29 offen offset:3072 lds
    s_add_u32 s28, s28, 2048
    s_add_u32 s29, s29, 131072
    s_add_u32 s30, s30, 1
    s_cmp_eq_u32 s30, s31
    s_cselect_b32 s12, s16, s12
    s_cselect_b32 s13, s17, s13
    s_cselect_b32 s14, s18, s14
    s_cselect_b32 s29, s34, s29
    s_cselect_b32 s28, s36, s28
    s_waitcnt lgkmcnt(0) vmcnt(16)
    s_barrier
    s_mov_b32 m0, s32
    s_nop 0
    buffer_load_dwordx4 v2, s[8:11], s28 offen offset:0 sc1 lds
    buffer_load_dwordx4 v2, s[8:11], s28 offen offset:1024 sc1 lds
    buffer_load_dwordx4 v3, s[8:11], s28 offen offset:2048 sc1 lds
    buffer_load_dwordx4 v3, s[8:11], s28 offen offset:3072 sc1 lds
    s_mov_b32 m0, s33
    s_nop 0
    buffer_load_dwordx4 v5, s[12:15], s29 offen offset:0 lds
    buffer_load_dwordx4 v6, s[12:15], s29 offen offset:1024 lds
    buffer_load_dwordx4 v7, s[12:15], s29 offen offset:2048 lds
    buffer_load_dwordx4 v8, s[12:15], s29 offen offset:3072 lds
    s_add_u32 s28, s28, 2048
    s_add_u32 s29, s29, 131072
    s_add_u32 s30, s30, 1
    s_cmp_eq_u32 s30, s31
    s_cselect_b32 s12, s16, s12
    s_cselect_b32 s13, s17, s13
    s_cselect_b32 s14, s18, s14
    s_cselect_b32 s29, s34, s29
    s_cselect_b32 s28, s36, s28
    s_waitcnt lgkmcnt(0) vmcnt(16)
    s_barrier
    s_add_u32 m0, s32, 16384
    s_nop 0
    buffer_load_dwordx4 v2, s[8:11], s28 offen offset:0 sc1 lds
    buffer_load_dwordx4 v2, s[8:11], s28 offen offset:1024 sc1 lds
    buffer_load_dwordx4 v3, s[8:11], s28 offen offset:2048 sc1 lds
    buffer_load_dwordx4 v3, s[8:11], s28 offen offset:3072 sc1 lds
    s_add_u32 m0, s33, 16384
    s_nop 0
    buffer_load_dwordx4 v5, s[12:15], s29 offen offset:0 lds
    buffer_load_dwordx4 v6, s[12:15], s29 offen offset:1024 lds
    buffer_load_dwordx4 v7, s[12:15], s29 offen offset:2048 lds
    buffer_load_dwordx4 v8, s[12:15], s29 offen offset:3072 lds
    s_add_u32 s28, s28, 2048
    s_add_u32 s29, s29, 131072
    s_add_u32 s30, s30, 1
    s_cmp_eq_u32 s30, s31
    s_cselect_b32 s12, s16, s12
    s_cselect_b32 s13, s17, s13
    s_cselect_b32 s14, s18, s14
    s_cselect_b32 s29, s34, s29
    s_cselect_b32 s28, s36, s28
    s_waitcnt lgkmcnt(0) vmcnt(16)
    s_barrier
    s_add_u32 m0, s32, 32768
    s_nop 0
    buffer_load_dwordx4 v2, s[8:11], s28 offen offset:0 sc1 lds
    buffer_load_dwordx4 v2, s[8:11], s28 offen offset:1024 sc1 lds
    buffer_load_dwordx4 v3, s[8:11], s28 offen offset:2048 sc1 lds
    buffer_load_dwordx4 v3, s[8:11], s28 offen offset:3072 sc1 lds
    s_add_u32 m0, s33, 32768
    s_nop 0
    buffer_load_dwordx4 v5, s[12:15], s29 offen offset:0 lds
    buffer_load_dwordx4 v6, s[12:15], s29 offen offset:1024 lds
    buffer_load_dwordx4 v7, s[12:15], s29 offen offset:2048 lds
    buffer_load_dwordx4 v8, s[12:15], s29 offen offset:3072 lds
    s_add_u32 s28, s28, 2048
    s_add_u32 s29, s29, 131072
    s_add_u32 s30, s30, 1
    s_cmp_eq_u32 s30, s31
    s_cselect_b32 s12, s16, s12
    s_cselect_b32 s13, s17, s13
    s_cselect_b32 s14, s18, s14
    s_cselect_b32 s29, s34, s29
    s_cselect_b32 s28, s36, s28
    s_waitcnt lgkmcnt(0) vmcnt(16)
    s_barrier
    s_add_u32 m0, s32, 49152
    s_nop 0
    buffer_load_dwordx4 v2, s[8:11], s28 offen offset:0 sc1 lds
    buffer_load_dwordx4 v2, s[8:11], s28 offen offset:1024 sc1 lds
    buffer_load_dwordx4 v3, s[8:11], s28 offen offset:2048 sc1 lds
    buffer_load_dwordx4 v3, s[8:11], s28 offen offset:3072 sc1 lds
    s_add_u32 m0, s33, 49152
    s_nop 0
    buffer_load_dwordx4 v5, s[12:15], s29 offen offset:0 lds
    buffer_load_dwordx4 v6, s[12:15], s29 offen offset:1024 lds
    buffer_load_dwordx4 v7, s[12:15], s29 offen offset:2048 lds
    buffer_load_dwordx4 v8, s[12:15], s29 offen offset:3072 lds
    s_add_u32 s28, s28, 2048
    s_add_u32 s29, s29, 131072
    s_add_u32 s30, s30, 1
    s_cmp_eq_u32 s30, s31
    s_cselect_b32 s12, s16, s12
    s_cselect_b32 s13, s17, s13
    s_cselect_b32 s14, s18, s14
    s_cselect_b32 s29, s34, s29
    s_cselect_b32 s28, s36, s28
    s_waitcnt lgkmcnt(0) vmcnt(16)
    s_barrier
    s_add_u32 m0, s35, 0
    s_nop 0
    buffer_load_dwordx4 v4, s[8:11], s28 offen offset:0 sc1 lds
    buffer_load_dwordx4 v4, s[8:11], s28 offen offset:1024 sc1 lds
    s_mov_b32 m0, s33
    s_nop 0
    buffer_load_dwordx4 v5, s[12:15], s29 offen offset:0 lds
    buffer_load_dwordx4 v6, s[12:15], s29 offen offset:1024 lds
    buffer_load_dwordx4 v7, s[12:15], s29 offen offset:2048 lds
    buffer_load_dwordx4 v8, s[12:15], s29 offen offset:3072 lds
    s_add_u32 s28, s28, 2048
    s_add_u32 s29, s29, 131072
    s_add_u32 s30, s30, 1
    s_cmp_eq_u32 s30, s31
    s_cselect_b32 s12, s16, s12
    s_cselect_b32 s13, s17, s13
    s_cselect_b32 s14, s18, s14
    s_cselect_b32 s29, s34, s29
    s_cselect_b32 s28, s36, s28
    s_waitcnt lgkmcnt(0) vmcnt(14)
    s_barrier
    s_add_u32 m0, s35, 16384
    s_nop 0
    buffer_load_dwordx4 v4, s[8:11], s28 offen offset:0 sc1 lds
    buffer_load_dwordx4 v4, s[8:11], s28 offen offset:1024 sc1 lds
    s_add_u32 m0, s33, 16384
    s_nop 0
    buffer_load_dwordx4 v5, s[12:15], s29 offen offset:0 lds
    buffer_load_dwordx4 v6, s[12:15], s29 offen offset:1024 lds
    buffer_load_dwordx4 v7, s[12:15], s29 offen offset:2048 lds
    buffer_load_dwordx4 v8, s[12:15], s29 offen offset:3072 lds
    s_add_u32 s28, s28, 2048
    s_add_u32 s29, s29, 131072
    s_add_u32 s30, s30, 1
    s_cmp_eq_u32 s30, s31
    s_cselect_b32 s12, s16, s12
    s_cselect_b32 s13, s17, s13
    s_cselect_b32 s14, s18, s14
    s_cselect_b32 s29, s34, s29
    s_cselect_b32 s28, s36, s28
    s_waitcnt lgkmcnt(0) vmcnt(12)
    s_barrier
    s_add_u32 m0, s35, 32768
    s_nop 0
    buffer_load_dwordx4 v4, s[8:11], s28 offen offset:0 sc1 lds
    buffer_load_dwordx4 v4, s[8:11], s28 offen offset:1024 sc1 lds
    s_add_u32 m0, s33, 32768
    s_nop 0
    buffer_load_dwordx4 v5, s[12:15], s29 offen offset:0 lds
    buffer_load_dwordx4 v6, s[12:15], s29 offen offset:1024 lds
    buffer_load_dwordx4 v7, s[12:15], s29 offen offset:2048 lds
    buffer_load_dwordx4 v8, s[12:15], s29 offen offset:3072 lds
    s_add_u32 s28, s28, 2048
    s_add_u32 s29, s29, 131072
    s_add_u32 s30, s30, 1
    s_cmp_eq_u32 s30, s31
    s_cselect_b32 s12, s16, s12
    s_cselect_b32 s13, s17, s13
    s_cselect_b32 s14, s18, s14
    s_cselect_b32 s29, s34, s29
    s_cselect_b32 s28, s36, s28
    s_waitcnt lgkmcnt(0) vmcnt(12)
    s_barrier
    s_add_u32 m0, s35, 49152
    s_nop 0
    buffer_load_dwordx4 v4, s[8:11], s28 offen offset:0 sc1 lds
    buffer_load_dwordx4 v4, s[8:11], s28 offen offset:1024 sc1 lds
    s_add_u32 m0, s33, 49152
    s_nop 0
    buffer_load_dwordx4 v5, s[12:15], s29 offen offset:0 lds
    buffer_load_dwordx4 v6, s[12:15], s29 offen offset:1024 lds
    buffer_load_dwordx4 v7, s[12:15], s29 offen offset:2048 lds
    buffer_load_dwordx4 v8, s[12:15], s29 offen offset:3072 lds
    s_add_u32 s28, s28, 2048
    s_add_u32 s29, s29, 131072
    s_add_u32 s30, s30, 1
    s_cmp_eq_u32 s30, s31
    s_cselect_b32 s12, s16, s12
    s_cselect_b32 s13, s17, s13
    s_cselect_b32 s14, s18, s14
    s_cselect_b32 s29, s34, s29
    s_cselect_b32 s28, s36, s28
    s_waitcnt lgkmcnt(0) vmcnt(12)
    s_barrier
    s_add_u32 m0, s35, 0
    s_nop 0
    buffer_load_dwordx4 v4, s[8:11], s28 offen offset:0 sc1 lds
    buffer_load_dwordx4 v4, s[8:11], s28 offen offset:1024 sc1 lds
    s_mov_b32 m0, s33
    s_nop 0
    buffer_load_dwordx4 v5, s[12:15], s29 offen offset:0 lds
    buffer_load_dwordx4 v6, s[12:15], s29 offen offset:1024 lds
    buffer_load_dwordx4 v7, s[12:15], s29 offen offset:2048 lds
    buffer_load_dwordx4 v8, s[12:15], s29 offen offset:3072 lds
    s_add_u32 s28, s28, 2048
    s_add_u32 s29, s29, 131072
    s_add_u32 s30, s30, 1
    s_cmp_eq_u32 s30, s31
    s_cselect_b32 s12, s16, s12
    s_cselect_b32 s13, s17, s13
    s_cselect_b32 s14, s18, s14
    s_cselect_b32 s29, s34, s29
    s_cselect_b32 s28, s36, s28
    s_waitcnt lgkmcnt(0) vmcnt(12)
    s_barrier
    s_add_u32 m0, s35, 16384
    s_nop 0
    buffer_load_dwordx4 v4, s[8:11], s28 offen offset:0 sc1 lds
    buffer_load_dwordx4 v4, s[8:11], s28 offen offset:1024 sc1 lds
    s_add_u32 m0, s33, 16384
    s_nop 0
    buffer_load_dwordx4 v5, s[12:15], s29 offen offset:0 lds
    buffer_load_dwordx4 v6, s[12:15], s29 offen offset:1024 lds
    buffer_load_dwordx4 v7, s[12:15], s29 offen offset:2048 lds
    buffer_load_dwordx4 v8, s[12:15], s29 offen offset:3072 lds
    s_add_u32 s28, s28, 2048
    s_add_u32 s29, s29, 131072
    s_add_u32 s30, s30, 1
    s_cmp_eq_u32 s30, s31
    s_cselect_b32 s12, s16, s12
    s_cselect_b32 s13, s17, s13
    s_cselect_b32 s14, s18, s14
    s_cselect_b32 s29, s34, s29
    s_cselect_b32 s28, s36, s28
    s_waitcnt lgkmcnt(0) vmcnt(12)
    s_barrier
    s_add_u32 m0, s35, 32768
    s_nop 0
    buffer_load_dwordx4 v4, s[8:11], s28 offen offset:0 sc1 lds
    buffer_load_dwordx4 v4, s[8:11], s28 offen offset:1024 sc1 lds
    s_add_u32 m0, s33, 32768
    s_nop 0
    buffer_load_dwordx4 v5, s[12:15], s29 offen offset:0 lds
    buffer_load_dwordx4 v6, s[12:15], s29 offen offset:1024 lds
    buffer_load_dwordx4 v7, s[12:15], s29 offen offset:2048 lds
    buffer_load_dwordx4 v8, s[12:15], s29 offen offset:3072 lds
    s_add_u32 s28, s28, 2048
    s_add_u32 s29, s29, 131072
    s_add_u32 s30, s30, 1
    s_cmp_eq_u32 s30, s31
    s_cselect_b32 s12, s16, s12
    s_cselect_b32 s13, s17, s13
    s_cselect_b32 s14, s18, s14
    s_cselect_b32 s29, s34, s29
    s_cselect_b32 s28, s36, s28
    s_waitcnt lgkmcnt(0) vmcnt(12)
    s_barrier
    s_add_u32 m0, s35, 49152
    s_nop 0
    buffer_load_dwordx4 v4, s[8:11], s28 offen offset:0 sc1 lds
    buffer_load_dwordx4 v4, s[8:11], s28 offen offset:1024 sc1 lds
    s_add_u32 m0, s33, 49152
    s_nop 0
    buffer_load_dwordx4 v5, s[12:15], s29 offen offset:0 lds
    buffer_load_dwordx4 v6, s[12:15], s29 offen offset:1024 lds
    buffer_load_dwordx4 v7, s[12:15], s29 offen offset:2048 lds
    buffer_load_dwordx4 v8, s[12:15], s29 offen offset:3072 lds
    s_add_u32 s28, s28, 2048
    s_add_u32 s29, s29, 131072
    s_add_u32 s30, s30, 1
    s_cmp_eq_u32 s30, s31
    s_cselect_b32 s12, s16, s12
    s_cselect_b32 s13, s17, s13
    s_cselect_b32 s14, s18, s14
    s_cselect_b32 s29, s34, s29
    s_cselect_b32 s28, s36, s28
    s_waitcnt lgkmcnt(0) vmcnt(12)
    s_barrier
    s_waitcnt lgkmcnt(0) vmcnt(6)
    s_barrier
    s_waitcnt lgkmcnt(0) vmcnt(0)
    s_barrier
    s_branch L_end
L_classG:
    v_add_u32 v2, 96256, v23
    v_add_u32 v3, 111616, v24
    s_and_b32 s3, s26, 1
    s_mul_i32 s3, s3, 7168
    s_cmp_ge_u32 s26, 2
    s_mov_b32 s60, 45056
    s_cselect_b32 s35, 59520, s60
    s_add_u32 s35, s35, s3
    s_add_u32 s36, s35, 4096
    s_lshr_b32 s60, s2, 6
    s_and_b32 s61, s26, 1
    s_lshl_b32 s3, s60, 6
    v_add_u32 v36, s3, v1
    v_lshlrev_b32 v36, 11, v36
    s_lshl_b32 s3, s61, 7
    v_add_u32 v36, s3, v36
    s_lshl_b32 s62, s24, 4
    s_lshl_b32 s3, s61, 3
    s_add_u32 s62, s62, s3
    s_and_b32 s63, s25, 28
    v_mul_u32_u24 v37, 10923, v1
    v_lshrrev_b32 v37, 16, v37
    v_mul_u32_u24 v38, 6, v37
    v_sub_u32 v38, v1, v38
    v_add_u32 v37, s62, v37
    v_mul_u32_u24 v37, 6144, v37
    v_lshrrev_b32 v39, 1, v38
    v_lshl_add_u32 v37, v39, 11, v37
    v_and_b32 v38, 1, v38
    v_lshl_add_u32 v37, v38, 7, v37
    s_lshl_b32 s3, s63, 6
    v_add_u32 v37, s3, v37
    v_mov_b32 v41, 0x7ffffff0
    v_cmp_gt_u32 vcc, 48, v1
    s_nop 1
    v_cndmask_b32 v37, v41, v37, vcc
    v_mul_u32_u24 v38, 9363, v1
    v_lshrrev_b32 v38, 16, v38
    v_mul_u32_u24 v39, 7, v38
    v_sub_u32 v39, v1, v39
    v_add_u32 v38, s62, v38
    v_mul_u32_u24 v38, 7168, v38
    v_lshl_add_u32 v38, v39, 7, v38
    s_mul_i32 s3, s63, 224
    v_add_u32 v38, s3, v38
    v_cmp_gt_u32 vcc, 56, v1
    s_nop 1
    v_cndmask_b32 v38, v41, v38, vcc
    s_and_b32 s3, s2, 63
    s_lshl_b32 s3, s3, 1
    s_add_u32 s3, s3, s61
    s_lshl_b32 s3, s3, 13
    v_lshlrev_b32 v39, 7, v1
    v_add_u32 v39, s3, v39
    s_waitcnt lgkmcnt(0)
    s_add_u32 s8, s4, s64
    s_addc_u32 s9, s5, 0
    s_sub_u32 s10, 4194304, s64
    s_mov_b32 s11, 0x20000
    s_mov_b32 s68, s6
    s_mov_b32 s69, s7
    s_mov_b32 s70, 6291456
    s_mov_b32 s71, 0x20000
    s_mov_b32 s37, 786432
    s_mov_b32 s31, 0
    v_mov_b32 v21, v37
    s_cmp_eq_u32 s60, 1
    s_cselect_b64 vcc, -1, 0
    s_cselect_b32 s68, s52, s68
    s_cselect_b32 s69, s53, s69
    s_cselect_b32 s70, 7340032, s70
    s_cselect_b32 s37, 917504, s37
    s_cselect_b32 s31, 0, s31
    v_cndmask_b32 v21, v21, v38, vcc
    s_cmp_eq_u32 s60, 2
    s_cselect_b64 vcc, -1, 0
    s_cselect_b32 s68, s54, s68
    s_cselect_b32 s69, s55, s69
    s_cselect_b32 s70, 7340032, s70
    s_cselect_b32 s37, 917504, s37
    s_cselect_b32 s31, 0, s31
    v_cndmask_b32 v21, v21, v38, vcc
    s_cmp_eq_u32 s60, 3
    s_cselect_b64 vcc, -1, 0
    s_cselect_b32 s68, s40, s68
    s_cselect_b32 s69, s41, s69
    s_cselect_b32 s70, 7340032, s70
    s_cselect_b32 s37, 1048576, s37
    s_cselect_b32 s31, 4293918720, s31
    v_cndmask_b32 v21, v21, v39, vcc
    s_lshr_b32 s61, s26, 1
    s_cmp_eq_u32 s61, 0
    s_cselect_b64 vcc, -1, 0
    s_cselect_b32 s68, s8, s68
    s_cselect_b32 s69, s9, s69
    s_cselect_b32 s70, 524288, s70
    s_cselect_b32 s37, 256, s37
    s_cselect_b32 s31, 0, s31
    v_cndmask_b32 v21, v21, v36, vcc
    buffer_load_dword v22, v21, s[68:71], s31 offen
    s_add_u32 s31, s31, s37
    s_mov_b32 m0, s33
    s_nop 0
    buffer_load_dwordx4 v2, s[8:11], s28 offen offset:2048 lds
    buffer_load_dwordx4 v3, s[8:11], s28 offen offset:3072 lds
    s_cmp_ge_u32 s26, 2
    s_cselect_b32 s60, s54, s52
    s_cselect_b32 s61, s55, s53
    s_mul_i32 s3, s25, 224
    s_add_u32 s12, s60, s3
    s_addc_u32 s13, s61, 0
    s_sub_u32 s14, 7340032, s3
    s_mov_b32 s15, 0x20000
    s_and_b32 s3, s26, 1
    s_mul_i32 s3, s3, 448
    s_and_b32 s65, s25, 1
    s_lshl_b32 s65, s65, 1
    v_add_u32 v23, s3, v1
    v_mul_u32_u24 v24, 4682, v23
    v_lshrrev_b32 v24, 16, v24
    v_mul_u32_u24 v25, 14, v24
    v_sub_u32 v25, v23, v25
    v_add_u32 v25, s65, v25
    v_subrev_u32 v26, 14, v25
    v_min_u32 v25, v25, v26
    v_and_b32 v27, 0xfffffff3, v24
    v_bfe_u32 v26, v24, 2, 1
    v_lshl_or_b32 v27, v26, 3, v27
    v_bfe_u32 v26, v24, 3, 1
    v_lshl_or_b32 v27, v26, 2, v27
    v_mul_u32_u24 v24, 7168, v27
    v_lshl_add_u32 v24, v25, 4, v24
    v_subrev_u32 v4, 0, v24
    s_mov_b32 m0, s35
    s_nop 0
    buffer_load_dwordx4 v4, s[12:15], s29 offen offset:0 lds
    v_add_u32 v23, s3, v1
    v_add_u32 v23, 64, v23
    v_mul_u32_u24 v24, 4682, v23
    v_lshrrev_b32 v24, 16, v24
    v_mul_u32_u24 v25, 14, v24
    v_sub_u32 v25, v23, v25
    v_add_u32 v25, s65, v25
    v_subrev_u32 v26, 14, v25
    v_min_u32 v25, v25, v26
    v_and_b32 v27, 0xfffffff3, v24
    v_bfe_u32 v26, v24, 2, 1
    v_lshl_or_b32 v27, v26, 3, v27
    v_bfe_u32 v26, v24, 3, 1
    v_lshl_or_b32 v27, v26, 2, v27
    v_mul_u32_u24 v24, 7168, v27
    v_lshl_add_u32 v24, v25, 4, v24
    v_subrev_u32 v5, 1024, v24
    buffer_load_dwordx4 v5, s[12:15], s29 offen offset:1024 lds
    v_add_u32 v23, s3, v1
    v_add_u32 v23, 128, v23
    v_mul_u32_u24 v24, 4682, v23
    v_lshrrev_b32 v24, 16, v24
    v_mul_u32_u24 v25, 14, v24
    v_sub_u32 v25, v23, v25
    v_add_u32 v25, s65, v25
    v_subrev_u32 v26, 14, v25
    v_min_u32 v25, v25, v26
    v_and_b32 v27, 0xfffffff3, v24
    v_bfe_u32 v26, v24, 2, 1
    v_lshl_or_b32 v27, v26, 3, v27
    v_bfe_u32 v26, v24, 3, 1
    v_lshl_or_b32 v27, v26, 2, v27
    v_mul_u32_u24 v24, 7168, v27
    v_lshl_add_u32 v24, v25, 4, v24
    v_subrev_u32 v6, 2048, v24
    buffer_load_dwordx4 v6, s[12:15], s29 offen offset:2048 lds
    v_add_u32 v23, s3, v1
    v_add_u32 v23, 192, v23
    v_mul_u32_u24 v24, 4682, v23
    v_lshrrev_b32 v24, 16, v24
    v_mul_u32_u24 v25, 14, v24
    v_sub_u32 v25, v23, v25
    v_add_u32 v25, s65, v25
    v_subrev_u32 v26, 14, v25
    v_min_u32 v25, v25, v26
    v_and_b32 v27, 0xfffffff3, v24
    v_bfe_u32 v26, v24, 2, 1
    v_lshl_or_b32 v27, v26, 3, v27
    v_bfe_u32 v26, v24, 3, 1
    v_lshl_or_b32 v27, v26, 2, v27
    v_mul_u32_u24 v24, 7168, v27
    v_lshl_add_u32 v24, v25, 4, v24
    v_subrev_u32 v7, 3072, v24
    buffer_load_dwordx4 v7, s[12:15], s29 offen offset:3072 lds
    v_add_u32 v23, s3, v1
    v_add_u32 v23, 256, v23
    v_mul_u32_u24 v24, 4682, v23
    v_lshrrev_b32 v24, 16, v24
    v_mul_u32_u24 v25, 14, v24
    v_sub_u32 v25, v23, v25
    v_add_u32 v25, s65, v25
    v_subrev_u32 v26, 14, v25
    v_min_u32 v25, v25, v26
    v_and_b32 v27, 0xfffffff3, v24
    v_bfe_u32 v26, v24, 2, 1
    v_lshl_or_b32 v27, v26, 3, v27
    v_bfe_u32 v26, v24, 3, 1
    v_lshl_or_b32 v27, v26, 2, v27
    v_mul_u32_u24 v24, 7168, v27
    v_lshl_add_u32 v24, v25, 4, v24
    v_subrev_u32 v8, 0, v24
    s_mov_b32 m0, s36
    s_nop 0
    buffer_load_dwordx4 v8, s[12:15], s29 offen offset:0 lds
    v_add_u32 v23, s3, v1
    v_add_u32 v23, 320, v23
    v_mul_u32_u24 v24, 4682, v23
    v_lshrrev_b32 v24, 16, v24
    v_mul_u32_u24 v25, 14, v24
    v_sub_u32 v25, v23, v25
    v_add_u32 v25, s65, v25
    v_subrev_u32 v26, 14, v25
    v_min_u32 v25, v25, v26
    v_and_b32 v27, 0xfffffff3, v24
    v_bfe_u32 v26, v24, 2, 1
    v_lshl_or_b32 v27, v26, 3, v27
    v_bfe_u32 v26, v24, 3, 1
    v_lshl_or_b32 v27, v26, 2, v27
    v_mul_u32_u24 v24, 7168, v27
    v_lshl_add_u32 v24, v25, 4, v24
    v_subrev_u32 v9, 1024, v24
    buffer_load_dwordx4 v9, s[12:15], s29 offen offset:1024 lds
    v_add_u32 v23, s3, v1
    v_add_u32 v23, 384, v23
    v_mul_u32_u24 v24, 4682, v23
    v_lshrrev_b32 v24, 16, v24
    v_mul_u32_u24 v25, 14, v24
    v_sub_u32 v25, v23, v25
    v_add_u32 v25, s65, v25
    v_subrev_u32 v26, 14, v25
    v_min_u32 v25, v25, v26
    v_and_b32 v27, 0xfffffff3, v24
    v_bfe_u32 v26, v24, 2, 1
    v_lshl_or_b32 v27, v26, 3, v27
    v_bfe_u32 v26, v24, 3, 1
    v_lshl_or_b32 v27, v26, 2, v27
    v_mul_u32_u24 v24, 7168, v27
    v_lshl_add_u32 v24, v25, 4, v24
    v_subrev_u32 v10, 2048, v24
    buffer_load_dwordx4 v10, s[12:15], s29 offen offset:2048 lds
    s_add_u32 s28, s28, 128
    s_add_u32 s29, s29, 458752
    s_mov_b32 s20, s58
    s_mov_b32 s21, s59
    s_mov_b32 s22, 35913728
    s_mov_b32 s23, 0x20000
    s_lshl_b32 s3, s24, 2
    s_add_u32 s3, s3, s26
    s_lshl_b32 s45, s3, 2
    s_lshr_b32 s3, s3, 1
    s_lshl_b32 s3, s3, 5
    s_add_u32 s3, s3, s25
    s_lshl_b32 s3, s3, 1
    s_and_b32 s60, s26, 1
    s_add_u32 s3, s3, s60
    s_lshl_b32 s65, s3, 2
    s_add_u32 s65, s65, 21594112
    s_lshl_b32 s77, s3, 3
    s_add_u32 s77, s77, 21577732
    v_mov_b32 v23, s77
    s_and_b32 s54, s2, 1
    s_xor_b32 s54, s54, 1
    s_bfe_u32 s52, s2, 0x30003
    s_bfe_u32 s3, s2, 0x10001
    s_lshl_b32 s3, s3, 3
    s_add_u32 s52, s52, s3
    s_lshr_b32 s53, s2, 6
    s_bfe_u32 s3, s2, 0x10002
    s_lshl_b32 s3, s3, 2
    s_add_u32 s53, s53, s3
    s_lshl_b32 s3, s52, 3
    s_add_u32 s3, s3, s53
    s_lshl_b32 s3, s3, 1
    s_add_u32 s3, s3, s54
    s_lshl_b32 s3, s3, 2
    s_add_u32 s3, s3, s26
    s_lshl_b32 s55, s3, 6
    s_add_u32 s55, s55, 21495808
    v_writelane_b32 v23, s55, 1
    v_mov_b32 v24, 0
    buffer_store_dword v24, v23, s[20:23], 0 offen sc1
    v_and_b32 v27, 15, v1
    v_lshlrev_b32 v27, 7, v27
    v_add_u32 v27, s32, v27
    v_bfe_u32 v28, v1, 1, 3
    v_lshrrev_b32 v29, 4, v1
    v_or_b32 v30, 0, v29
    v_xor_b32 v30, v30, v28
    v_lshl_add_u32 v11, v30, 4, v27
    v_add_u32 v13, 73984, v11
    v_or_b32 v30, 4, v29
    v_xor_b32 v30, v30, v28
    v_lshl_add_u32 v12, v30, 4, v27
    v_add_u32 v14, 73984, v12
    v_bfe_u32 v27, v1, 2, 2
    v_and_b32 v28, 3, v1
    v_bfe_u32 v30, v1, 4, 1
    v_lshrrev_b32 v31, 5, v1
    v_lshl_add_u32 v27, v31, 4, v27
    v_lshl_add_u32 v27, v30, 2, v27
    v_lshlrev_b32 v28, 3, v28
    v_mul_u32_u24 v29, 224, v27
    v_add_u32 v31, v29, v28
    v_add_u32 v19, 45056, v31
    v_add_u32 v20, 119040, v31
    s_mov_b32 s48, s56
    s_mov_b32 s49, s57
    s_mov_b32 s50, 256
    s_mov_b32 s51, 0x20000
    s_load_dwordx2 s[56:57], s[0:1], 72
    s_waitcnt vmcnt(0) lgkmcnt(0)
    s_barrier
    ds_read_b128 a[0:3], v11 offset:0
    ds_read_b128 a[4:7], v11 offset:2048
    ds_read_b128 a[8:11], v11 offset:4096
    ds_read_b128 a[12:15], v11 offset:6144
    ds_read_b64_tr_b16 a[32:33], v19 offset:64
    ds_read_b64_tr_b16 a[34:35], v19 offset:1856
    ds_read_b64_tr_b16 a[36:37], v19 offset:14528
    ds_read_b64_tr_b16 a[38:39], v19 offset:16320
    ds_read_b64_tr_b16 a[40:41], v19 offset:96
    ds_read_b64_tr_b16 a[42:43], v19 offset:1888
    s_waitcnt lgkmcnt(4)
    v_mfma_f32_16x16x32_bf16 v[32:35], a[32:35], a[0:3], 0
    ds_read_b64_tr_b16 a[44:45], v19 offset:14560
    v_mfma_f32_16x16x32_bf16 v[36:39], a[32:35], a[4:7], 0
    ds_read_b64_tr_b16 a[46:47], v19 offset:16352
    v_mfma_f32_16x16x32_bf16 v[40:43], a[32:35], a[8:11], 0
    s_add_u32 m0, s33, 73984
    s_nop 0
    buffer_load_dwordx4 v2, s[8:11], s28 offen offset:2048 lds
    v_mfma_f32_16x16x32_bf16 v[44:47], a[32:35], a[12:15], 0
    s_waitcnt lgkmcnt(4)
    v_mfma_f32_16x16x32_bf16 v[48:51], a[36:39], a[0:3], 0
    ds_read_b64_tr_b16 a[48:49], v19 offset:128
    v_mfma_f32_16x16x32_bf16 v[52:55], a[36:39], a[4:7], 0
    ds_read_b64_tr_b16 a[50:51], v19 offset:1920
    v_mfma_f32_16x16x32_bf16 v[56:59], a[36:39], a[8:11], 0
    ds_read_b128 a[16:19], v12 offset:0
    buffer_load_dwordx4 v3, s[8:11], s28 offen offset:3072 lds
    v_mfma_f32_16x16x32_bf16 v[60:63], a[36:39], a[12:15], 0
    s_waitcnt lgkmcnt(5)
    v_mfma_f32_16x16x32_bf16 v[64:67], a[40:43], a[0:3], 0
    ds_read_b64_tr_b16 a[32:33], v19 offset:14592
    v_mfma_f32_16x16x32_bf16 v[68:71], a[40:43], a[4:7], 0
    ds_read_b64_tr_b16 a[34:35], v19 offset:16384
    v_mfma_f32_16x16x32_bf16 v[72:75], a[40:43], a[8:11], 0
    s_add_u32 m0, s35, 73984
    s_nop 0
    buffer_load_dwordx4 v4, s[12:15], s29 offen offset:0 lds
    v_mfma_f32_16x16x32_bf16 v[76:79], a[40:43], a[12:15], 0
    s_waitcnt lgkmcnt(5)
    v_mfma_f32_16x16x32_bf16 v[80:83], a[44:47], a[0:3], 0
    ds_read_b64_tr_b16 a[36:37], v19 offset:160
    v_mfma_f32_16x16x32_bf16 v[84:87], a[44:47], a[4:7], 0
    ds_read_b64_tr_b16 a[38:39], v19 offset:1952
    v_mfma_f32_16x16x32_bf16 v[88:91], a[44:47], a[8:11], 0
    ds_read_b128 a[20:23], v12 offset:2048
    buffer_load_dwordx4 v5, s[12:15], s29 offen offset:1024 lds
    v_mfma_f32_16x16x32_bf16 v[92:95], a[44:47], a[12:15], 0
    s_waitcnt lgkmcnt(6)
    v_mfma_f32_16x16x32_bf16 v[96:99], a[48:51], a[0:3], 0
    ds_read_b64_tr_b16 a[40:41], v19 offset:14624
    v_mfma_f32_16x16x32_bf16 v[100:103], a[48:51], a[4:7], 0
    ds_read_b64_tr_b16 a[42:43], v19 offset:16416
    v_mfma_f32_16x16x32_bf16 v[104:107], a[48:51], a[8:11], 0
    buffer_load_dwordx4 v6, s[12:15], s29 offen offset:2048 lds
    v_mfma_f32_16x16x32_bf16 v[108:111], a[48:51], a[12:15], 0
    s_waitcnt lgkmcnt(5)
    v_mfma_f32_16x16x32_bf16 v[112:115], a[32:35], a[0:3], 0
    ds_read_b64_tr_b16 a[44:45], v19 offset:192
    v_mfma_f32_16x16x32_bf16 v[116:119], a[32:35], a[4:7], 0
    ds_read_b64_tr_b16 a[46:47], v19 offset:1984
    v_mfma_f32_16x16x32_bf16 v[120:123], a[32:35], a[8:11], 0
    ds_read_b128 a[24:27], v12 offset:4096
    buffer_load_dwordx4 v7, s[12:15], s29 offen offset:3072 lds
    v_mfma_f32_16x16x32_bf16 v[124:127], a[32:35], a[12:15], 0
    s_waitcnt lgkmcnt(6)
    v_mfma_f32_16x16x32_bf16 v[128:131], a[36:39], a[0:3], 0
    ds_read_b64_tr_b16 a[48:49], v19 offset:14656
    v_mfma_f32_16x16x32_bf16 v[132:135], a[36:39], a[4:7], 0
    ds_read_b64_tr_b16 a[50:51], v19 offset:16448
    v_mfma_f32_16x16x32_bf16 v[136:139], a[36:39], a[8:11], 0
    s_add_u32 m0, s36, 73984
    s_nop 0
    buffer_load_dwordx4 v8, s[12:15], s29 offen offset:0 lds
    v_mfma_f32_16x16x32_bf16 v[140:143], a[36:39], a[12:15], 0
    s_waitcnt lgkmcnt(5)
    v_mfma_f32_16x16x32_bf16 v[144:147], a[40:43], a[0:3], 0
    ds_read_b64_tr_b16 a[32:33], v19 offset:7232
    v_mfma_f32_16x16x32_bf16 v[148:151], a[40:43], a[4:7], 0
    ds_read_b64_tr_b16 a[34:35], v19 offset:9024
    v_mfma_f32_16x16x32_bf16 v[152:155], a[40:43], a[8:11], 0
    ds_read_b128 a[28:31], v12 offset:6144
    buffer_load_dwordx4 v9, s[12:15], s29 offen offset:1024 lds
    v_mfma_f32_16x16x32_bf16 v[156:159], a[40:43], a[12:15], 0
    s_waitcnt lgkmcnt(6)
    v_mfma_f32_16x16x32_bf16 v[160:163], a[44:47], a[0:3], 0
    ds_read_b64_tr_b16 a[36:37], v19 offset:21696
    v_mfma_f32_16x16x32_bf16 v[164:167], a[44:47], a[4:7], 0
    ds_read_b64_tr_b16 a[38:39], v19 offset:23488
    v_mfma_f32_16x16x32_bf16 v[168:171], a[44:47], a[8:11], 0
    buffer_load_dwordx4 v10, s[12:15], s29 offen offset:2048 lds
    s_add_u32 s28, s28, 128
    s_add_u32 s29, s29, 458752
    v_mfma_f32_16x16x32_bf16 v[172:175], a[44:47], a[12:15], 0
    s_waitcnt lgkmcnt(5)
    v_mfma_f32_16x16x32_bf16 v[176:179], a[48:51], a[0:3], 0
    ds_read_b64_tr_b16 a[40:41], v19 offset:7264
    v_mfma_f32_16x16x32_bf16 v[180:183], a[48:51], a[4:7], 0
    ds_read_b64_tr_b16 a[42:43], v19 offset:9056
    v_mfma_f32_16x16x32_bf16 v[184:187], a[48:51], a[8:11], 0
    buffer_load_dword v22, v21, s[68:71], s31 offen
    s_add_u32 s31, s31, s37
    v_mfma_f32_16x16x32_bf16 v[188:191], a[48:51], a[12:15], 0
    s_waitcnt lgkmcnt(4)
    v_mfma_f32_16x16x32_bf16 v[32:35], a[32:35], a[16:19], v[32:35]
    ds_read_b64_tr_b16 a[44:45], v19 offset:21728
    v_mfma_f32_16x16x32_bf16 v[36:39], a[32:35], a[20:23], v[36:39]
    ds_read_b64_tr_b16 a[46:47], v19 offset:23520
    v_mfma_f32_16x16x32_bf16 v[40:43], a[32:35], a[24:27], v[40:43]
    v_mfma_f32_16x16x32_bf16 v[44:47], a[32:35], a[28:31], v[44:47]
    s_waitcnt lgkmcnt(4)
    v_mfma_f32_16x16x32_bf16 v[48:51], a[36:39], a[16:19], v[48:51]
    ds_read_b64_tr_b16 a[48:49], v19 offset:7296
    v_mfma_f32_16x16x32_bf16 v[52:55], a[36:39], a[20:23], v[52:55]
    ds_read_b64_tr_b16 a[50:51], v19 offset:9088
    v_mfma_f32_16x16x32_bf16 v[56:59], a[36:39], a[24:27], v[56:59]
    v_mfma_f32_16x16x32_bf16 v[60:63], a[36:39], a[28:31], v[60:63]
    s_waitcnt lgkmcnt(4)
    v_mfma_f32_16x16x32_bf16 v[64:67], a[40:43], a[16:19], v[64:67]
    ds_read_b64_tr_b16 a[32:33], v19 offset:21760
    v_mfma_f32_16x16x32_bf16 v[68:71], a[40:43], a[20:23], v[68:71]
    ds_read_b64_tr_b16 a[34:35], v19 offset:23552
    v_mfma_f32_16x16x32_bf16 v[72:75], a[40:43], a[24:27], v[72:75]
    v_mfma_f32_16x16x32_bf16 v[76:79], a[40:43], a[28:31], v[76:79]
    s_waitcnt lgkmcnt(4)
    v_mfma_f32_16x16x32_bf16 v[80:83], a[44:47], a[16:19], v[80:83]
    ds_read_b64_tr_b16 a[36:37], v19 offset:7328
    v_mfma_f32_16x16x32_bf16 v[84:87], a[44:47], a[20:23], v[84:87]
    ds_read_b64_tr_b16 a[38:39], v19 offset:9120
    v_mfma_f32_16x16x32_bf16 v[88:91], a[44:47], a[24:27], v[88:91]
    v_mfma_f32_16x16x32_bf16 v[92:95], a[44:47], a[28:31], v[92:95]
    s_waitcnt lgkmcnt(4)
    v_mfma_f32_16x16x32_bf16 v[96:99], a[48:51], a[16:19], v[96:99]
    ds_read_b64_tr_b16 a[40:41], v19 offset:21792
    v_mfma_f32_16x16x32_bf16 v[100:103], a[48:51], a[20:23], v[100:103]
    ds_read_b64_tr_b16 a[42:43], v19 offset:23584
    v_mfma_f32_16x16x32_bf16 v[104:107], a[48:51], a[24:27], v[104:107]
    v_mfma_f32_16x16x32_bf16 v[108:111], a[48:51], a[28:31], v[108:111]
    s_waitcnt lgkmcnt(4)
    v_mfma_f32_16x16x32_bf16 v[112:115], a[32:35], a[16:19], v[112:115]
    ds_read_b64_tr_b16 a[44:45], v19 offset:7360
    v_mfma_f32_16x16x32_bf16 v[116:119], a[32:35], a[20:23], v[116:119]
    ds_read_b64_tr_b16 a[46:47], v19 offset:9152
    v_mfma_f32_16x16x32_bf16 v[120:123], a[32:35], a[24:27], v[120:123]
    ds_read_b64_tr_b16 a[48:49], v19 offset:21824
    v_mfma_f32_16x16x32_bf16 v[124:127], a[32:35], a[28:31], v[124:127]
    ds_read_b64_tr_b16 a[50:51], v19 offset:23616
    s_waitcnt lgkmcnt(6)
    v_mfma_f32_16x16x32_bf16 v[128:131], a[36:39], a[16:19], v[128:131]
    v_mfma_f32_16x16x32_bf16 v[132:135], a[36:39], a[20:23], v[132:135]
    v_mfma_f32_16x16x32_bf16 v[136:139], a[36:39], a[24:27], v[136:139]
    v_mfma_f32_16x16x32_bf16 v[140:143], a[36:39], a[28:31], v[140:143]
    s_waitcnt lgkmcnt(0) vmcnt(1)
    s_barrier
    v_mfma_f32_16x16x32_bf16 v[144:147], a[40:43], a[16:19], v[144:147]
    ds_read_b64_tr_b16 a[32:33], v20 offset:64
    v_mfma_f32_16x16x32_bf16 v[148:151], a[40:43], a[20:23], v[148:151]
    ds_read_b64_tr_b16 a[34:35], v20 offset:1856
    v_mfma_f32_16x16x32_bf16 v[152:155], a[40:43], a[24:27], v[152:155]
    ds_read_b128 a[0:3], v13 offset:0
    s_mov_b32 m0, s33
    s_nop 0
    buffer_load_dwordx4 v2, s[8:11], s28 offen offset:2048 lds
    v_mfma_f32_16x16x32_bf16 v[156:159], a[40:43], a[28:31], v[156:159]
    ds_read_b128 a[4:7], v13 offset:2048
    s_waitcnt lgkmcnt(6)
    v_mfma_f32_16x16x32_bf16 v[160:163], a[44:47], a[16:19], v[160:163]
    ds_read_b64_tr_b16 a[36:37], v20 offset:14528
    v_mfma_f32_16x16x32_bf16 v[164:167], a[44:47], a[20:23], v[164:167]
    ds_read_b64_tr_b16 a[38:39], v20 offset:16320
    v_mfma_f32_16x16x32_bf16 v[168:171], a[44:47], a[24:27], v[168:171]
    ds_read_b128 a[8:11], v13 offset:4096
    buffer_load_dwordx4 v3, s[8:11], s28 offen offset:3072 lds
    v_mfma_f32_16x16x32_bf16 v[172:175], a[44:47], a[28:31], v[172:175]
    ds_read_b128 a[12:15], v13 offset:6144
    s_waitcnt lgkmcnt(8)
    v_mfma_f32_16x16x32_bf16 v[176:179], a[48:51], a[16:19], v[176:179]
    ds_read_b64_tr_b16 a[40:41], v20 offset:96
    v_mfma_f32_16x16x32_bf16 v[180:183], a[48:51], a[20:23], v[180:183]
    ds_read_b64_tr_b16 a[42:43], v20 offset:1888
    v_mfma_f32_16x16x32_bf16 v[184:187], a[48:51], a[24:27], v[184:187]
    s_mov_b32 m0, s35
    s_nop 0
    buffer_load_dwordx4 v4, s[12:15], s29 offen offset:0 lds
    v_mfma_f32_16x16x32_bf16 v[188:191], a[48:51], a[28:31], v[188:191]
    s_mov_b32 s27, 0
L_k1_loop1:
    s_waitcnt lgkmcnt(2)
    v_mfma_f32_16x16x32_bf16 v[32:35], a[32:35], a[0:3], v[32:35]
    ds_read_b64_tr_b16 a[44:45], v20 offset:14560
    v_mfma_f32_16x16x32_bf16 v[36:39], a[32:35], a[4:7], v[36:39]
    ds_read_b64_tr_b16 a[46:47], v20 offset:16352
    v_mfma_f32_16x16x32_bf16 v[40:43], a[32:35], a[8:11], v[40:43]
    buffer_load_dwordx4 v5, s[12:15], s29 offen offset:1024 lds
    v_mfma_f32_16x16x32_bf16 v[44:47], a[32:35], a[12:15], v[44:47]
    s_waitcnt lgkmcnt(6)
    v_mfma_f32_16x16x32_bf16 v[48:51], a[36:39], a[0:3], v[48:51]
    ds_read_b64_tr_b16 a[48:49], v20 offset:128
    v_mfma_f32_16x16x32_bf16 v[52:55], a[36:39], a[4:7], v[52:55]
    ds_read_b64_tr_b16 a[50:51], v20 offset:1920
    v_mfma_f32_16x16x32_bf16 v[56:59], a[36:39], a[8:11], v[56:59]
    ds_read_b128 a[16:19], v14 offset:0
    buffer_load_dwordx4 v6, s[12:15], s29 offen offset:2048 lds
    v_mfma_f32_16x16x32_bf16 v[60:63], a[36:39], a[12:15], v[60:63]
    s_waitcnt lgkmcnt(5)
    v_mfma_f32_16x16x32_bf16 v[64:67], a[40:43], a[0:3], v[64:67]
    ds_read_b64_tr_b16 a[32:33], v20 offset:14592
    v_mfma_f32_16x16x32_bf16 v[68:71], a[40:43], a[4:7], v[68:71]
    ds_read_b64_tr_b16 a[34:35], v20 offset:16384
    v_mfma_f32_16x16x32_bf16 v[72:75], a[40:43], a[8:11], v[72:75]
    buffer_load_dwordx4 v7, s[12:15], s29 offen offset:3072 lds
    v_mfma_f32_16x16x32_bf16 v[76:79], a[40:43], a[12:15], v[76:79]
    s_waitcnt lgkmcnt(5)
    v_mfma_f32_16x16x32_bf16 v[80:83], a[44:47], a[0:3], v[80:83]
    ds_read_b64_tr_b16 a[36:37], v20 offset:160
    v_mfma_f32_16x16x32_bf16 v[84:87], a[44:47], a[4:7], v[84:87]
    ds_read_b64_tr_b16 a[38:39], v20 offset:1952
    v_mfma_f32_16x16x32_bf16 v[88:91], a[44:47], a[8:11], v[88:91]
    ds_read_b128 a[20:23], v14 offset:2048
    s_mov_b32 m0, s36
    s_nop 0
    buffer_load_dwordx4 v8, s[12:15], s29 offen offset:0 lds
    v_mfma_f32_16x16x32_bf16 v[92:95], a[44:47], a[12:15], v[92:95]
    s_waitcnt lgkmcnt(6)
    v_mfma_f32_16x16x32_bf16 v[96:99], a[48:51], a[0:3], v[96:99]
    ds_read_b64_tr_b16 a[40:41], v20 offset:14624
    v_mfma_f32_16x16x32_bf16 v[100:103], a[48:51], a[4:7], v[100:103]
    ds_read_b64_tr_b16 a[42:43], v20 offset:16416
    v_mfma_f32_16x16x32_bf16 v[104:107], a[48:51], a[8:11], v[104:107]
    buffer_load_dwordx4 v9, s[12:15], s29 offen offset:1024 lds
    v_mfma_f32_16x16x32_bf16 v[108:111], a[48:51], a[12:15], v[108:111]
    s_waitcnt lgkmcnt(5)
    v_mfma_f32_16x16x32_bf16 v[112:115], a[32:35], a[0:3], v[112:115]
    ds_read_b64_tr_b16 a[44:45], v20 offset:192
    v_mfma_f32_16x16x32_bf16 v[116:119], a[32:35], a[4:7], v[116:119]
    ds_read_b64_tr_b16 a[46:47], v20 offset:1984
    v_mfma_f32_16x16x32_bf16 v[120:123], a[32:35], a[8:11], v[120:123]
    ds_read_b128 a[24:27], v14 offset:4096
    buffer_load_dwordx4 v10, s[12:15], s29 offen offset:2048 lds
    s_add_u32 s28, s28, 128
    s_add_u32 s29, s29, 458752
    v_mfma_f32_16x16x32_bf16 v[124:127], a[32:35], a[12:15], v[124:127]
    s_waitcnt lgkmcnt(6)
    v_mfma_f32_16x16x32_bf16 v[128:131], a[36:39], a[0:3], v[128:131]
    ds_read_b64_tr_b16 a[48:49], v20 offset:14656
    v_mfma_f32_16x16x32_bf16 v[132:135], a[36:39], a[4:7], v[132:135]
    ds_read_b64_tr_b16 a[50:51], v20 offset:16448
    v_mfma_f32_16x16x32_bf16 v[136:139], a[36:39], a[8:11], v[136:139]
    v_mfma_f32_16x16x32_bf16 v[140:143], a[36:39], a[12:15], v[140:143]
    s_waitcnt lgkmcnt(5)
    v_mfma_f32_16x16x32_bf16 v[144:147], a[40:43], a[0:3], v[144:147]
    ds_read_b64_tr_b16 a[32:33], v20 offset:7232
    v_mfma_f32_16x16x32_bf16 v[148:151], a[40:43], a[4:7], v[148:151]
    ds_read_b64_tr_b16 a[34:35], v20 offset:9024
    v_mfma_f32_16x16x32_bf16 v[152:155], a[40:43], a[8:11], v[152:155]
    ds_read_b128 a[28:31], v14 offset:6144
    v_mfma_f32_16x16x32_bf16 v[156:159], a[40:43], a[12:15], v[156:159]
    s_waitcnt lgkmcnt(6)
    v_mfma_f32_16x16x32_bf16 v[160:163], a[44:47], a[0:3], v[160:163]
    ds_read_b64_tr_b16 a[36:37], v20 offset:21696
    v_mfma_f32_16x16x32_bf16 v[164:167], a[44:47], a[4:7], v[164:167]
    ds_read_b64_tr_b16 a[38:39], v20 offset:23488
    v_mfma_f32_16x16x32_bf16 v[168:171], a[44:47], a[8:11], v[168:171]
    v_mfma_f32_16x16x32_bf16 v[172:175], a[44:47], a[12:15], v[172:175]
    s_waitcnt lgkmcnt(5)
    v_mfma_f32_16x16x32_bf16 v[176:179], a[48:51], a[0:3], v[176:179]
    ds_read_b64_tr_b16 a[40:41], v20 offset:7264
    v_mfma_f32_16x16x32_bf16 v[180:183], a[48:51], a[4:7], v[180:183]
    ds_read_b64_tr_b16 a[42:43], v20 offset:9056
    v_mfma_f32_16x16x32_bf16 v[184:187], a[48:51], a[8:11], v[184:187]
    v_mfma_f32_16x16x32_bf16 v[188:191], a[48:51], a[12:15], v[188:191]
    s_waitcnt lgkmcnt(4)
    v_mfma_f32_16x16x32_bf16 v[32:35], a[32:35], a[16:19], v[32:35]
    ds_read_b64_tr_b16 a[44:45], v20 offset:21728
    v_mfma_f32_16x16x32_bf16 v[36:39], a[32:35], a[20:23], v[36:39]
    ds_read_b64_tr_b16 a[46:47], v20 offset:23520
    v_mfma_f32_16x16x32_bf16 v[40:43], a[32:35], a[24:27], v[40:43]
    v_mfma_f32_16x16x32_bf16 v[44:47], a[32:35], a[28:31], v[44:47]
    s_waitcnt lgkmcnt(4)
    v_mfma_f32_16x16x32_bf16 v[48:51], a[36:39], a[16:19], v[48:51]
    ds_read_b64_tr_b16 a[48:49], v20 offset:7296
    v_mfma_f32_16x16x32_bf16 v[52:55], a[36:39], a[20:23], v[52:55]
    ds_read_b64_tr_b16 a[50:51], v20 offset:9088
    v_mfma_f32_16x16x32_bf16 v[56:59], a[36:39], a[24:27], v[56:59]
    v_mfma_f32_16x16x32_bf16 v[60:63], a[36:39], a[28:31], v[60:63]
    s_waitcnt lgkmcnt(4)
    v_mfma_f32_16x16x32_bf16 v[64:67], a[40:43], a[16:19], v[64:67]
    ds_read_b64_tr_b16 a[32:33], v20 offset:21760
    v_mfma_f32_16x16x32_bf16 v[68:71], a[40:43], a[20:23], v[68:71]
    ds_read_b64_tr_b16 a[34:35], v20 offset:23552
    v_mfma_f32_16x16x32_bf16 v[72:75], a[40:43], a[24:27], v[72:75]
    v_mfma_f32_16x16x32_bf16 v[76:79], a[40:43], a[28:31], v[76:79]
    s_waitcnt lgkmcnt(4)
    v_mfma_f32_16x16x32_bf16 v[80:83], a[44:47], a[16:19], v[80:83]
    ds_read_b64_tr_b16 a[36:37], v20 offset:7328
    v_mfma_f32_16x16x32_bf16 v[84:87], a[44:47], a[20:23], v[84:87]
    ds_read_b64_tr_b16 a[38:39], v20 offset:9120
    v_mfma_f32_16x16x32_bf16 v[88:91], a[44:47], a[24:27], v[88:91]
    v_mfma_f32_16x16x32_bf16 v[92:95], a[44:47], a[28:31], v[92:95]
    s_waitcnt lgkmcnt(4)
    v_mfma_f32_16x16x32_bf16 v[96:99], a[48:51], a[16:19], v[96:99]
    ds_read_b64_tr_b16 a[40:41], v20 offset:21792
    v_mfma_f32_16x16x32_bf16 v[100:103], a[48:51], a[20:23], v[100:103]
    ds_read_b64_tr_b16 a[42:43], v20 offset:23584
    v_mfma_f32_16x16x32_bf16 v[104:107], a[48:51], a[24:27], v[104:107]
    v_mfma_f32_16x16x32_bf16 v[108:111], a[48:51], a[28:31], v[108:111]
    s_waitcnt lgkmcnt(4)
    v_mfma_f32_16x16x32_bf16 v[112:115], a[32:35], a[16:19], v[112:115]
    ds_read_b64_tr_b16 a[44:45], v20 offset:7360
    v_mfma_f32_16x16x32_bf16 v[116:119], a[32:35], a[20:23], v[116:119]
    ds_read_b64_tr_b16 a[46:47], v20 offset:9152
    v_mfma_f32_16x16x32_bf16 v[120:123], a[32:35], a[24:27], v[120:123]
    ds_read_b64_tr_b16 a[48:49], v20 offset:21824
    v_mfma_f32_16x16x32_bf16 v[124:127], a[32:35], a[28:31], v[124:127]
    ds_read_b64_tr_b16 a[50:51], v20 offset:23616
    s_waitcnt lgkmcnt(6)
    v_mfma_f32_16x16x32_bf16 v[128:131], a[36:39], a[16:19], v[128:131]
    v_mfma_f32_16x16x32_bf16 v[132:135], a[36:39], a[20:23], v[132:135]
    v_mfma_f32_16x16x32_bf16 v[136:139], a[36:39], a[24:27], v[136:139]
    v_mfma_f32_16x16x32_bf16 v[140:143], a[36:39], a[28:31], v[140:143]
    s_waitcnt lgkmcnt(0) vmcnt(0)
    s_barrier
    v_mfma_f32_16x16x32_bf16 v[144:147], a[40:43], a[16:19], v[144:147]
    ds_read_b64_tr_b16 a[32:33], v19 offset:64
    v_mfma_f32_16x16x32_bf16 v[148:151], a[40:43], a[20:23], v[148:151]
    ds_read_b64_tr_b16 a[34:35], v19 offset:1856
    v_mfma_f32_16x16x32_bf16 v[152:155], a[40:43], a[24:27], v[152:155]
    ds_read_b128 a[0:3], v11 offset:0
    s_add_u32 m0, s33, 73984
    s_nop 0
    buffer_load_dwordx4 v2, s[8:11], s28 offen offset:2048 lds
    v_mfma_f32_16x16x32_bf16 v[156:159], a[40:43], a[28:31], v[156:159]
    ds_read_b128 a[4:7], v11 offset:2048
    s_waitcnt lgkmcnt(6)
    v_mfma_f32_16x16x32_bf16 v[160:163], a[44:47], a[16:19], v[160:163]
    ds_read_b64_tr_b16 a[36:37], v19 offset:14528
    v_mfma_f32_16x16x32_bf16 v[164:167], a[44:47], a[20:23], v[164:167]
    ds_read_b64_tr_b16 a[38:39], v19 offset:16320
    v_mfma_f32_16x16x32_bf16 v[168:171], a[44:47], a[24:27], v[168:171]
    ds_read_b128 a[8:11], v11 offset:4096
    buffer_load_dwordx4 v3, s[8:11], s28 offen offset:3072 lds
    v_mfma_f32_16x16x32_bf16 v[172:175], a[44:47], a[28:31], v[172:175]
    ds_read_b128 a[12:15], v11 offset:6144
    s_waitcnt lgkmcnt(8)
    v_mfma_f32_16x16x32_bf16 v[176:179], a[48:51], a[16:19], v[176:179]
    ds_read_b64_tr_b16 a[40:41], v19 offset:96
    v_mfma_f32_16x16x32_bf16 v[180:183], a[48:51], a[20:23], v[180:183]
    ds_read_b64_tr_b16 a[42:43], v19 offset:1888
    v_mfma_f32_16x16x32_bf16 v[184:187], a[48:51], a[24:27], v[184:187]
    s_add_u32 m0, s35, 73984
    s_nop 0
    buffer_load_dwordx4 v4, s[12:15], s29 offen offset:0 lds
    v_mfma_f32_16x16x32_bf16 v[188:191], a[48:51], a[28:31], v[188:191]
    s_waitcnt lgkmcnt(2)
    v_mfma_f32_16x16x32_bf16 v[32:35], a[32:35], a[0:3], v[32:35]
    ds_read_b64_tr_b16 a[44:45], v19 offset:14560
    v_mfma_f32_16x16x32_bf16 v[36:39], a[32:35], a[4:7], v[36:39]
    ds_read_b64_tr_b16 a[46:47], v19 offset:16352
    v_mfma_f32_16x16x32_bf16 v[40:43], a[32:35], a[8:11], v[40:43]
    buffer_load_dwordx4 v5, s[12:15], s29 offen offset:1024 lds
    v_mfma_f32_16x16x32_bf16 v[44:47], a[32:35], a[12:15], v[44:47]
    s_waitcnt lgkmcnt(6)
    v_mfma_f32_16x16x32_bf16 v[48:51], a[36:39], a[0:3], v[48:51]
    ds_read_b64_tr_b16 a[48:49], v19 offset:128
    v_mfma_f32_16x16x32_bf16 v[52:55], a[36:39], a[4:7], v[52:55]
    ds_read_b64_tr_b16 a[50:51], v19 offset:1920
    v_mfma_f32_16x16x32_bf16 v[56:59], a[36:39], a[8:11], v[56:59]
    ds_read_b128 a[16:19], v12 offset:0
    buffer_load_dwordx4 v6, s[12:15], s29 offen offset:2048 lds
    v_mfma_f32_16x16x32_bf16 v[60:63], a[36:39], a[12:15], v[60:63]
    s_waitcnt lgkmcnt(5)
    v_mfma_f32_16x16x32_bf16 v[64:67], a[40:43], a[0:3], v[64:67]
    ds_read_b64_tr_b16 a[32:33], v19 offset:14592
    v_mfma_f32_16x16x32_bf16 v[68:71], a[40:43], a[4:7], v[68:71]
    ds_read_b64_tr_b16 a[34:35], v19 offset:16384
    v_mfma_f32_16x16x32_bf16 v[72:75], a[40:43], a[8:11], v[72:75]
    buffer_load_dwordx4 v7, s[12:15], s29 offen offset:3072 lds
    v_mfma_f32_16x16x32_bf16 v[76:79], a[40:43], a[12:15], v[76:79]
    s_waitcnt lgkmcnt(5)
    v_mfma_f32_16x16x32_bf16 v[80:83], a[44:47], a[0:3], v[80:83]
    ds_read_b64_tr_b16 a[36:37], v19 offset:160
    v_mfma_f32_16x16x32_bf16 v[84:87], a[44:47], a[4:7], v[84:87]
    ds_read_b64_tr_b16 a[38:39], v19 offset:1952
    v_mfma_f32_16x16x32_bf16 v[88:91], a[44:47], a[8:11], v[88:91]
    ds_read_b128 a[20:23], v12 offset:2048
    s_add_u32 m0, s36, 73984
    s_nop 0
    buffer_load_dwordx4 v8, s[12:15], s29 offen offset:0 lds
    v_mfma_f32_16x16x32_bf16 v[92:95], a[44:47], a[12:15], v[92:95]
    s_waitcnt lgkmcnt(6)
    v_mfma_f32_16x16x32_bf16 v[96:99], a[48:51], a[0:3], v[96:99]
    ds_read_b64_tr_b16 a[40:41], v19 offset:14624
    v_mfma_f32_16x16x32_bf16 v[100:103], a[48:51], a[4:7], v[100:103]
    ds_read_b64_tr_b16 a[42:43], v19 offset:16416
    v_mfma_f32_16x16x32_bf16 v[104:107], a[48:51], a[8:11], v[104:107]
    buffer_load_dwordx4 v9, s[12:15], s29 offen offset:1024 lds
    v_mfma_f32_16x16x32_bf16 v[108:111], a[48:51], a[12:15], v[108:111]
    s_waitcnt lgkmcnt(5)
    v_mfma_f32_16x16x32_bf16 v[112:115], a[32:35], a[0:3], v[112:115]
    ds_read_b64_tr_b16 a[44:45], v19 offset:192
    v_mfma_f32_16x16x32_bf16 v[116:119], a[32:35], a[4:7], v[116:119]
    ds_read_b64_tr_b16 a[46:47], v19 offset:1984
    v_mfma_f32_16x16x32_bf16 v[120:123], a[32:35], a[8:11], v[120:123]
    ds_read_b128 a[24:27], v12 offset:4096
    buffer_load_dwordx4 v10, s[12:15], s29 offen offset:2048 lds
    s_add_u32 s28, s28, 128
    s_add_u32 s29, s29, 458752
    v_mfma_f32_16x16x32_bf16 v[124:127], a[32:35], a[12:15], v[124:127]
    s_waitcnt lgkmcnt(6)
    v_mfma_f32_16x16x32_bf16 v[128:131], a[36:39], a[0:3], v[128:131]
    ds_read_b64_tr_b16 a[48:49], v19 offset:14656
    v_mfma_f32_16x16x32_bf16 v[132:135], a[36:39], a[4:7], v[132:135]
    ds_read_b64_tr_b16 a[50:51], v19 offset:16448
    v_mfma_f32_16x16x32_bf16 v[136:139], a[36:39], a[8:11], v[136:139]
    buffer_load_dword v22, v21, s[68:71], s31 offen
    s_add_u32 s31, s31, s37
    v_mfma_f32_16x16x32_bf16 v[140:143], a[36:39], a[12:15], v[140:143]
    s_waitcnt lgkmcnt(5)
    v_mfma_f32_16x16x32_bf16 v[144:147], a[40:43], a[0:3], v[144:147]
    ds_read_b64_tr_b16 a[32:33], v19 offset:7232
    v_mfma_f32_16x16x32_bf16 v[148:151], a[40:43], a[4:7], v[148:151]
    ds_read_b64_tr_b16 a[34:35], v19 offset:9024
    v_mfma_f32_16x16x32_bf16 v[152:155], a[40:43], a[8:11], v[152:155]
    ds_read_b128 a[28:31], v12 offset:6144
    v_mfma_f32_16x16x32_bf16 v[156:159], a[40:43], a[12:15], v[156:159]
    s_waitcnt lgkmcnt(6)
    v_mfma_f32_16x16x32_bf16 v[160:163], a[44:47], a[0:3], v[160:163]
    ds_read_b64_tr_b16 a[36:37], v19 offset:21696
    v_mfma_f32_16x16x32_bf16 v[164:167], a[44:47], a[4:7], v[164:167]
    ds_read_b64_tr_b16 a[38:39], v19 offset:23488
    v_mfma_f32_16x16x32_bf16 v[168:171], a[44:47], a[8:11], v[168:171]
    v_mfma_f32_16x16x32_bf16 v[172:175], a[44:47], a[12:15], v[172:175]
    s_waitcnt lgkmcnt(5)
    v_mfma_f32_16x16x32_bf16 v[176:179], a[48:51], a[0:3], v[176:179]
    ds_read_b64_tr_b16 a[40:41], v19 offset:7264
    v_mfma_f32_16x16x32_bf16 v[180:183], a[48:51], a[4:7], v[180:183]
    ds_read_b64_tr_b16 a[42:43], v19 offset:9056
    v_mfma_f32_16x16x32_bf16 v[184:187], a[48:51], a[8:11], v[184:187]
    v_mfma_f32_16x16x32_bf16 v[188:191], a[48:51], a[12:15], v[188:191]
    s_waitcnt lgkmcnt(4)
    v_mfma_f32_16x16x32_bf16 v[32:35], a[32:35], a[16:19], v[32:35]
    ds_read_b64_tr_b16 a[44:45], v19 offset:21728
    v_mfma_f32_16x16x32_bf16 v[36:39], a[32:35], a[20:23], v[36:39]
    ds_read_b64_tr_b16 a[46:47], v19 offset:23520
    v_mfma_f32_16x16x32_bf16 v[40:43], a[32:35], a[24:27], v[40:43]
    v_mfma_f32_16x16x32_bf16 v[44:47], a[32:35], a[28:31], v[44:47]
    s_waitcnt lgkmcnt(4)
    v_mfma_f32_16x16x32_bf16 v[48:51], a[36:39], a[16:19], v[48:51]
    ds_read_b64_tr_b16 a[48:49], v19 offset:7296
    v_mfma_f32_16x16x32_bf16 v[52:55], a[36:39], a[20:23], v[52:55]
    ds_read_b64_tr_b16 a[50:51], v19 offset:9088
    v_mfma_f32_16x16x32_bf16 v[56:59], a[36:39], a[24:27], v[56:59]
    v_mfma_f32_16x16x32_bf16 v[60:63], a[36:39], a[28:31], v[60:63]
    s_waitcnt lgkmcnt(4)
    v_mfma_f32_16x16x32_bf16 v[64:67], a[40:43], a[16:19], v[64:67]
    ds_read_b64_tr_b16 a[32:33], v19 offset:21760
    v_mfma_f32_16x16x32_bf16 v[68:71], a[40:43], a[20:23], v[68:71]
    ds_read_b64_tr_b16 a[34:35], v19 offset:23552
    v_mfma_f32_16x16x32_bf16 v[72:75], a[40:43], a[24:27], v[72:75]
    v_mfma_f32_16x16x32_bf16 v[76:79], a[40:43], a[28:31], v[76:79]
    s_waitcnt lgkmcnt(4)
    v_mfma_f32_16x16x32_bf16 v[80:83], a[44:47], a[16:19], v[80:83]
    ds_read_b64_tr_b16 a[36:37], v19 offset:7328
    v_mfma_f32_16x16x32_bf16 v[84:87], a[44:47], a[20:23], v[84:87]
    ds_read_b64_tr_b16 a[38:39], v19 offset:9120
    v_mfma_f32_16x16x32_bf16 v[88:91], a[44:47], a[24:27], v[88:91]
    v_mfma_f32_16x16x32_bf16 v[92:95], a[44:47], a[28:31], v[92:95]
    s_waitcnt lgkmcnt(4)
    v_mfma_f32_16x16x32_bf16 v[96:99], a[48:51], a[16:19], v[96:99]
    ds_read_b64_tr_b16 a[40:41], v19 offset:21792
    v_mfma_f32_16x16x32_bf16 v[100:103], a[48:51], a[20:23], v[100:103]
    ds_read_b64_tr_b16 a[42:43], v19 offset:23584
    v_mfma_f32_16x16x32_bf16 v[104:107], a[48:51], a[24:27], v[104:107]
    v_mfma_f32_16x16x32_bf16 v[108:111], a[48:51], a[28:31], v[108:111]
    s_waitcnt lgkmcnt(4)
    v_mfma_f32_16x16x32_bf16 v[112:115], a[32:35], a[16:19], v[112:115]
    ds_read_b64_tr_b16 a[44:45], v19 offset:7360
    v_mfma_f32_16x16x32_bf16 v[116:119], a[32:35], a[20:23], v[116:119]
    ds_read_b64_tr_b16 a[46:47], v19 offset:9152
    v_mfma_f32_16x16x32_bf16 v[120:123], a[32:35], a[24:27], v[120:123]
    ds_read_b64_tr_b16 a[48:49], v19 offset:21824
    v_mfma_f32_16x16x32_bf16 v[124:127], a[32:35], a[28:31], v[124:127]
    ds_read_b64_tr_b16 a[50:51], v19 offset:23616
    s_waitcnt lgkmcnt(6)
    v_mfma_f32_16x16x32_bf16 v[128:131], a[36:39], a[16:19], v[128:131]
    v_mfma_f32_16x16x32_bf16 v[132:135], a[36:39], a[20:23], v[132:135]
    v_mfma_f32_16x16x32_bf16 v[136:139], a[36:39], a[24:27], v[136:139]
    v_mfma_f32_16x16x32_bf16 v[140:143], a[36:39], a[28:31], v[140:143]
    s_waitcnt lgkmcnt(0) vmcnt(1)
    s_barrier
    v_mfma_f32_16x16x32_bf16 v[144:147], a[40:43], a[16:19], v[144:147]
    ds_read_b64_tr_b16 a[32:33], v20 offset:64
    v_mfma_f32_16x16x32_bf16 v[148:151], a[40:43], a[20:23], v[148:151]
    ds_read_b64_tr_b16 a[34:35], v20 offset:1856
    v_mfma_f32_16x16x32_bf16 v[152:155], a[40:43], a[24:27], v[152:155]
    ds_read_b128 a[0:3], v13 offset:0
    s_mov_b32 m0, s33
    s_nop 0
    buffer_load_dwordx4 v2, s[8:11], s28 offen offset:2048 lds
    v_mfma_f32_16x16x32_bf16 v[156:159], a[40:43], a[28:31], v[156:159]
    ds_read_b128 a[4:7], v13 offset:2048
    s_waitcnt lgkmcnt(6)
    v_mfma_f32_16x16x32_bf16 v[160:163], a[44:47], a[16:19], v[160:163]
    ds_read_b64_tr_b16 a[36:37], v20 offset:14528
    v_mfma_f32_16x16x32_bf16 v[164:167], a[44:47], a[20:23], v[164:167]
    ds_read_b64_tr_b16 a[38:39], v20 offset:16320
    v_mfma_f32_16x16x32_bf16 v[168:171], a[44:47], a[24:27], v[168:171]
    ds_read_b128 a[8:11], v13 offset:4096
    buffer_load_dwordx4 v3, s[8:11], s28 offen offset:3072 lds
    v_mfma_f32_16x16x32_bf16 v[172:175], a[44:47], a[28:31], v[172:175]
    ds_read_b128 a[12:15], v13 offset:6144
    s_waitcnt lgkmcnt(8)
    v_mfma_f32_16x16x32_bf16 v[176:179], a[48:51], a[16:19], v[176:179]
    ds_read_b64_tr_b16 a[40:41], v20 offset:96
    v_mfma_f32_16x16x32_bf16 v[180:183], a[48:51], a[20:23], v[180:183]
    ds_read_b64_tr_b16 a[42:43], v20 offset:1888
    v_mfma_f32_16x16x32_bf16 v[184:187], a[48:51], a[24:27], v[184:187]
    s_mov_b32 m0, s35
    s_nop 0
    buffer_load_dwordx4 v4, s[12:15], s29 offen offset:0 lds
    v_mfma_f32_16x16x32_bf16 v[188:191], a[48:51], a[28:31], v[188:191]
    s_add_u32 s27, s27, 1
    s_cmp_lt_u32 s27, 6
    s_cbranch_scc1 L_k1_loop1
    s_waitcnt lgkmcnt(2)
    v_mfma_f32_16x16x32_bf16 v[32:35], a[32:35], a[0:3], v[32:35]
    ds_read_b64_tr_b16 a[44:45], v20 offset:14560
    v_mfma_f32_16x16x32_bf16 v[36:39], a[32:35], a[4:7], v[36:39]
    ds_read_b64_tr_b16 a[46:47], v20 offset:16352
    v_mfma_f32_16x16x32_bf16 v[40:43], a[32:35], a[8:11], v[40:43]
    buffer_load_dwordx4 v5, s[12:15], s29 offen offset:1024 lds
    v_mfma_f32_16x16x32_bf16 v[44:47], a[32:35], a[12:15], v[44:47]
    s_waitcnt lgkmcnt(6)
    v_mfma_f32_16x16x32_bf16 v[48:51], a[36:39], a[0:3], v[48:51]
    ds_read_b64_tr_b16 a[48:49], v20 offset:128
    v_mfma_f32_16x16x32_bf16 v[52:55], a[36:39], a[4:7], v[52:55]
    ds_read_b64_tr_b16 a[50:51], v20 offset:1920
    v_mfma_f32_16x16x32_bf16 v[56:59], a[36:39], a[8:11], v[56:59]
    ds_read_b128 a[16:19], v14 offset:0
    buffer_load_dwordx4 v6, s[12:15], s29 offen offset:2048 lds
    v_mfma_f32_16x16x32_bf16 v[60:63], a[36:39], a[12:15], v[60:63]
    s_waitcnt lgkmcnt(5)
    v_mfma_f32_16x16x32_bf16 v[64:67], a[40:43], a[0:3], v[64:67]
    ds_read_b64_tr_b16 a[32:33], v20 offset:14592
    v_mfma_f32_16x16x32_bf16 v[68:71], a[40:43], a[4:7], v[68:71]
    ds_read_b64_tr_b16 a[34:35], v20 offset:16384
    v_mfma_f32_16x16x32_bf16 v[72:75], a[40:43], a[8:11], v[72:75]
    buffer_load_dwordx4 v7, s[12:15], s29 offen offset:3072 lds
    v_mfma_f32_16x16x32_bf16 v[76:79], a[40:43], a[12:15], v[76:79]
    s_waitcnt lgkmcnt(5)
    v_mfma_f32_16x16x32_bf16 v[80:83], a[44:47], a[0:3], v[80:83]
    ds_read_b64_tr_b16 a[36:37], v20 offset:160
    v_mfma_f32_16x16x32_bf16 v[84:87], a[44:47], a[4:7], v[84:87]
    ds_read_b64_tr_b16 a[38:39], v20 offset:1952
    v_mfma_f32_16x16x32_bf16 v[88:91], a[44:47], a[8:11], v[88:91]
    ds_read_b128 a[20:23], v14 offset:2048
    s_mov_b32 m0, s36
    s_nop 0
    buffer_load_dwordx4 v8, s[12:15], s29 offen offset:0 lds
    v_mfma_f32_16x16x32_bf16 v[92:95], a[44:47], a[12:15], v[92:95]
    s_waitcnt lgkmcnt(6)
    v_mfma_f32_16x16x32_bf16 v[96:99], a[48:51], a[0:3], v[96:99]
    ds_read_b64_tr_b16 a[40:41], v20 offset:14624
    v_mfma_f32_16x16x32_bf16 v[100:103], a[48:51], a[4:7], v[100:103]
    ds_read_b64_tr_b16 a[42:43], v20 offset:16416
    v_mfma_f32_16x16x32_bf16 v[104:107], a[48:51], a[8:11], v[104:107]
    buffer_load_dwordx4 v9, s[12:15], s29 offen offset:1024 lds
    v_mfma_f32_16x16x32_bf16 v[108:111], a[48:51], a[12:15], v[108:111]
    s_waitcnt lgkmcnt(5)
    v_mfma_f32_16x16x32_bf16 v[112:115], a[32:35], a[0:3], v[112:115]
    ds_read_b64_tr_b16 a[44:45], v20 offset:192
    v_mfma_f32_16x16x32_bf16 v[116:119], a[32:35], a[4:7], v[116:119]
    ds_read_b64_tr_b16 a[46:47], v20 offset:1984
    v_mfma_f32_16x16x32_bf16 v[120:123], a[32:35], a[8:11], v[120:123]
    ds_read_b128 a[24:27], v14 offset:4096
    buffer_load_dwordx4 v10, s[12:15], s29 offen offset:2048 lds
    s_add_u32 s28, s28, 128
    s_add_u32 s29, s29, 458752
    v_mfma_f32_16x16x32_bf16 v[124:127], a[32:35], a[12:15], v[124:127]
    s_waitcnt lgkmcnt(6)
    v_mfma_f32_16x16x32_bf16 v[128:131], a[36:39], a[0:3], v[128:131]
    ds_read_b64_tr_b16 a[48:49], v20 offset:14656
    v_mfma_f32_16x16x32_bf16 v[132:135], a[36:39], a[4:7], v[132:135]
    ds_read_b64_tr_b16 a[50:51], v20 offset:16448
    v_mfma_f32_16x16x32_bf16 v[136:139], a[36:39], a[8:11], v[136:139]
    buffer_load_dword v22, v21, s[68:71], s31 offen
    s_add_u32 s31, s31, s37
    v_mfma_f32_16x16x32_bf16 v[140:143], a[36:39], a[12:15], v[140:143]
    s_waitcnt lgkmcnt(5)
    v_mfma_f32_16x16x32_bf16 v[144:147], a[40:43], a[0:3], v[144:147]
    ds_read_b64_tr_b16 a[32:33], v20 offset:7232
    v_mfma_f32_16x16x32_bf16 v[148:151], a[40:43], a[4:7], v[148:151]
    ds_read_b64_tr_b16 a[34:35], v20 offset:9024
    v_mfma_f32_16x16x32_bf16 v[152:155], a[40:43], a[8:11], v[152:155]
    ds_read_b128 a[28:31], v14 offset:6144
    v_mfma_f32_16x16x32_bf16 v[156:159], a[40:43], a[12:15], v[156:159]
    s_waitcnt lgkmcnt(6)
    v_mfma_f32_16x16x32_bf16 v[160:163], a[44:47], a[0:3], v[160:163]
    ds_read_b64_tr_b16 a[36:37], v20 offset:21696
    v_mfma_f32_16x16x32_bf16 v[164:167], a[44:47], a[4:7], v[164:167]
    ds_read_b64_tr_b16 a[38:39], v20 offset:23488
    v_mfma_f32_16x16x32_bf16 v[168:171], a[44:47], a[8:11], v[168:171]
    v_mfma_f32_16x16x32_bf16 v[172:175], a[44:47], a[12:15], v[172:175]
    s_waitcnt lgkmcnt(5)
    v_mfma_f32_16x16x32_bf16 v[176:179], a[48:51], a[0:3], v[176:179]
    ds_read_b64_tr_b16 a[40:41], v20 offset:7264
    v_mfma_f32_16x16x32_bf16 v[180:183], a[48:51], a[4:7], v[180:183]
    ds_read_b64_tr_b16 a[42:43], v20 offset:9056
    v_mfma_f32_16x16x32_bf16 v[184:187], a[48:51], a[8:11], v[184:187]
    v_mfma_f32_16x16x32_bf16 v[188:191], a[48:51], a[12:15], v[188:191]
    s_waitcnt lgkmcnt(4)
    v_mfma_f32_16x16x32_bf16 v[32:35], a[32:35], a[16:19], v[32:35]
    ds_read_b64_tr_b16 a[44:45], v20 offset:21728
    v_mfma_f32_16x16x32_bf16 v[36:39], a[32:35], a[20:23], v[36:39]
    ds_read_b64_tr_b16 a[46:47], v20 offset:23520
    v_mfma_f32_16x16x32_bf16 v[40:43], a[32:35], a[24:27], v[40:43]
    v_mfma_f32_16x16x32_bf16 v[44:47], a[32:35], a[28:31], v[44:47]
    s_waitcnt lgkmcnt(4)
    v_mfma_f32_16x16x32_bf16 v[48:51], a[36:39], a[16:19], v[48:51]
    ds_read_b64_tr_b16 a[48:49], v20 offset:7296
    v_mfma_f32_16x16x32_bf16 v[52:55], a[36:39], a[20:23], v[52:55]
    ds_read_b64_tr_b16 a[50:51], v20 offset:9088
    v_mfma_f32_16x16x32_bf16 v[56:59], a[36:39], a[24:27], v[56:59]
    v_mfma_f32_16x16x32_bf16 v[60:63], a[36:39], a[28:31], v[60:63]
    s_waitcnt lgkmcnt(4)
    v_mfma_f32_16x16x32_bf16 v[64:67], a[40:43], a[16:19], v[64:67]
    ds_read_b64_tr_b16 a[32:33], v20 offset:21760
    v_mfma_f32_16x16x32_bf16 v[68:71], a[40:43], a[20:23], v[68:71]
    ds_read_b64_tr_b16 a[34:35], v20 offset:23552
    v_mfma_f32_16x16x32_bf16 v[72:75], a[40:43], a[24:27], v[72:75]
    v_mfma_f32_16x16x32_bf16 v[76:79], a[40:43], a[28:31], v[76:79]
    s_waitcnt lgkmcnt(4)
    v_mfma_f32_16x16x32_bf16 v[80:83], a[44:47], a[16:19], v[80:83]
    ds_read_b64_tr_b16 a[36:37], v20 offset:7328
    v_mfma_f32_16x16x32_bf16 v[84:87], a[44:47], a[20:23], v[84:87]
    ds_read_b64_tr_b16 a[38:39], v20 offset:9120
    v_mfma_f32_16x16x32_bf16 v[88:91], a[44:47], a[24:27], v[88:91]
    v_mfma_f32_16x16x32_bf16 v[92:95], a[44:47], a[28:31], v[92:95]
    s_waitcnt lgkmcnt(4)
    v_mfma_f32_16x16x32_bf16 v[96:99], a[48:51], a[16:19], v[96:99]
    ds_read_b64_tr_b16 a[40:41], v20 offset:21792
    v_mfma_f32_16x16x32_bf16 v[100:103], a[48:51], a[20:23], v[100:103]
    ds_read_b64_tr_b16 a[42:43], v20 offset:23584
    v_mfma_f32_16x16x32_bf16 v[104:107], a[48:51], a[24:27], v[104:107]
    v_mfma_f32_16x16x32_bf16 v[108:111], a[48:51], a[28:31], v[108:111]
    s_waitcnt lgkmcnt(4)
    v_mfma_f32_16x16x32_bf16 v[112:115], a[32:35], a[16:19], v[112:115]
    ds_read_b64_tr_b16 a[44:45], v20 offset:7360
    v_mfma_f32_16x16x32_bf16 v[116:119], a[32:35], a[20:23], v[116:119]
    ds_read_b64_tr_b16 a[46:47], v20 offset:9152
    v_mfma_f32_16x16x32_bf16 v[120:123], a[32:35], a[24:27], v[120:123]
    ds_read_b64_tr_b16 a[48:49], v20 offset:21824
    v_mfma_f32_16x16x32_bf16 v[124:127], a[32:35], a[28:31], v[124:127]
    ds_read_b64_tr_b16 a[50:51], v20 offset:23616
    s_waitcnt lgkmcnt(6)
    v_mfma_f32_16x16x32_bf16 v[128:131], a[36:39], a[16:19], v[128:131]
    v_mfma_f32_16x16x32_bf16 v[132:135], a[36:39], a[20:23], v[132:135]
    v_mfma_f32_16x16x32_bf16 v[136:139], a[36:39], a[24:27], v[136:139]
    v_mfma_f32_16x16x32_bf16 v[140:143], a[36:39], a[28:31], v[140:143]
    s_waitcnt lgkmcnt(0) vmcnt(1)
    s_barrier
    v_mfma_f32_16x16x32_bf16 v[144:147], a[40:43], a[16:19], v[144:147]
    ds_read_b64_tr_b16 a[32:33], v19 offset:64
    v_mfma_f32_16x16x32_bf16 v[148:151], a[40:43], a[20:23], v[148:151]
    ds_read_b64_tr_b16 a[34:35], v19 offset:1856
    v_mfma_f32_16x16x32_bf16 v[152:155], a[40:43], a[24:27], v[152:155]
    ds_read_b128 a[0:3], v11 offset:0
    s_add_u32 m0, s33, 73984
    s_nop 0
    buffer_load_dwordx4 v2, s[8:11], s28 offen offset:2048 lds
    v_mfma_f32_16x16x32_bf16 v[156:159], a[40:43], a[28:31], v[156:159]
    ds_read_b128 a[4:7], v11 offset:2048
    s_waitcnt lgkmcnt(6)
    v_mfma_f32_16x16x32_bf16 v[160:163], a[44:47], a[16:19], v[160:163]
    ds_read_b64_tr_b16 a[36:37], v19 offset:14528
    v_mfma_f32_16x16x32_bf16 v[164:167], a[44:47], a[20:23], v[164:167]
    ds_read_b64_tr_b16 a[38:39], v19 offset:16320
    v_mfma_f32_16x16x32_bf16 v[168:171], a[44:47], a[24:27], v[168:171]
    ds_read_b128 a[8:11], v11 offset:4096
    buffer_load_dwordx4 v3, s[8:11], s28 offen offset:3072 lds
    v_mfma_f32_16x16x32_bf16 v[172:175], a[44:47], a[28:31], v[172:175]
    ds_read_b128 a[12:15], v11 offset:6144
    s_waitcnt lgkmcnt(8)
    v_mfma_f32_16x16x32_bf16 v[176:179], a[48:51], a[16:19], v[176:179]
    ds_read_b64_tr_b16 a[40:41], v19 offset:96
    v_mfma_f32_16x16x32_bf16 v[180:183], a[48:51], a[20:23], v[180:183]
    ds_read_b64_tr_b16 a[42:43], v19 offset:1888
    v_mfma_f32_16x16x32_bf16 v[184:187], a[48:51], a[24:27], v[184:187]
    s_add_u32 m0, s35, 73984
    s_nop 0
    buffer_load_dwordx4 v4, s[12:15], s29 offen offset:0 lds
    v_mfma_f32_16x16x32_bf16 v[188:191], a[48:51], a[28:31], v[188:191]
    s_waitcnt lgkmcnt(2)
    v_mfma_f32_16x16x32_bf16 v[32:35], a[32:35], a[0:3], v[32:35]
    ds_read_b64_tr_b16 a[44:45], v19 offset:14560
    v_mfma_f32_16x16x32_bf16 v[36:39], a[32:35], a[4:7], v[36:39]
    ds_read_b64_tr_b16 a[46:47], v19 offset:16352
    v_mfma_f32_16x16x32_bf16 v[40:43], a[32:35], a[8:11], v[40:43]
    buffer_load_dwordx4 v5, s[12:15], s29 offen offset:1024 lds
    v_mfma_f32_16x16x32_bf16 v[44:47], a[32:35], a[12:15], v[44:47]
    s_waitcnt lgkmcnt(6)
    v_mfma_f32_16x16x32_bf16 v[48:51], a[36:39], a[0:3], v[48:51]
    ds_read_b64_tr_b16 a[48:49], v19 offset:128
    v_mfma_f32_16x16x32_bf16 v[52:55], a[36:39], a[4:7], v[52:55]
    ds_read_b64_tr_b16 a[50:51], v19 offset:1920
    v_mfma_f32_16x16x32_bf16 v[56:59], a[36:39], a[8:11], v[56:59]
    ds_read_b128 a[16:19], v12 offset:0
    buffer_load_dwordx4 v6, s[12:15], s29 offen offset:2048 lds
    v_mfma_f32_16x16x32_bf16 v[60:63], a[36:39], a[12:15], v[60:63]
    s_waitcnt lgkmcnt(5)
    v_mfma_f32_16x16x32_bf16 v[64:67], a[40:43], a[0:3], v[64:67]
    ds_read_b64_tr_b16 a[32:33], v19 offset:14592
    v_mfma_f32_16x16x32_bf16 v[68:71], a[40:43], a[4:7], v[68:71]
    ds_read_b64_tr_b16 a[34:35], v19 offset:16384
    v_mfma_f32_16x16x32_bf16 v[72:75], a[40:43], a[8:11], v[72:75]
    buffer_load_dwordx4 v7, s[12:15], s29 offen offset:3072 lds
    v_mfma_f32_16x16x32_bf16 v[76:79], a[40:43], a[12:15], v[76:79]
    s_waitcnt lgkmcnt(5)
    v_mfma_f32_16x16x32_bf16 v[80:83], a[44:47], a[0:3], v[80:83]
    ds_read_b64_tr_b16 a[36:37], v19 offset:160
    v_mfma_f32_16x16x32_bf16 v[84:87], a[44:47], a[4:7], v[84:87]
    ds_read_b64_tr_b16 a[38:39], v19 offset:1952
    v_mfma_f32_16x16x32_bf16 v[88:91], a[44:47], a[8:11], v[88:91]
    ds_read_b128 a[20:23], v12 offset:2048
    s_add_u32 m0, s36, 73984
    s_nop 0
    buffer_load_dwordx4 v8, s[12:15], s29 offen offset:0 lds
    v_mfma_f32_16x16x32_bf16 v[92:95], a[44:47], a[12:15], v[92:95]
    s_waitcnt lgkmcnt(6)
    v_mfma_f32_16x16x32_bf16 v[96:99], a[48:51], a[0:3], v[96:99]
    ds_read_b64_tr_b16 a[40:41], v19 offset:14624
    v_mfma_f32_16x16x32_bf16 v[100:103], a[48:51], a[4:7], v[100:103]
    ds_read_b64_tr_b16 a[42:43], v19 offset:16416
    v_mfma_f32_16x16x32_bf16 v[104:107], a[48:51], a[8:11], v[104:107]
    buffer_load_dwordx4 v9, s[12:15], s29 offen offset:1024 lds
    v_mfma_f32_16x16x32_bf16 v[108:111], a[48:51], a[12:15], v[108:111]
    s_waitcnt lgkmcnt(5)
    v_mfma_f32_16x16x32_bf16 v[112:115], a[32:35], a[0:3], v[112:115]
    ds_read_b64_tr_b16 a[44:45], v19 offset:192
    v_mfma_f32_16x16x32_bf16 v[116:119], a[32:35], a[4:7], v[116:119]
    ds_read_b64_tr_b16 a[46:47], v19 offset:1984
    v_mfma_f32_16x16x32_bf16 v[120:123], a[32:35], a[8:11], v[120:123]
    ds_read_b128 a[24:27], v12 offset:4096
    buffer_load_dwordx4 v10, s[12:15], s29 offen offset:2048 lds
    s_add_u32 s28, s28, 128
    s_add_u32 s29, s29, 458752
    v_mfma_f32_16x16x32_bf16 v[124:127], a[32:35], a[12:15], v[124:127]
    s_waitcnt lgkmcnt(6)
    v_mfma_f32_16x16x32_bf16 v[128:131], a[36:39], a[0:3], v[128:131]
    ds_read_b64_tr_b16 a[48:49], v19 offset:14656
    v_mfma_f32_16x16x32_bf16 v[132:135], a[36:39], a[4:7], v[132:135]
    ds_read_b64_tr_b16 a[50:51], v19 offset:16448
    v_mfma_f32_16x16x32_bf16 v[136:139], a[36:39], a[8:11], v[136:139]
    v_mfma_f32_16x16x32_bf16 v[140:143], a[36:39], a[12:15], v[140:143]
    s_waitcnt lgkmcnt(5)
    v_mfma_f32_16x16x32_bf16 v[144:147], a[40:43], a[0:3], v[144:147]
    ds_read_b64_tr_b16 a[32:33], v19 offset:7232
    v_mfma_f32_16x16x32_bf16 v[148:151], a[40:43], a[4:7], v[148:151]
    ds_read_b64_tr_b16 a[34:35], v19 offset:9024
    v_mfma_f32_16x16x32_bf16 v[152:155], a[40:43], a[8:11], v[152:155]
    ds_read_b128 a[28:31], v12 offset:6144
    v_mfma_f32_16x16x32_bf16 v[156:159], a[40:43], a[12:15], v[156:159]
    s_waitcnt lgkmcnt(6)
    v_mfma_f32_16x16x32_bf16 v[160:163], a[44:47], a[0:3], v[160:163]
    ds_read_b64_tr_b16 a[36:37], v19 offset:21696
    v_mfma_f32_16x16x32_bf16 v[164:167], a[44:47], a[4:7], v[164:167]
    ds_read_b64_tr_b16 a[38:39], v19 offset:23488
    v_mfma_f32_16x16x32_bf16 v[168:171], a[44:47], a[8:11], v[168:171]
    v_mfma_f32_16x16x32_bf16 v[172:175], a[44:47], a[12:15], v[172:175]
    s_waitcnt lgkmcnt(5)
    v_mfma_f32_16x16x32_bf16 v[176:179], a[48:51], a[0:3], v[176:179]
    ds_read_b64_tr_b16 a[40:41], v19 offset:7264
    v_mfma_f32_16x16x32_bf16 v[180:183], a[48:51], a[4:7], v[180:183]
    ds_read_b64_tr_b16 a[42:43], v19 offset:9056
    v_mfma_f32_16x16x32_bf16 v[184:187], a[48:51], a[8:11], v[184:187]
    v_mfma_f32_16x16x32_bf16 v[188:191], a[48:51], a[12:15], v[188:191]
    s_waitcnt lgkmcnt(4)
    v_mfma_f32_16x16x32_bf16 v[32:35], a[32:35], a[16:19], v[32:35]
    ds_read_b64_tr_b16 a[44:45], v19 offset:21728
    v_mfma_f32_16x16x32_bf16 v[36:39], a[32:35], a[20:23], v[36:39]
    ds_read_b64_tr_b16 a[46:47], v19 offset:23520
    v_mfma_f32_16x16x32_bf16 v[40:43], a[32:35], a[24:27], v[40:43]
    v_mfma_f32_16x16x32_bf16 v[44:47], a[32:35], a[28:31], v[44:47]
    s_waitcnt lgkmcnt(4)
    v_mfma_f32_16x16x32_bf16 v[48:51], a[36:39], a[16:19], v[48:51]
    ds_read_b64_tr_b16 a[48:49], v19 offset:7296
    v_mfma_f32_16x16x32_bf16 v[52:55], a[36:39], a[20:23], v[52:55]
    ds_read_b64_tr_b16 a[50:51], v19 offset:9088
    v_mfma_f32_16x16x32_bf16 v[56:59], a[36:39], a[24:27], v[56:59]
    v_mfma_f32_16x16x32_bf16 v[60:63], a[36:39], a[28:31], v[60:63]
    s_waitcnt lgkmcnt(4)
    v_mfma_f32_16x16x32_bf16 v[64:67], a[40:43], a[16:19], v[64:67]
    ds_read_b64_tr_b16 a[32:33], v19 offset:21760
    v_mfma_f32_16x16x32_bf16 v[68:71], a[40:43], a[20:23], v[68:71]
    ds_read_b64_tr_b16 a[34:35], v19 offset:23552
    v_mfma_f32_16x16x32_bf16 v[72:75], a[40:43], a[24:27], v[72:75]
    v_mfma_f32_16x16x32_bf16 v[76:79], a[40:43], a[28:31], v[76:79]
    s_waitcnt lgkmcnt(4)
    v_mfma_f32_16x16x32_bf16 v[80:83], a[44:47], a[16:19], v[80:83]
    ds_read_b64_tr_b16 a[36:37], v19 offset:7328
    v_mfma_f32_16x16x32_bf16 v[84:87], a[44:47], a[20:23], v[84:87]
    ds_read_b64_tr_b16 a[38:39], v19 offset:9120
    v_mfma_f32_16x16x32_bf16 v[88:91], a[44:47], a[24:27], v[88:91]
    v_mfma_f32_16x16x32_bf16 v[92:95], a[44:47], a[28:31], v[92:95]
    s_waitcnt lgkmcnt(4)
    v_mfma_f32_16x16x32_bf16 v[96:99], a[48:51], a[16:19], v[96:99]
    ds_read_b64_tr_b16 a[40:41], v19 offset:21792
    v_mfma_f32_16x16x32_bf16 v[100:103], a[48:51], a[20:23], v[100:103]
    ds_read_b64_tr_b16 a[42:43], v19 offset:23584
    v_mfma_f32_16x16x32_bf16 v[104:107], a[48:51], a[24:27], v[104:107]
    v_mfma_f32_16x16x32_bf16 v[108:111], a[48:51], a[28:31], v[108:111]
    s_waitcnt lgkmcnt(4)
    v_mfma_f32_16x16x32_bf16 v[112:115], a[32:35], a[16:19], v[112:115]
    ds_read_b64_tr_b16 a[44:45], v19 offset:7360
    v_mfma_f32_16x16x32_bf16 v[116:119], a[32:35], a[20:23], v[116:119]
    ds_read_b64_tr_b16 a[46:47], v19 offset:9152
    v_mfma_f32_16x16x32_bf16 v[120:123], a[32:35], a[24:27], v[120:123]
    ds_read_b64_tr_b16 a[48:49], v19 offset:21824
    v_mfma_f32_16x16x32_bf16 v[124:127], a[32:35], a[28:31], v[124:127]
    ds_read_b64_tr_b16 a[50:51], v19 offset:23616
    s_waitcnt lgkmcnt(6)
    v_mfma_f32_16x16x32_bf16 v[128:131], a[36:39], a[16:19], v[128:131]
    v_mfma_f32_16x16x32_bf16 v[132:135], a[36:39], a[20:23], v[132:135]
    v_mfma_f32_16x16x32_bf16 v[136:139], a[36:39], a[24:27], v[136:139]
    v_mfma_f32_16x16x32_bf16 v[140:143], a[36:39], a[28:31], v[140:143]
    s_waitcnt lgkmcnt(0) vmcnt(0)
    s_barrier
    s_setprio 2
    v_mfma_f32_16x16x32_bf16 v[144:147], a[40:43], a[16:19], v[144:147]
    ds_read_b64_tr_b16 a[32:33], v20 offset:64
    v_mfma_f32_16x16x32_bf16 v[148:151], a[40:43], a[20:23], v[148:151]
    ds_read_b64_tr_b16 a[34:35], v20 offset:1856
    v_mfma_f32_16x16x32_bf16 v[152:155], a[40:43], a[24:27], v[152:155]
    ds_read_b128 a[0:3], v13 offset:0
    v_mfma_f32_16x16x32_bf16 v[156:159], a[40:43], a[28:31], v[156:159]
    ds_read_b128 a[4:7], v13 offset:2048
    s_waitcnt lgkmcnt(6)
    v_mfma_f32_16x16x32_bf16 v[160:163], a[44:47], a[16:19], v[160:163]
    ds_read_b64_tr_b16 a[36:37], v20 offset:14528
    v_mfma_f32_16x16x32_bf16 v[164:167], a[44:47], a[20:23], v[164:167]
    ds_read_b64_tr_b16 a[38:39], v20 offset:16320
    v_mfma_f32_16x16x32_bf16 v[168:171], a[44:47], a[24:27], v[168:171]
    ds_read_b128 a[8:11], v13 offset:4096
    v_mfma_f32_16x16x32_bf16 v[172:175], a[44:47], a[28:31], v[172:175]
    ds_read_b128 a[12:15], v13 offset:6144
    s_waitcnt lgkmcnt(8)
    v_mfma_f32_16x16x32_bf16 v[176:179], a[48:51], a[16:19], v[176:179]
    ds_read_b64_tr_b16 a[40:41], v20 offset:96
    v_mfma_f32_16x16x32_bf16 v[180:183], a[48:51], a[20:23], v[180:183]
    ds_read_b64_tr_b16 a[42:43], v20 offset:1888
    v_mfma_f32_16x16x32_bf16 v[184:187], a[48:51], a[24:27], v[184:187]
    v_mfma_f32_16x16x32_bf16 v[188:191], a[48:51], a[28:31], v[188:191]
    s_waitcnt lgkmcnt(2)
    v_mfma_f32_16x16x32_bf16 v[32:35], a[32:35], a[0:3], v[32:35]
    ds_read_b64_tr_b16 a[44:45], v20 offset:14560
    v_mfma_f32_16x16x32_bf16 v[36:39], a[32:35], a[4:7], v[36:39]
    ds_read_b64_tr_b16 a[46:47], v20 offset:16352
    v_mfma_f32_16x16x32_bf16 v[40:43], a[32:35], a[8:11], v[40:43]
    v_mfma_f32_16x16x32_bf16 v[44:47], a[32:35], a[12:15], v[44:47]
    s_waitcnt lgkmcnt(6)
    v_mfma_f32_16x16x32_bf16 v[48:51], a[36:39], a[0:3], v[48:51]
    ds_read_b64_tr_b16 a[48:49], v20 offset:128
    v_mfma_f32_16x16x32_bf16 v[52:55], a[36:39], a[4:7], v[52:55]
    ds_read_b64_tr_b16 a[50:51], v20 offset:1920
    v_mfma_f32_16x16x32_bf16 v[56:59], a[36:39], a[8:11], v[56:59]
    ds_read_b128 a[16:19], v14 offset:0
    v_mfma_f32_16x16x32_bf16 v[60:63], a[36:39], a[12:15], v[60:63]
    s_waitcnt lgkmcnt(5)
    v_mfma_f32_16x16x32_bf16 v[64:67], a[40:43], a[0:3], v[64:67]
    ds_read_b64_tr_b16 a[32:33], v20 offset:14592
    v_mfma_f32_16x16x32_bf16 v[68:71], a[40:43], a[4:7], v[68:71]
    ds_read_b64_tr_b16 a[34:35], v20 offset:16384
    v_mfma_f32_16x16x32_bf16 v[72:75], a[40:43], a[8:11], v[72:75]
    v_mfma_f32_16x16x32_bf16 v[76:79], a[40:43], a[12:15], v[76:79]
    s_waitcnt lgkmcnt(5)
    v_mfma_f32_16x16x32_bf16 v[80:83], a[44:47], a[0:3], v[80:83]
    ds_read_b64_tr_b16 a[36:37], v20 offset:160
    v_mfma_f32_16x16x32_bf16 v[84:87], a[44:47], a[4:7], v[84:87]
    ds_read_b64_tr_b16 a[38:39], v20 offset:1952
    v_mfma_f32_16x16x32_bf16 v[88:91], a[44:47], a[8:11], v[88:91]
    ds_read_b128 a[20:23], v14 offset:2048
    v_mfma_f32_16x16x32_bf16 v[92:95], a[44:47], a[12:15], v[92:95]
    s_waitcnt lgkmcnt(6)
    v_mfma_f32_16x16x32_bf16 v[96:99], a[48:51], a[0:3], v[96:99]
    ds_read_b64_tr_b16 a[40:41], v20 offset:14624
    v_mfma_f32_16x16x32_bf16 v[100:103], a[48:51], a[4:7], v[100:103]
    ds_read_b64_tr_b16 a[42:43], v20 offset:16416
    v_mfma_f32_16x16x32_bf16 v[104:107], a[48:51], a[8:11], v[104:107]
    v_mfma_f32_16x16x32_bf16 v[108:111], a[48:51], a[12:15], v[108:111]
    s_waitcnt lgkmcnt(5)
    v_mfma_f32_16x16x32_bf16 v[112:115], a[32:35], a[0:3], v[112:115]
    ds_read_b64_tr_b16 a[44:45], v20 offset:192
    v_mfma_f32_16x16x32_bf16 v[116:119], a[32:35], a[4:7], v[116:119]
    ds_read_b64_tr_b16 a[46:47], v20 offset:1984
    v_mfma_f32_16x16x32_bf16 v[120:123], a[32:35], a[8:11], v[120:123]
    ds_read_b128 a[24:27], v14 offset:4096
    v_mfma_f32_16x16x32_bf16 v[124:127], a[32:35], a[12:15], v[124:127]
    s_waitcnt lgkmcnt(6)
    v_mfma_f32_16x16x32_bf16 v[128:131], a[36:39], a[0:3], v[128:131]
    ds_read_b64_tr_b16 a[48:49], v20 offset:14656
    v_mfma_f32_16x16x32_bf16 v[132:135], a[36:39], a[4:7], v[132:135]
    ds_read_b64_tr_b16 a[50:51], v20 offset:16448
    v_mfma_f32_16x16x32_bf16 v[136:139], a[36:39], a[8:11], v[136:139]
    v_mfma_f32_16x16x32_bf16 v[140:143], a[36:39], a[12:15], v[140:143]
    s_waitcnt lgkmcnt(5)
    v_mfma_f32_16x16x32_bf16 v[144:147], a[40:43], a[0:3], v[144:147]
    ds_read_b64_tr_b16 a[32:33], v20 offset:7232
    v_mfma_f32_16x16x32_bf16 v[148:151], a[40:43], a[4:7], v[148:151]
    ds_read_b64_tr_b16 a[34:35], v20 offset:9024
    v_mfma_f32_16x16x32_bf16 v[152:155], a[40:43], a[8:11], v[152:155]
    ds_read_b128 a[28:31], v14 offset:6144
    v_mfma_f32_16x16x32_bf16 v[156:159], a[40:43], a[12:15], v[156:159]
    s_waitcnt lgkmcnt(6)
    v_mfma_f32_16x16x32_bf16 v[160:163], a[44:47], a[0:3], v[160:163]
    ds_read_b64_tr_b16 a[36:37], v20 offset:21696
    v_mfma_f32_16x16x32_bf16 v[164:167], a[44:47], a[4:7], v[164:167]
    ds_read_b64_tr_b16 a[38:39], v20 offset:23488
    v_mfma_f32_16x16x32_bf16 v[168:171], a[44:47], a[8:11], v[168:171]
    v_mfma_f32_16x16x32_bf16 v[172:175], a[44:47], a[12:15], v[172:175]
    s_waitcnt lgkmcnt(5)
    v_mfma_f32_16x16x32_bf16 v[176:179], a[48:51], a[0:3], v[176:179]
    ds_read_b64_tr_b16 a[40:41], v20 offset:7264
    v_mfma_f32_16x16x32_bf16 v[180:183], a[48:51], a[4:7], v[180:183]
    ds_read_b64_tr_b16 a[42:43], v20 offset:9056
    v_mfma_f32_16x16x32_bf16 v[184:187], a[48:51], a[8:11], v[184:187]
    v_mfma_f32_16x16x32_bf16 v[188:191], a[48:51], a[12:15], v[188:191]
    s_waitcnt lgkmcnt(4)
    v_mfma_f32_16x16x32_bf16 v[32:35], a[32:35], a[16:19], v[32:35]
    ds_read_b64_tr_b16 a[44:45], v20 offset:21728
    v_mfma_f32_16x16x32_bf16 v[36:39], a[32:35], a[20:23], v[36:39]
    ds_read_b64_tr_b16 a[46:47], v20 offset:23520
    v_mfma_f32_16x16x32_bf16 v[40:43], a[32:35], a[24:27], v[40:43]
    v_mfma_f32_16x16x32_bf16 v[44:47], a[32:35], a[28:31], v[44:47]
    s_waitcnt lgkmcnt(4)
    v_mfma_f32_16x16x32_bf16 v[48:51], a[36:39], a[16:19], v[48:51]
    ds_read_b64_tr_b16 a[48:49], v20 offset:7296
    v_mfma_f32_16x16x32_bf16 v[52:55], a[36:39], a[20:23], v[52:55]
    ds_read_b64_tr_b16 a[50:51], v20 offset:9088
    v_mfma_f32_16x16x32_bf16 v[56:59], a[36:39], a[24:27], v[56:59]
    v_mfma_f32_16x16x32_bf16 v[60:63], a[36:39], a[28:31], v[60:63]
    s_waitcnt lgkmcnt(4)
    v_mfma_f32_16x16x32_bf16 v[64:67], a[40:43], a[16:19], v[64:67]
    ds_read_b64_tr_b16 a[32:33], v20 offset:21760
    v_mfma_f32_16x16x32_bf16 v[68:71], a[40:43], a[20:23], v[68:71]
    ds_read_b64_tr_b16 a[34:35], v20 offset:23552
    v_mfma_f32_16x16x32_bf16 v[72:75], a[40:43], a[24:27], v[72:75]
    v_mfma_f32_16x16x32_bf16 v[76:79], a[40:43], a[28:31], v[76:79]
    s_waitcnt lgkmcnt(4)
    v_mfma_f32_16x16x32_bf16 v[80:83], a[44:47], a[16:19], v[80:83]
    ds_read_b64_tr_b16 a[36:37], v20 offset:7328
    v_mfma_f32_16x16x32_bf16 v[84:87], a[44:47], a[20:23], v[84:87]
    ds_read_b64_tr_b16 a[38:39], v20 offset:9120
    v_mfma_f32_16x16x32_bf16 v[88:91], a[44:47], a[24:27], v[88:91]
    v_mfma_f32_16x16x32_bf16 v[92:95], a[44:47], a[28:31], v[92:95]
    s_waitcnt lgkmcnt(4)
    v_mfma_f32_16x16x32_bf16 v[96:99], a[48:51], a[16:19], v[96:99]
    ds_read_b64_tr_b16 a[40:41], v20 offset:21792
    v_mfma_f32_16x16x32_bf16 v[100:103], a[48:51], a[20:23], v[100:103]
    ds_read_b64_tr_b16 a[42:43], v20 offset:23584
    v_mfma_f32_16x16x32_bf16 v[104:107], a[48:51], a[24:27], v[104:107]
    v_mfma_f32_16x16x32_bf16 v[108:111], a[48:51], a[28:31], v[108:111]
    s_waitcnt lgkmcnt(4)
    v_mfma_f32_16x16x32_bf16 v[112:115], a[32:35], a[16:19], v[112:115]
    ds_read_b64_tr_b16 a[44:45], v20 offset:7360
    v_mfma_f32_16x16x32_bf16 v[116:119], a[32:35], a[20:23], v[116:119]
    ds_read_b64_tr_b16 a[46:47], v20 offset:9152
    v_mfma_f32_16x16x32_bf16 v[120:123], a[32:35], a[24:27], v[120:123]
    ds_read_b64_tr_b16 a[48:49], v20 offset:21824
    v_mfma_f32_16x16x32_bf16 v[124:127], a[32:35], a[28:31], v[124:127]
    ds_read_b64_tr_b16 a[50:51], v20 offset:23616
    s_waitcnt lgkmcnt(6)
    v_mfma_f32_16x16x32_bf16 v[128:131], a[36:39], a[16:19], v[128:131]
    v_mfma_f32_16x16x32_bf16 v[132:135], a[36:39], a[20:23], v[132:135]
    v_mfma_f32_16x16x32_bf16 v[136:139], a[36:39], a[24:27], v[136:139]
    v_mfma_f32_16x16x32_bf16 v[140:143], a[36:39], a[28:31], v[140:143]
    s_waitcnt lgkmcnt(4)
    v_mfma_f32_16x16x32_bf16 v[144:147], a[40:43], a[16:19], v[144:147]
    v_mfma_f32_16x16x32_bf16 v[148:151], a[40:43], a[20:23], v[148:151]
    v_mfma_f32_16x16x32_bf16 v[152:155], a[40:43], a[24:27], v[152:155]
    v_mfma_f32_16x16x32_bf16 v[156:159], a[40:43], a[28:31], v[156:159]
    s_waitcnt lgkmcnt(2)
    v_mfma_f32_16x16x32_bf16 v[160:163], a[44:47], a[16:19], v[160:163]
    v_mfma_f32_16x16x32_bf16 v[164:167], a[44:47], a[20:23], v[164:167]
    v_mfma_f32_16x16x32_bf16 v[168:171], a[44:47], a[24:27], v[168:171]
    v_mfma_f32_16x16x32_bf16 v[172:175], a[44:47], a[28:31], v[172:175]
    s_waitcnt lgkmcnt(0)
    v_mfma_f32_16x16x32_bf16 v[176:179], a[48:51], a[16:19], v[176:179]
    v_mfma_f32_16x16x32_bf16 v[180:183], a[48:51], a[20:23], v[180:183]
    v_mfma_f32_16x16x32_bf16 v[184:187], a[48:51], a[24:27], v[184:187]
    v_mfma_f32_16x16x32_bf16 v[188:191], a[48:51], a[28:31], v[188:191]
    s_setprio 1
    v_and_b32 v23, 15, v1
    v_lshlrev_b32 v23, 4, v23
    v_lshrrev_b32 v27, 5, v1
    v_lshl_add_u32 v23, v27, 8, v23
    v_bfe_u32 v27, v1, 4, 1
    v_mul_u32_u24 v25, 147456, v27
    v_add_u32 v25, v25, v23
    v_lshl_add_u32 v23, v27, 9, v23
    s_lshl_b32 s3, s24, 4
    s_lshl_b32 s62, s26, 2
    s_add_u32 s62, s62, s3
    s_mul_i32 s62, s62, 147456
    s_mul_i32 s3, s25, 7
    s_add_u32 s3, s3, 1
    s_lshr_b32 s3, s3, 1
    s_lshl_b32 s3, s3, 10
    s_add_u32 s63, s62, s3
    s_add_u32 s64, s63, 147456
    s_add_u32 s65, s63, 294912
    s_add_u32 s66, s63, 442368
    s_add_u32 s67, s63, 3072
    s_sub_u32 s3, s63, 512
    s_bitcmp1_b32 s25, 0
    s_cselect_b32 s67, s3, s67
    s_add_u32 s76, s67, 294912
    v_pk_mul_f32 v[32:33], v[32:33], s[38:39]
    v_pk_mul_f32 v[34:35], v[34:35], s[38:39]
    v_pk_mul_f32 v[36:37], v[36:37], s[38:39]
    v_pk_mul_f32 v[38:39], v[38:39], s[38:39]
    v_pk_mul_f32 v[40:41], v[40:41], s[38:39]
    v_pk_mul_f32 v[42:43], v[42:43], s[38:39]
    v_pk_mul_f32 v[44:45], v[44:45], s[38:39]
    v_pk_mul_f32 v[46:47], v[46:47], s[38:39]
    v_exp_f32 v32, -v32
    v_exp_f32 v33, -v33
    v_exp_f32 v34, -v34
    v_exp_f32 v35, -v35
    v_exp_f32 v36, -v36
    v_exp_f32 v37, -v37
    v_exp_f32 v38, -v38
    v_exp_f32 v39, -v39
    v_exp_f32 v40, -v40
    v_exp_f32 v41, -v41
    v_exp_f32 v42, -v42
    v_exp_f32 v43, -v43
    v_exp_f32 v44, -v44
    v_exp_f32 v45, -v45
    v_exp_f32 v46, -v46
    v_exp_f32 v47, -v47
    v_pk_add_f32 v[32:33], v[32:33], 1.0 op_sel_hi:[1,0]
    v_pk_add_f32 v[34:35], v[34:35], 1.0 op_sel_hi:[1,0]
    v_pk_add_f32 v[36:37], v[36:37], 1.0 op_sel_hi:[1,0]
    v_pk_add_f32 v[38:39], v[38:39], 1.0 op_sel_hi:[1,0]
    v_pk_add_f32 v[40:41], v[40:41], 1.0 op_sel_hi:[1,0]
    v_pk_add_f32 v[42:43], v[42:43], 1.0 op_sel_hi:[1,0]
    v_pk_add_f32 v[44:45], v[44:45], 1.0 op_sel_hi:[1,0]
    v_pk_add_f32 v[46:47], v[46:47], 1.0 op_sel_hi:[1,0]
    v_rcp_f32 v32, v32
    v_rcp_f32 v33, v33
    v_rcp_f32 v34, v34
    v_rcp_f32 v35, v35
    v_rcp_f32 v36, v36
    v_rcp_f32 v37, v37
    v_rcp_f32 v38, v38
    v_rcp_f32 v39, v39
    v_rcp_f32 v40, v40
    v_rcp_f32 v41, v41
    v_rcp_f32 v42, v42
    v_rcp_f32 v43, v43
    v_rcp_f32 v44, v44
    v_rcp_f32 v45, v45
    v_rcp_f32 v46, v46
    v_rcp_f32 v47, v47
    v_pk_mul_f32 v[32:33], v[32:33], v[48:49]
    v_pk_mul_f32 v[34:35], v[34:35], v[50:51]
    v_pk_mul_f32 v[36:37], v[36:37], v[52:53]
    v_pk_mul_f32 v[38:39], v[38:39], v[54:55]
    v_pk_mul_f32 v[40:41], v[40:41], v[56:57]
    v_pk_mul_f32 v[42:43], v[42:43], v[58:59]
    v_pk_mul_f32 v[44:45], v[44:45], v[60:61]
    v_pk_mul_f32 v[46:47], v[46:47], v[62:63]
    v_pk_mul_f32 v[64:65], v[64:65], s[38:39]
    v_pk_mul_f32 v[66:67], v[66:67], s[38:39]
    v_pk_mul_f32 v[68:69], v[68:69], s[38:39]
    v_pk_mul_f32 v[70:71], v[70:71], s[38:39]
    v_pk_mul_f32 v[72:73], v[72:73], s[38:39]
    v_pk_mul_f32 v[74:75], v[74:75], s[38:39]
    v_pk_mul_f32 v[76:77], v[76:77], s[38:39]
    v_pk_mul_f32 v[78:79], v[78:79], s[38:39]
    v_exp_f32 v64, -v64
    v_exp_f32 v65, -v65
    v_exp_f32 v66, -v66
    v_exp_f32 v67, -v67
    v_exp_f32 v68, -v68
    v_exp_f32 v69, -v69
    v_exp_f32 v70, -v70
    v_exp_f32 v71, -v71
    v_exp_f32 v72, -v72
    v_exp_f32 v73, -v73
    v_exp_f32 v74, -v74
    v_exp_f32 v75, -v75
    v_exp_f32 v76, -v76
    v_exp_f32 v77, -v77
    v_exp_f32 v78, -v78
    v_exp_f32 v79, -v79
    v_pk_add_f32 v[64:65], v[64:65], 1.0 op_sel_hi:[1,0]
    v_pk_add_f32 v[66:67], v[66:67], 1.0 op_sel_hi:[1,0]
    v_pk_add_f32 v[68:69], v[68:69], 1.0 op_sel_hi:[1,0]
    v_pk_add_f32 v[70:71], v[70:71], 1.0 op_sel_hi:[1,0]
    v_pk_add_f32 v[72:73], v[72:73], 1.0 op_sel_hi:[1,0]
    v_pk_add_f32 v[74:75], v[74:75], 1.0 op_sel_hi:[1,0]
    v_pk_add_f32 v[76:77], v[76:77], 1.0 op_sel_hi:[1,0]
    v_pk_add_f32 v[78:79], v[78:79], 1.0 op_sel_hi:[1,0]
    v_rcp_f32 v64, v64
    v_rcp_f32 v65, v65
    v_rcp_f32 v66, v66
    v_rcp_f32 v67, v67
    v_rcp_f32 v68, v68
    v_rcp_f32 v69, v69
    v_rcp_f32 v70, v70
    v_rcp_f32 v71, v71
    v_rcp_f32 v72, v72
    v_rcp_f32 v73, v73
    v_rcp_f32 v74, v74
    v_rcp_f32 v75, v75
    v_rcp_f32 v76, v76
    v_rcp_f32 v77, v77
    v_rcp_f32 v78, v78
    v_rcp_f32 v79, v79
    v_pk_mul_f32 v[64:65], v[64:65], v[80:81]
    v_pk_mul_f32 v[66:67], v[66:67], v[82:83]
    v_pk_mul_f32 v[68:69], v[68:69], v[84:85]
    v_pk_mul_f32 v[70:71], v[70:71], v[86:87]
    v_pk_mul_f32 v[72:73], v[72:73], v[88:89]
    v_pk_mul_f32 v[74:75], v[74:75], v[90:91]
    v_pk_mul_f32 v[76:77], v[76:77], v[92:93]
    v_pk_mul_f32 v[78:79], v[78:79], v[94:95]
    v_cvt_pk_bf16_f32 v48, v32, v33
    v_cvt_pk_bf16_f32 v49, v34, v35
    v_cvt_pk_bf16_f32 v50, v64, v65
    v_cvt_pk_bf16_f32 v51, v66, v67
    v_cvt_pk_bf16_f32 v52, v36, v37
    v_cvt_pk_bf16_f32 v53, v38, v39
    v_cvt_pk_bf16_f32 v54, v68, v69
    v_cvt_pk_bf16_f32 v55, v70, v71
    v_cvt_pk_bf16_f32 v56, v40, v41
    v_cvt_pk_bf16_f32 v57, v42, v43
    v_cvt_pk_bf16_f32 v58, v72, v73
    v_cvt_pk_bf16_f32 v59, v74, v75
    v_cvt_pk_bf16_f32 v60, v44, v45
    v_cvt_pk_bf16_f32 v61, v46, v47
    v_cvt_pk_bf16_f32 v62, v76, v77
    v_cvt_pk_bf16_f32 v63, v78, v79
    v_permlane16_swap_b32 v48, v50
    v_permlane16_swap_b32 v49, v51
    v_permlane16_swap_b32 v52, v54
    v_permlane16_swap_b32 v53, v55
    v_permlane16_swap_b32 v56, v58
    v_permlane16_swap_b32 v57, v59
    v_permlane16_swap_b32 v60, v62
    v_permlane16_swap_b32 v61, v63
    buffer_store_dwordx4 v[48:51], v23, s[20:23], s63 offen offset:1024 sc1
    v_pk_mul_f32 v[96:97], v[96:97], s[38:39]
    v_pk_mul_f32 v[98:99], v[98:99], s[38:39]
    v_pk_mul_f32 v[100:101], v[100:101], s[38:39]
    v_pk_mul_f32 v[102:103], v[102:103], s[38:39]
    v_pk_mul_f32 v[104:105], v[104:105], s[38:39]
    v_pk_mul_f32 v[106:107], v[106:107], s[38:39]
    v_pk_mul_f32 v[108:109], v[108:109], s[38:39]
    v_pk_mul_f32 v[110:111], v[110:111], s[38:39]
    v_exp_f32 v96, -v96
    v_exp_f32 v97, -v97
    v_exp_f32 v98, -v98
    v_exp_f32 v99, -v99
    v_exp_f32 v100, -v100
    v_exp_f32 v101, -v101
    v_exp_f32 v102, -v102
    v_exp_f32 v103, -v103
    v_exp_f32 v104, -v104
    v_exp_f32 v105, -v105
    v_exp_f32 v106, -v106
    v_exp_f32 v107, -v107
    v_exp_f32 v108, -v108
    v_exp_f32 v109, -v109
    v_exp_f32 v110, -v110
    v_exp_f32 v111, -v111
    v_pk_add_f32 v[96:97], v[96:97], 1.0 op_sel_hi:[1,0]
    v_pk_add_f32 v[98:99], v[98:99], 1.0 op_sel_hi:[1,0]
    v_pk_add_f32 v[100:101], v[100:101], 1.0 op_sel_hi:[1,0]
    v_pk_add_f32 v[102:103], v[102:103], 1.0 op_sel_hi:[1,0]
    v_pk_add_f32 v[104:105], v[104:105], 1.0 op_sel_hi:[1,0]
    v_pk_add_f32 v[106:107], v[106:107], 1.0 op_sel_hi:[1,0]
    v_pk_add_f32 v[108:109], v[108:109], 1.0 op_sel_hi:[1,0]
    v_pk_add_f32 v[110:111], v[110:111], 1.0 op_sel_hi:[1,0]
    v_rcp_f32 v96, v96
    v_rcp_f32 v97, v97
    v_rcp_f32 v98, v98
    buffer_store_dwordx4 v[52:55], v23, s[20:23], s64 offen offset:1024 sc1
    v_rcp_f32 v99, v99
    v_rcp_f32 v100, v100
    v_rcp_f32 v101, v101
    v_rcp_f32 v102, v102
    v_rcp_f32 v103, v103
    v_rcp_f32 v104, v104
    v_rcp_f32 v105, v105
    v_rcp_f32 v106, v106
    v_rcp_f32 v107, v107
    v_rcp_f32 v108, v108
    v_rcp_f32 v109, v109
    v_rcp_f32 v110, v110
    v_rcp_f32 v111, v111
    v_pk_mul_f32 v[96:97], v[96:97], v[112:113]
    v_pk_mul_f32 v[98:99], v[98:99], v[114:115]
    v_pk_mul_f32 v[100:101], v[100:101], v[116:117]
    v_pk_mul_f32 v[102:103], v[102:103], v[118:119]
    v_pk_mul_f32 v[104:105], v[104:105], v[120:121]
    v_pk_mul_f32 v[106:107], v[106:107], v[122:123]
    v_pk_mul_f32 v[108:109], v[108:109], v[124:125]
    v_pk_mul_f32 v[110:111], v[110:111], v[126:127]
    v_pk_mul_f32 v[128:129], v[128:129], s[38:39]
    v_pk_mul_f32 v[130:131], v[130:131], s[38:39]
    v_pk_mul_f32 v[132:133], v[132:133], s[38:39]
    v_pk_mul_f32 v[134:135], v[134:135], s[38:39]
    v_pk_mul_f32 v[136:137], v[136:137], s[38:39]
    v_pk_mul_f32 v[138:139], v[138:139], s[38:39]
    v_pk_mul_f32 v[140:141], v[140:141], s[38:39]
    v_pk_mul_f32 v[142:143], v[142:143], s[38:39]
    v_exp_f32 v128, -v128
    v_exp_f32 v129, -v129
    v_exp_f32 v130, -v130
    v_exp_f32 v131, -v131
    v_exp_f32 v132, -v132
    v_exp_f32 v133, -v133
    buffer_store_dwordx4 v[56:59], v23, s[20:23], s65 offen offset:1024 sc1
    v_exp_f32 v134, -v134
    v_exp_f32 v135, -v135
    v_exp_f32 v136, -v136
    v_exp_f32 v137, -v137
    v_exp_f32 v138, -v138
    v_exp_f32 v139, -v139
    v_exp_f32 v140, -v140
    v_exp_f32 v141, -v141
    v_exp_f32 v142, -v142
    v_exp_f32 v143, -v143
    v_pk_add_f32 v[128:129], v[128:129], 1.0 op_sel_hi:[1,0]
    v_pk_add_f32 v[130:131], v[130:131], 1.0 op_sel_hi:[1,0]
    v_pk_add_f32 v[132:133], v[132:133], 1.0 op_sel_hi:[1,0]
    v_pk_add_f32 v[134:135], v[134:135], 1.0 op_sel_hi:[1,0]
    v_pk_add_f32 v[136:137], v[136:137], 1.0 op_sel_hi:[1,0]
    v_pk_add_f32 v[138:139], v[138:139], 1.0 op_sel_hi:[1,0]
    v_pk_add_f32 v[140:141], v[140:141], 1.0 op_sel_hi:[1,0]
    v_pk_add_f32 v[142:143], v[142:143], 1.0 op_sel_hi:[1,0]
    v_rcp_f32 v128, v128
    v_rcp_f32 v129, v129
    v_rcp_f32 v130, v130
    v_rcp_f32 v131, v131
    v_rcp_f32 v132, v132
    v_rcp_f32 v133, v133
    v_rcp_f32 v134, v134
    v_rcp_f32 v135, v135
    v_rcp_f32 v136, v136
    v_rcp_f32 v137, v137
    v_rcp_f32 v138, v138
    v_rcp_f32 v139, v139
    v_rcp_f32 v140, v140
    v_rcp_f32 v141, v141
    v_rcp_f32 v142, v142
    v_rcp_f32 v143, v143
    v_pk_mul_f32 v[128:129], v[128:129], v[144:145]
    buffer_store_dwordx4 v[60:63], v23, s[20:23], s66 offen offset:1024 sc1
    v_pk_mul_f32 v[130:131], v[130:131], v[146:147]
    v_pk_mul_f32 v[132:133], v[132:133], v[148:149]
    v_pk_mul_f32 v[134:135], v[134:135], v[150:151]
    v_pk_mul_f32 v[136:137], v[136:137], v[152:153]
    v_pk_mul_f32 v[138:139], v[138:139], v[154:155]
    v_pk_mul_f32 v[140:141], v[140:141], v[156:157]
    v_pk_mul_f32 v[142:143], v[142:143], v[158:159]
    v_cvt_pk_bf16_f32 v112, v96, v97
    v_cvt_pk_bf16_f32 v113, v98, v99
    v_cvt_pk_bf16_f32 v114, v128, v129
    v_cvt_pk_bf16_f32 v115, v130, v131
    v_cvt_pk_bf16_f32 v116, v100, v101
    v_cvt_pk_bf16_f32 v117, v102, v103
    v_cvt_pk_bf16_f32 v118, v132, v133
    v_cvt_pk_bf16_f32 v119, v134, v135
    v_cvt_pk_bf16_f32 v120, v104, v105
    v_cvt_pk_bf16_f32 v121, v106, v107
    v_cvt_pk_bf16_f32 v122, v136, v137
    v_cvt_pk_bf16_f32 v123, v138, v139
    v_cvt_pk_bf16_f32 v124, v108, v109
    v_cvt_pk_bf16_f32 v125, v110, v111
    v_cvt_pk_bf16_f32 v126, v140, v141
    v_cvt_pk_bf16_f32 v127, v142, v143
    v_permlane16_swap_b32 v112, v114
    v_permlane16_swap_b32 v113, v115
    v_permlane16_swap_b32 v116, v118
    v_permlane16_swap_b32 v117, v119
    v_permlane16_swap_b32 v120, v122
    v_permlane16_swap_b32 v121, v123
    v_permlane16_swap_b32 v124, v126
    v_permlane16_swap_b32 v125, v127
    buffer_store_dwordx4 v[112:115], v23, s[20:23], s63 offen offset:2048 sc1
    v_pk_mul_f32 v[160:161], v[160:161], s[38:39]
    v_pk_mul_f32 v[162:163], v[162:163], s[38:39]
    v_pk_mul_f32 v[164:165], v[164:165], s[38:39]
    v_pk_mul_f32 v[166:167], v[166:167], s[38:39]
    v_pk_mul_f32 v[168:169], v[168:169], s[38:39]
    v_pk_mul_f32 v[170:171], v[170:171], s[38:39]
    v_pk_mul_f32 v[172:173], v[172:173], s[38:39]
    v_pk_mul_f32 v[174:175], v[174:175], s[38:39]
    v_exp_f32 v160, -v160
    v_exp_f32 v161, -v161
    v_exp_f32 v162, -v162
    v_exp_f32 v163, -v163
    v_exp_f32 v164, -v164
    v_exp_f32 v165, -v165
    v_exp_f32 v166, -v166
    v_exp_f32 v167, -v167
    v_exp_f32 v168, -v168
    v_exp_f32 v169, -v169
    buffer_store_dwordx4 v[116:119], v23, s[20:23], s64 offen offset:2048 sc1
    v_exp_f32 v170, -v170
    v_exp_f32 v171, -v171
    v_exp_f32 v172, -v172
    v_exp_f32 v173, -v173
    v_exp_f32 v174, -v174
    v_exp_f32 v175, -v175
    v_pk_add_f32 v[160:161], v[160:161], 1.0 op_sel_hi:[1,0]
    v_pk_add_f32 v[162:163], v[162:163], 1.0 op_sel_hi:[1,0]
    v_pk_add_f32 v[164:165], v[164:165], 1.0 op_sel_hi:[1,0]
    v_pk_add_f32 v[166:167], v[166:167], 1.0 op_sel_hi:[1,0]
    v_pk_add_f32 v[168:169], v[168:169], 1.0 op_sel_hi:[1,0]
    v_pk_add_f32 v[170:171], v[170:171], 1.0 op_sel_hi:[1,0]
    v_pk_add_f32 v[172:173], v[172:173], 1.0 op_sel_hi:[1,0]
    v_pk_add_f32 v[174:175], v[174:175], 1.0 op_sel_hi:[1,0]
    v_rcp_f32 v160, v160
    v_rcp_f32 v161, v161
    v_rcp_f32 v162, v162
    v_rcp_f32 v163, v163
    buffer_store_dwordx4 v[120:123], v23, s[20:23], s65 offen offset:2048 sc1
    v_rcp_f32 v164, v164
    v_rcp_f32 v165, v165
    v_rcp_f32 v166, v166
    v_rcp_f32 v167, v167
    v_rcp_f32 v168, v168
    v_rcp_f32 v169, v169
    v_rcp_f32 v170, v170
    v_rcp_f32 v171, v171
    v_rcp_f32 v172, v172
    v_rcp_f32 v173, v173
    v_rcp_f32 v174, v174
    v_rcp_f32 v175, v175
    v_pk_mul_f32 v[160:161], v[160:161], v[176:177]
    v_pk_mul_f32 v[162:163], v[162:163], v[178:179]
    v_pk_mul_f32 v[164:165], v[164:165], v[180:181]
    v_pk_mul_f32 v[166:167], v[166:167], v[182:183]
    v_pk_mul_f32 v[168:169], v[168:169], v[184:185]
    v_pk_mul_f32 v[170:171], v[170:171], v[186:187]
    buffer_store_dwordx4 v[124:127], v23, s[20:23], s66 offen offset:2048 sc1
    v_pk_mul_f32 v[172:173], v[172:173], v[188:189]
    v_pk_mul_f32 v[174:175], v[174:175], v[190:191]
    v_cvt_pk_bf16_f32 v176, v160, v161
    v_cvt_pk_bf16_f32 v177, v162, v163
    v_cvt_pk_bf16_f32 v178, v164, v165
    v_cvt_pk_bf16_f32 v179, v166, v167
    v_cvt_pk_bf16_f32 v184, v168, v169
    v_cvt_pk_bf16_f32 v185, v170, v171
    v_cvt_pk_bf16_f32 v186, v172, v173
    v_cvt_pk_bf16_f32 v187, v174, v175
    v_permlane16_swap_b32 v176, v178
    v_permlane16_swap_b32 v177, v179
    v_permlane16_swap_b32 v184, v186
    v_permlane16_swap_b32 v185, v187
    buffer_store_dwordx4 v[176:179], v25, s[20:23], s67 offen sc1
    buffer_store_dwordx4 v[184:187], v25, s[20:23], s76 offen sc1
    v_lshlrev_b32 v13, 4, v1
    s_mov_b32 s16, s56
    s_mov_b32 s17, s57
    s_mov_b32 s18, 4194304
    s_mov_b32 s19, 0x20000
    s_lshr_b32 s42, s26, 1
    s_and_b32 s43, s26, 1
    s_lshl_b32 s6, s52, 7
    s_lshl_b32 s3, s42, 6
    s_add_u32 s6, s6, s3
    s_lshl_b32 s3, s54, 5
    s_add_u32 s6, s6, s3
    v_and_b32 v27, 15, v1
    v_add_u32 v9, s6, v27
    v_lshlrev_b32 v11, 2, v9
    v_add_u32 v11, 21692416, v11
    s_lshl_b32 s3, s42, 13
    s_add_u32 s3, s3, 65536
    s_lshl_b32 s6, s54, 12
    s_add_u32 s7, s3, s6
    v_add_u32 v2, s7, v13
    s_sub_u32 s3, s3, s6
    v_add_u32 v3, s3, v13
    v_lshrrev_b32 v29, 4, v1
    v_bfe_u32 v27, v1, 2, 2
    v_lshl_add_u32 v29, v29, 3, v27
    v_lshlrev_b32 v29, 8, v29
    v_and_b32 v31, 3, v1
    v_lshl_add_u32 v29, v31, 3, v29
    v_bfe_u32 v31, v1, 4, 1
    v_lshl_add_u32 v27, v31, 2, v27
    s_lshl_b32 s3, s43, 2
    s_add_u32 s6, s3, 0
    v_xor_b32 v31, s6, v27
    v_lshl_add_u32 v4, v31, 5, v29
    s_add_u32 s6, s3, 1
    v_xor_b32 v31, s6, v27
    v_lshl_add_u32 v5, v31, 5, v29
    s_add_u32 s6, s3, 2
    v_xor_b32 v31, s6, v27
    v_lshl_add_u32 v6, v31, 5, v29
    s_add_u32 s6, s3, 3
    v_xor_b32 v31, s6, v27
    v_lshl_add_u32 v7, v31, 5, v29
    v_mov_b32 v15, 0
    s_sub_u32 s3, s55, 21495808
    s_lshl_b32 s3, s3, 7
    s_add_u32 s60, s3, 22020096
    s_xor_b32 s3, s3, 32768
    s_add_u32 s62, s3, 22020096
    s_xor_b32 s64, s55, 256
    s_lshl_b32 s72, s53, 8
    s_lshl_b32 s3, s43, 7
    s_add_u32 s72, s72, s3
    s_add_u32 s73, s72, 16384
    v_lshrrev_b32 v32, 4, v1
    v_and_b32 v33, 15, v1
    v_lshlrev_b32 v34, 1, v32
    v_xor_b32 v33, v33, v34
    s_lshl_b32 s3, s26, 4
    v_add_u32 v32, s3, v32
    v_lshlrev_b32 v32, 11, v32
    v_lshl_add_u32 v32, v33, 4, v32
    v_xor_b32 v33, 128, v32
    v_add_u32 v23, 0, v32
    v_add_u32 v25, 7168, v32
    v_add_u32 v31, 14336, v33
    v_add_u32 v21, 21504, v33
    s_lshl_b32 s33, s26, 12
    s_add_u32 s32, s33, 65536
    s_mul_i32 s3, s54, 4194304
    s_lshl_b32 s6, s53, 8
    s_add_u32 s3, s3, s6
    s_add_u32 s12, s40, s3
    s_addc_u32 s13, s41, 0
    s_sub_u32 s14, 7340032, s3
    s_mov_b32 s15, 0x20000
    s_mov_b32 s29, 524288
    s_mul_i32 s3, s26, 294912
    v_add_u32 v27, s3, v13
    v_add_u32 v29, 145408, v27
    s_mov_b32 s28, 0
    s_mul_i32 s3, s52, 1179648
    s_mul_i32 s6, s54, 65536
    s_add_u32 s3, s3, s6
    s_add_u32 s8, s58, s3
    s_addc_u32 s9, s59, 0
    s_sub_u32 s10, 18874368, s3
    s_mov_b32 s11, 0x20000
    s_mov_b32 s66, 0xffffffff
    s_mov_b32 s67, 0xf
    s_cmp_eq_u32 s54, 0
    s_cselect_b32 s66, 0x0, s66
    s_cselect_b32 s67, 0xffffffc0, s67
    s_lshl_b32 s76, s52, 9
    s_add_u32 s76, s76, 21577728
    s_mov_b32 s46, 0x01010101
    v_lshlrev_b32 v36, 2, v1
    v_lshlrev_b32 v37, 3, v1
    buffer_load_dword v38, v36, s[48:51], 0 offen sc1
    s_waitcnt vmcnt(0)
    v_mov_b32 v40, s77
    v_mov_b32 v41, 1
    s_mov_b64 exec, 1
    buffer_store_dword v41, v40, s[20:23], 0 offen sc1
    s_mov_b64 exec, -1
    s_barrier
    s_barrier
    s_mov_b32 s37, 0x40000
L_dpollG:
    v_cmp_eq_u32 vcc, s46, v38
    s_nop 0
    s_cmp_eq_u64 vcc, -1
    s_cbranch_scc1 L_dpollG_ok
    s_sleep 2
    buffer_load_dword v38, v36, s[48:51], 0 offen sc1
    s_sub_u32 s37, s37, 1
    s_waitcnt vmcnt(0)
    s_cbranch_scc0 L_dpollG
L_dpollG_ok:
    s_mov_b32 s6, 0xffffffff
    s_mov_b32 s7, 0xfffffc0f
    s_cmp_eq_u32 s54, 0
    s_cselect_b32 s6, 0xffffffc0, s6
    s_cselect_b32 s7, 0xffffffff, s7
    buffer_load_dwordx2 v[38:39], v37, s[20:23], s76 offen sc1
    s_waitcnt vmcnt(0)
    s_mov_b32 s37, 0x40000
L_hpoll:
    v_and_b32 v38, v38, v39
    v_cmp_eq_u32 vcc, 1, v38
    s_nop 0
    s_or_b64 vcc, vcc, s[6:7]
    s_cmp_eq_u64 vcc, -1
    s_cbranch_scc1 L_hpoll_ok
    s_sleep 2
    buffer_load_dwordx2 v[38:39], v37, s[20:23], s76 offen sc1
    s_sub_u32 s37, s37, 1
    s_waitcnt vmcnt(0)
    s_cbranch_scc0 L_hpoll
L_hpoll_ok:
    s_mov_b32 m0, s32
    s_nop 0
    buffer_load_dwordx4 v27, s[8:11], s28 offen offset:0 sc1 lds
    buffer_load_dwordx4 v27, s[8:11], s28 offen offset:1024 sc1 lds
    buffer_load_dwordx4 v29, s[8:11], s28 offen offset:2048 sc1 lds
    buffer_load_dwordx4 v29, s[8:11], s28 offen offset:3072 sc1 lds
    s_add_u32 s28, s28, 2048
    s_add_u32 m0, s32, 16384
    s_nop 0
    buffer_load_dwordx4 v27, s[8:11], s28 offen offset:0 sc1 lds
    buffer_load_dwordx4 v27, s[8:11], s28 offen offset:1024 sc1 lds
    buffer_load_dwordx4 v29, s[8:11], s28 offen offset:2048 sc1 lds
    buffer_load_dwordx4 v29, s[8:11], s28 offen offset:3072 sc1 lds
    s_add_u32 s28, s28, 2048
    v_mov_b32 v39, v38
    s_mov_b32 s37, 0x40000
L_hpoll2:
    v_and_b32 v38, v38, v39
    v_cmp_eq_u32 vcc, 1, v38
    s_nop 0
    s_or_b64 vcc, vcc, s[66:67]
    s_cmp_eq_u64 vcc, -1
    s_cbranch_scc1 L_hpoll2_ok
    s_sleep 2
    buffer_load_dwordx2 v[38:39], v37, s[20:23], s76 offen sc1
    s_sub_u32 s37, s37, 1
    s_waitcnt vmcnt(0)
    s_cbranch_scc0 L_hpoll2
L_hpoll2_ok:
    s_waitcnt vmcnt(4)
    s_barrier
    ds_read_b128 a[0:3], v2 offset:0
    ds_read_b64_tr_b16 a[16:17], v4 offset:0
    ds_read_b64_tr_b16 a[18:19], v4 offset:1024
    ds_read_b128 a[4:7], v2 offset:2048
    ds_read_b128 a[8:11], v3 offset:4096
    ds_read_b128 a[12:15], v3 offset:6144
    ds_read_b64_tr_b16 a[20:21], v5 offset:0
    ds_read_b64_tr_b16 a[22:23], v5 offset:1024
    ds_read_b64_tr_b16 a[24:25], v6 offset:0
    ds_read_b64_tr_b16 a[26:27], v6 offset:1024
    ds_read_b64_tr_b16 a[28:29], v7 offset:0
    ds_read_b64_tr_b16 a[30:31], v7 offset:1024
    s_lshl_b32 s44, s25, 7
    s_add_u32 s44, s44, 21561344
    s_lshl_b32 s47, s52, 8
    s_add_u32 s47, s47, 21594112
    v_lshlrev_b32 v24, 2, v1
    v_and_b32 v26, 124, v24
    s_waitcnt lgkmcnt(0)
    v_mfma_f32_16x16x32_bf16 v[32:35], a[16:19], a[0:3], 0
    ds_read_b128 a[32:35], v2 offset:1024
    s_add_u32 m0, s32, 32768
    s_nop 0
    buffer_load_dwordx4 v27, s[8:11], s28 offen offset:0 sc1 lds
    v_mfma_f32_16x16x32_bf16 v[36:39], a[16:19], a[4:7], 0
    ds_read_b64_tr_b16 a[48:49], v4 offset:8192
    buffer_load_dwordx4 v27, s[8:11], s28 offen offset:1024 sc1 lds
    v_mfma_f32_16x16x32_bf16 v[40:43], a[16:19], a[8:11], 0
    ds_read_b64_tr_b16 a[50:51], v4 offset:9216
    buffer_load_dwordx4 v29, s[8:11], s28 offen offset:2048 sc1 lds
    v_mfma_f32_16x16x32_bf16 v[44:47], a[16:19], a[12:15], 0
    ds_read_b128 a[36:39], v2 offset:3072
    buffer_load_dwordx4 v29, s[8:11], s28 offen offset:3072 sc1 lds
    s_add_u32 s28, s28, 2048
    v_mfma_f32_16x16x32_bf16 v[48:51], a[20:23], a[0:3], 0
    ds_read_b128 a[40:43], v3 offset:5120
    s_add_u32 m0, s32, 49152
    s_nop 0
    buffer_load_dwordx4 v27, s[8:11], s28 offen offset:0 sc1 lds
    v_mfma_f32_16x16x32_bf16 v[52:55], a[20:23], a[4:7], 0
    ds_read_b128 a[44:47], v3 offset:7168
    v_mfma_f32_16x16x32_bf16 v[56:59], a[20:23], a[8:11], 0
    ds_read_b64_tr_b16 a[52:53], v5 offset:8192
    v_mfma_f32_16x16x32_bf16 v[60:63], a[20:23], a[12:15], 0
    ds_read_b64_tr_b16 a[54:55], v5 offset:9216
    buffer_load_dwordx4 v27, s[8:11], s28 offen offset:1024 sc1 lds
    v_mfma_f32_16x16x32_bf16 v[64:67], a[24:27], a[0:3], 0
    ds_read_b64_tr_b16 a[56:57], v6 offset:8192
    v_mfma_f32_16x16x32_bf16 v[68:71], a[24:27], a[4:7], 0
    ds_read_b64_tr_b16 a[58:59], v6 offset:9216
    v_mfma_f32_16x16x32_bf16 v[72:75], a[24:27], a[8:11], 0
    ds_read_b64_tr_b16 a[60:61], v7 offset:8192
    v_mfma_f32_16x16x32_bf16 v[76:79], a[24:27], a[12:15], 0
    ds_read_b64_tr_b16 a[62:63], v7 offset:9216
    buffer_load_dwordx4 v29, s[8:11], s28 offen offset:2048 sc1 lds
    v_mfma_f32_16x16x32_bf16 v[80:83], a[28:31], a[0:3], 0
    v_mfma_f32_16x16x32_bf16 v[84:87], a[28:31], a[4:7], 0
    v_mfma_f32_16x16x32_bf16 v[88:91], a[28:31], a[8:11], 0
    v_mfma_f32_16x16x32_bf16 v[92:95], a[28:31], a[12:15], 0
    buffer_load_dwordx4 v29, s[8:11], s28 offen offset:3072 sc1 lds
    s_add_u32 s28, s28, 2048
    s_waitcnt lgkmcnt(0) vmcnt(8)
    s_barrier
    v_mfma_f32_16x16x32_bf16 v[32:35], a[48:51], a[32:35], v[32:35]
    ds_read_b128 a[0:3], v2 offset:16384
    v_mfma_f32_16x16x32_bf16 v[36:39], a[48:51], a[36:39], v[36:39]
    ds_read_b64_tr_b16 a[16:17], v4 offset:16384
    v_mfma_f32_16x16x32_bf16 v[40:43], a[48:51], a[40:43], v[40:43]
    ds_read_b64_tr_b16 a[18:19], v4 offset:17408
    v_mfma_f32_16x16x32_bf16 v[44:47], a[48:51], a[44:47], v[44:47]
    ds_read_b128 a[4:7], v2 offset:18432
    v_mfma_f32_16x16x32_bf16 v[48:51], a[52:55], a[32:35], v[48:51]
    ds_read_b128 a[8:11], v3 offset:20480
    v_mfma_f32_16x16x32_bf16 v[52:55], a[52:55], a[36:39], v[52:55]
    ds_read_b128 a[12:15], v3 offset:22528
    v_mfma_f32_16x16x32_bf16 v[56:59], a[52:55], a[40:43], v[56:59]
    ds_read_b64_tr_b16 a[20:21], v5 offset:16384
    v_mfma_f32_16x16x32_bf16 v[60:63], a[52:55], a[44:47], v[60:63]
    ds_read_b64_tr_b16 a[22:23], v5 offset:17408
    v_mfma_f32_16x16x32_bf16 v[64:67], a[56:59], a[32:35], v[64:67]
    ds_read_b64_tr_b16 a[24:25], v6 offset:16384
    v_mfma_f32_16x16x32_bf16 v[68:71], a[56:59], a[36:39], v[68:71]
    ds_read_b64_tr_b16 a[26:27], v6 offset:17408
    v_mfma_f32_16x16x32_bf16 v[72:75], a[56:59], a[40:43], v[72:75]
    ds_read_b64_tr_b16 a[28:29], v7 offset:16384
    v_mfma_f32_16x16x32_bf16 v[76:79], a[56:59], a[44:47], v[76:79]
    ds_read_b64_tr_b16 a[30:31], v7 offset:17408
    v_mfma_f32_16x16x32_bf16 v[80:83], a[60:63], a[32:35], v[80:83]
    v_mfma_f32_16x16x32_bf16 v[84:87], a[60:63], a[36:39], v[84:87]
    v_mfma_f32_16x16x32_bf16 v[88:91], a[60:63], a[40:43], v[88:91]
    v_mfma_f32_16x16x32_bf16 v[92:95], a[60:63], a[44:47], v[92:95]
    s_waitcnt lgkmcnt(0)
    v_mfma_f32_16x16x32_bf16 v[32:35], a[16:19], a[0:3], v[32:35]
    ds_read_b128 a[32:35], v2 offset:17408
    v_mfma_f32_16x16x32_bf16 v[36:39], a[16:19], a[4:7], v[36:39]
    ds_read_b64_tr_b16 a[48:49], v4 offset:24576
    v_mfma_f32_16x16x32_bf16 v[40:43], a[16:19], a[8:11], v[40:43]
    ds_read_b64_tr_b16 a[50:51], v4 offset:25600
    v_mfma_f32_16x16x32_bf16 v[44:47], a[16:19], a[12:15], v[44:47]
    ds_read_b128 a[36:39], v2 offset:19456
    v_mfma_f32_16x16x32_bf16 v[48:51], a[20:23], a[0:3], v[48:51]
    ds_read_b128 a[40:43], v3 offset:21504
    v_mfma_f32_16x16x32_bf16 v[52:55], a[20:23], a[4:7], v[52:55]
    ds_read_b128 a[44:47], v3 offset:23552
    v_mfma_f32_16x16x32_bf16 v[56:59], a[20:23], a[8:11], v[56:59]
    ds_read_b64_tr_b16 a[52:53], v5 offset:24576
    v_mfma_f32_16x16x32_bf16 v[60:63], a[20:23], a[12:15], v[60:63]
    ds_read_b64_tr_b16 a[54:55], v5 offset:25600
    v_mfma_f32_16x16x32_bf16 v[64:67], a[24:27], a[0:3], v[64:67]
    ds_read_b64_tr_b16 a[56:57], v6 offset:24576
    v_mfma_f32_16x16x32_bf16 v[68:71], a[24:27], a[4:7], v[68:71]
    ds_read_b64_tr_b16 a[58:59], v6 offset:25600
    v_mfma_f32_16x16x32_bf16 v[72:75], a[24:27], a[8:11], v[72:75]
    ds_read_b64_tr_b16 a[60:61], v7 offset:24576
    v_mfma_f32_16x16x32_bf16 v[76:79], a[24:27], a[12:15], v[76:79]
    ds_read_b64_tr_b16 a[62:63], v7 offset:25600
    v_mfma_f32_16x16x32_bf16 v[80:83], a[28:31], a[0:3], v[80:83]
    v_mfma_f32_16x16x32_bf16 v[84:87], a[28:31], a[4:7], v[84:87]
    v_mfma_f32_16x16x32_bf16 v[88:91], a[28:31], a[8:11], v[88:91]
    v_mfma_f32_16x16x32_bf16 v[92:95], a[28:31], a[12:15], v[92:95]
    buffer_load_dword v17, v26, s[20:23], s44 offen sc1
    s_waitcnt lgkmcnt(0) vmcnt(5)
    s_barrier
    v_mfma_f32_16x16x32_bf16 v[32:35], a[48:51], a[32:35], v[32:35]
    ds_read_b128 a[0:3], v2 offset:32768
    v_mfma_f32_16x16x32_bf16 v[36:39], a[48:51], a[36:39], v[36:39]
    ds_read_b64_tr_b16 a[16:17], v4 offset:32768
    v_mfma_f32_16x16x32_bf16 v[40:43], a[48:51], a[40:43], v[40:43]
    ds_read_b64_tr_b16 a[18:19], v4 offset:33792
    v_mfma_f32_16x16x32_bf16 v[44:47], a[48:51], a[44:47], v[44:47]
    ds_read_b128 a[4:7], v2 offset:34816
    v_mfma_f32_16x16x32_bf16 v[48:51], a[52:55], a[32:35], v[48:51]
    ds_read_b128 a[8:11], v3 offset:36864
    v_mfma_f32_16x16x32_bf16 v[52:55], a[52:55], a[36:39], v[52:55]
    ds_read_b128 a[12:15], v3 offset:38912
    v_mfma_f32_16x16x32_bf16 v[56:59], a[52:55], a[40:43], v[56:59]
    ds_read_b64_tr_b16 a[20:21], v5 offset:32768
    v_mfma_f32_16x16x32_bf16 v[60:63], a[52:55], a[44:47], v[60:63]
    ds_read_b64_tr_b16 a[22:23], v5 offset:33792
    v_mfma_f32_16x16x32_bf16 v[64:67], a[56:59], a[32:35], v[64:67]
    ds_read_b64_tr_b16 a[24:25], v6 offset:32768
    v_mfma_f32_16x16x32_bf16 v[68:71], a[56:59], a[36:39], v[68:71]
    ds_read_b64_tr_b16 a[26:27], v6 offset:33792
    v_mfma_f32_16x16x32_bf16 v[72:75], a[56:59], a[40:43], v[72:75]
    ds_read_b64_tr_b16 a[28:29], v7 offset:32768
    v_mfma_f32_16x16x32_bf16 v[76:79], a[56:59], a[44:47], v[76:79]
    ds_read_b64_tr_b16 a[30:31], v7 offset:33792
    v_mfma_f32_16x16x32_bf16 v[80:83], a[60:63], a[32:35], v[80:83]
    v_mfma_f32_16x16x32_bf16 v[84:87], a[60:63], a[36:39], v[84:87]
    v_mfma_f32_16x16x32_bf16 v[88:91], a[60:63], a[40:43], v[88:91]
    v_mfma_f32_16x16x32_bf16 v[92:95], a[60:63], a[44:47], v[92:95]
    s_waitcnt lgkmcnt(0)
    v_mfma_f32_16x16x32_bf16 v[32:35], a[16:19], a[0:3], v[32:35]
    ds_read_b128 a[32:35], v2 offset:33792
    v_mfma_f32_16x16x32_bf16 v[36:39], a[16:19], a[4:7], v[36:39]
    ds_read_b64_tr_b16 a[48:49], v4 offset:40960
    v_mfma_f32_16x16x32_bf16 v[40:43], a[16:19], a[8:11], v[40:43]
    ds_read_b64_tr_b16 a[50:51], v4 offset:41984
    v_mfma_f32_16x16x32_bf16 v[44:47], a[16:19], a[12:15], v[44:47]
    ds_read_b128 a[36:39], v2 offset:35840
    v_mfma_f32_16x16x32_bf16 v[48:51], a[20:23], a[0:3], v[48:51]
    ds_read_b128 a[40:43], v3 offset:37888
    v_mfma_f32_16x16x32_bf16 v[52:55], a[20:23], a[4:7], v[52:55]
    ds_read_b128 a[44:47], v3 offset:39936
    v_mfma_f32_16x16x32_bf16 v[56:59], a[20:23], a[8:11], v[56:59]
    ds_read_b64_tr_b16 a[52:53], v5 offset:40960
    v_mfma_f32_16x16x32_bf16 v[60:63], a[20:23], a[12:15], v[60:63]
    ds_read_b64_tr_b16 a[54:55], v5 offset:41984
    v_mfma_f32_16x16x32_bf16 v[64:67], a[24:27], a[0:3], v[64:67]
    ds_read_b64_tr_b16 a[56:57], v6 offset:40960
    v_mfma_f32_16x16x32_bf16 v[68:71], a[24:27], a[4:7], v[68:71]
    ds_read_b64_tr_b16 a[58:59], v6 offset:41984
    v_mfma_f32_16x16x32_bf16 v[72:75], a[24:27], a[8:11], v[72:75]
    ds_read_b64_tr_b16 a[60:61], v7 offset:40960
    v_mfma_f32_16x16x32_bf16 v[76:79], a[24:27], a[12:15], v[76:79]
    ds_read_b64_tr_b16 a[62:63], v7 offset:41984
    v_mfma_f32_16x16x32_bf16 v[80:83], a[28:31], a[0:3], v[80:83]
    v_mfma_f32_16x16x32_bf16 v[84:87], a[28:31], a[4:7], v[84:87]
    v_mfma_f32_16x16x32_bf16 v[88:91], a[28:31], a[8:11], v[88:91]
    v_mfma_f32_16x16x32_bf16 v[92:95], a[28:31], a[12:15], v[92:95]
    s_waitcnt lgkmcnt(0) vmcnt(1)
    s_barrier
    v_mfma_f32_16x16x32_bf16 v[32:35], a[48:51], a[32:35], v[32:35]
    ds_read_b128 a[0:3], v2 offset:49152
    v_mfma_f32_16x16x32_bf16 v[36:39], a[48:51], a[36:39], v[36:39]
    ds_read_b64_tr_b16 a[16:17], v4 offset:49152
    v_mfma_f32_16x16x32_bf16 v[40:43], a[48:51], a[40:43], v[40:43]
    ds_read_b64_tr_b16 a[18:19], v4 offset:50176
    v_mfma_f32_16x16x32_bf16 v[44:47], a[48:51], a[44:47], v[44:47]
    ds_read_b128 a[4:7], v2 offset:51200
    v_mfma_f32_16x16x32_bf16 v[48:51], a[52:55], a[32:35], v[48:51]
    ds_read_b128 a[8:11], v3 offset:53248
    v_mfma_f32_16x16x32_bf16 v[52:55], a[52:55], a[36:39], v[52:55]
    ds_read_b128 a[12:15], v3 offset:55296
    v_mfma_f32_16x16x32_bf16 v[56:59], a[52:55], a[40:43], v[56:59]
    ds_read_b64_tr_b16 a[20:21], v5 offset:49152
    v_mfma_f32_16x16x32_bf16 v[60:63], a[52:55], a[44:47], v[60:63]
    ds_read_b64_tr_b16 a[22:23], v5 offset:50176
    v_mfma_f32_16x16x32_bf16 v[64:67], a[56:59], a[32:35], v[64:67]
    ds_read_b64_tr_b16 a[24:25], v6 offset:49152
    v_mfma_f32_16x16x32_bf16 v[68:71], a[56:59], a[36:39], v[68:71]
    ds_read_b64_tr_b16 a[26:27], v6 offset:50176
    v_mfma_f32_16x16x32_bf16 v[72:75], a[56:59], a[40:43], v[72:75]
    ds_read_b64_tr_b16 a[28:29], v7 offset:49152
    v_mfma_f32_16x16x32_bf16 v[76:79], a[56:59], a[44:47], v[76:79]
    ds_read_b64_tr_b16 a[30:31], v7 offset:50176
    v_mfma_f32_16x16x32_bf16 v[80:83], a[60:63], a[32:35], v[80:83]
    v_mfma_f32_16x16x32_bf16 v[84:87], a[60:63], a[36:39], v[84:87]
    v_mfma_f32_16x16x32_bf16 v[88:91], a[60:63], a[40:43], v[88:91]
    v_mfma_f32_16x16x32_bf16 v[92:95], a[60:63], a[44:47], v[92:95]
    s_waitcnt lgkmcnt(0)
    v_mfma_f32_16x16x32_bf16 v[32:35], a[16:19], a[0:3], v[32:35]
    ds_read_b128 a[32:35], v2 offset:50176
    v_mfma_f32_16x16x32_bf16 v[36:39], a[16:19], a[4:7], v[36:39]
    ds_read_b64_tr_b16 a[48:49], v4 offset:57344
    v_mfma_f32_16x16x32_bf16 v[40:43], a[16:19], a[8:11], v[40:43]
    ds_read_b64_tr_b16 a[50:51], v4 offset:58368
    v_mfma_f32_16x16x32_bf16 v[44:47], a[16:19], a[12:15], v[44:47]
    ds_read_b128 a[36:39], v2 offset:52224
    v_mfma_f32_16x16x32_bf16 v[48:51], a[20:23], a[0:3], v[48:51]
    ds_read_b128 a[40:43], v3 offset:54272
    v_mfma_f32_16x16x32_bf16 v[52:55], a[20:23], a[4:7], v[52:55]
    ds_read_b128 a[44:47], v3 offset:56320
    v_mfma_f32_16x16x32_bf16 v[56:59], a[20:23], a[8:11], v[56:59]
    ds_read_b64_tr_b16 a[52:53], v5 offset:57344
    v_mfma_f32_16x16x32_bf16 v[60:63], a[20:23], a[12:15], v[60:63]
    ds_read_b64_tr_b16 a[54:55], v5 offset:58368
    v_mfma_f32_16x16x32_bf16 v[64:67], a[24:27], a[0:3], v[64:67]
    ds_read_b64_tr_b16 a[56:57], v6 offset:57344
    v_mfma_f32_16x16x32_bf16 v[68:71], a[24:27], a[4:7], v[68:71]
    ds_read_b64_tr_b16 a[58:59], v6 offset:58368
    v_mfma_f32_16x16x32_bf16 v[72:75], a[24:27], a[8:11], v[72:75]
    ds_read_b64_tr_b16 a[60:61], v7 offset:57344
    v_mfma_f32_16x16x32_bf16 v[76:79], a[24:27], a[12:15], v[76:79]
    ds_read_b64_tr_b16 a[62:63], v7 offset:58368
    v_mfma_f32_16x16x32_bf16 v[80:83], a[28:31], a[0:3], v[80:83]
    v_mfma_f32_16x16x32_bf16 v[84:87], a[28:31], a[4:7], v[84:87]
    v_mfma_f32_16x16x32_bf16 v[88:91], a[28:31], a[8:11], v[88:91]
    v_mfma_f32_16x16x32_bf16 v[92:95], a[28:31], a[12:15], v[92:95]
    s_waitcnt vmcnt(0)
    s_mov_b32 s37, 0x40000
L_kvpoll:
    v_cmp_eq_u32 vcc, 1, v17
    s_nop 0
    s_cmp_eq_u64 vcc, -1
    s_cbranch_scc1 L_kvpoll_ok
    s_sleep 2
    buffer_load_dword v17, v26, s[20:23], s44 offen sc1
    s_sub_u32 s37, s37, 1
    s_waitcnt vmcnt(0)
    s_cbranch_scc0 L_kvpoll
L_kvpoll_ok:
    s_waitcnt lgkmcnt(0)
    s_barrier
    v_mfma_f32_16x16x32_bf16 v[32:35], a[48:51], a[32:35], v[32:35]
    ds_read_b128 a[0:3], v2 offset:0
    v_mfma_f32_16x16x32_bf16 v[36:39], a[48:51], a[36:39], v[36:39]
    ds_read_b64_tr_b16 a[16:17], v4 offset:0
    v_mfma_f32_16x16x32_bf16 v[40:43], a[48:51], a[40:43], v[40:43]
    ds_read_b64_tr_b16 a[18:19], v4 offset:1024
    v_mfma_f32_16x16x32_bf16 v[44:47], a[48:51], a[44:47], v[44:47]
    ds_read_b128 a[4:7], v2 offset:2048
    v_mfma_f32_16x16x32_bf16 v[48:51], a[52:55], a[32:35], v[48:51]
    ds_read_b128 a[8:11], v3 offset:4096
    v_mfma_f32_16x16x32_bf16 v[52:55], a[52:55], a[36:39], v[52:55]
    ds_read_b128 a[12:15], v3 offset:6144
    v_mfma_f32_16x16x32_bf16 v[56:59], a[52:55], a[40:43], v[56:59]
    ds_read_b64_tr_b16 a[20:21], v5 offset:0
    v_mfma_f32_16x16x32_bf16 v[60:63], a[52:55], a[44:47], v[60:63]
    ds_read_b64_tr_b16 a[22:23], v5 offset:1024
    v_mfma_f32_16x16x32_bf16 v[64:67], a[56:59], a[32:35], v[64:67]
    ds_read_b64_tr_b16 a[24:25], v6 offset:0
    v_mfma_f32_16x16x32_bf16 v[68:71], a[56:59], a[36:39], v[68:71]
    ds_read_b64_tr_b16 a[26:27], v6 offset:1024
    v_mfma_f32_16x16x32_bf16 v[72:75], a[56:59], a[40:43], v[72:75]
    ds_read_b64_tr_b16 a[28:29], v7 offset:0
    v_mfma_f32_16x16x32_bf16 v[76:79], a[56:59], a[44:47], v[76:79]
    ds_read_b64_tr_b16 a[30:31], v7 offset:1024
    v_mfma_f32_16x16x32_bf16 v[80:83], a[60:63], a[32:35], v[80:83]
    v_mfma_f32_16x16x32_bf16 v[84:87], a[60:63], a[36:39], v[84:87]
    v_mfma_f32_16x16x32_bf16 v[88:91], a[60:63], a[40:43], v[88:91]
    v_mfma_f32_16x16x32_bf16 v[92:95], a[60:63], a[44:47], v[92:95]
    s_waitcnt lgkmcnt(0)
    v_mfma_f32_16x16x32_bf16 v[32:35], a[16:19], a[0:3], v[32:35]
    ds_read_b128 a[32:35], v2 offset:1024
    v_mfma_f32_16x16x32_bf16 v[36:39], a[16:19], a[4:7], v[36:39]
    ds_read_b64_tr_b16 a[48:49], v4 offset:8192
    v_mfma_f32_16x16x32_bf16 v[40:43], a[16:19], a[8:11], v[40:43]
    ds_read_b64_tr_b16 a[50:51], v4 offset:9216
    v_mfma_f32_16x16x32_bf16 v[44:47], a[16:19], a[12:15], v[44:47]
    ds_read_b128 a[36:39], v2 offset:3072
    v_mfma_f32_16x16x32_bf16 v[48:51], a[20:23], a[0:3], v[48:51]
    ds_read_b128 a[40:43], v3 offset:5120
    v_mfma_f32_16x16x32_bf16 v[52:55], a[20:23], a[4:7], v[52:55]
    ds_read_b128 a[44:47], v3 offset:7168
    v_mfma_f32_16x16x32_bf16 v[56:59], a[20:23], a[8:11], v[56:59]
    ds_read_b64_tr_b16 a[52:53], v5 offset:8192
    v_mfma_f32_16x16x32_bf16 v[60:63], a[20:23], a[12:15], v[60:63]
    ds_read_b64_tr_b16 a[54:55], v5 offset:9216
    v_mfma_f32_16x16x32_bf16 v[64:67], a[24:27], a[0:3], v[64:67]
    ds_read_b64_tr_b16 a[56:57], v6 offset:8192
    v_mfma_f32_16x16x32_bf16 v[68:71], a[24:27], a[4:7], v[68:71]
    ds_read_b64_tr_b16 a[58:59], v6 offset:9216
    v_mfma_f32_16x16x32_bf16 v[72:75], a[24:27], a[8:11], v[72:75]
    ds_read_b64_tr_b16 a[60:61], v7 offset:8192
    v_mfma_f32_16x16x32_bf16 v[76:79], a[24:27], a[12:15], v[76:79]
    ds_read_b64_tr_b16 a[62:63], v7 offset:9216
    v_mfma_f32_16x16x32_bf16 v[80:83], a[28:31], a[0:3], v[80:83]
    v_mfma_f32_16x16x32_bf16 v[84:87], a[28:31], a[4:7], v[84:87]
    v_mfma_f32_16x16x32_bf16 v[88:91], a[28:31], a[8:11], v[88:91]
    v_mfma_f32_16x16x32_bf16 v[92:95], a[28:31], a[12:15], v[92:95]
    s_waitcnt lgkmcnt(0)
    s_barrier
    v_mfma_f32_16x16x32_bf16 v[32:35], a[48:51], a[32:35], v[32:35]
    ds_read_b128 a[0:3], v2 offset:16384
    v_mfma_f32_16x16x32_bf16 v[36:39], a[48:51], a[36:39], v[36:39]
    ds_read_b64_tr_b16 a[16:17], v4 offset:16384
    v_mfma_f32_16x16x32_bf16 v[40:43], a[48:51], a[40:43], v[40:43]
    ds_read_b64_tr_b16 a[18:19], v4 offset:17408
    v_mfma_f32_16x16x32_bf16 v[44:47], a[48:51], a[44:47], v[44:47]
    ds_read_b128 a[4:7], v2 offset:18432
    v_mfma_f32_16x16x32_bf16 v[48:51], a[52:55], a[32:35], v[48:51]
    ds_read_b128 a[8:11], v3 offset:20480
    v_mfma_f32_16x16x32_bf16 v[52:55], a[52:55], a[36:39], v[52:55]
    ds_read_b128 a[12:15], v3 offset:22528
    v_mfma_f32_16x16x32_bf16 v[56:59], a[52:55], a[40:43], v[56:59]
    ds_read_b64_tr_b16 a[20:21], v5 offset:16384
    v_mfma_f32_16x16x32_bf16 v[60:63], a[52:55], a[44:47], v[60:63]
    ds_read_b64_tr_b16 a[22:23], v5 offset:17408
    v_mfma_f32_16x16x32_bf16 v[64:67], a[56:59], a[32:35], v[64:67]
    ds_read_b64_tr_b16 a[24:25], v6 offset:16384
    v_mfma_f32_16x16x32_bf16 v[68:71], a[56:59], a[36:39], v[68:71]
    ds_read_b64_tr_b16 a[26:27], v6 offset:17408
    v_mfma_f32_16x16x32_bf16 v[72:75], a[56:59], a[40:43], v[72:75]
    ds_read_b64_tr_b16 a[28:29], v7 offset:16384
    v_mfma_f32_16x16x32_bf16 v[76:79], a[56:59], a[44:47], v[76:79]
    ds_read_b64_tr_b16 a[30:31], v7 offset:17408
    v_mfma_f32_16x16x32_bf16 v[80:83], a[60:63], a[32:35], v[80:83]
    v_mfma_f32_16x16x32_bf16 v[84:87], a[60:63], a[36:39], v[84:87]
    v_mfma_f32_16x16x32_bf16 v[88:91], a[60:63], a[40:43], v[88:91]
    v_mfma_f32_16x16x32_bf16 v[92:95], a[60:63], a[44:47], v[92:95]
    s_waitcnt lgkmcnt(0)
    v_mfma_f32_16x16x32_bf16 v[32:35], a[16:19], a[0:3], v[32:35]
    ds_read_b128 a[32:35], v2 offset:17408
    v_mfma_f32_16x16x32_bf16 v[36:39], a[16:19], a[4:7], v[36:39]
    ds_read_b64_tr_b16 a[48:49], v4 offset:24576
    v_mfma_f32_16x16x32_bf16 v[40:43], a[16:19], a[8:11], v[40:43]
    ds_read_b64_tr_b16 a[50:51], v4 offset:25600
    v_mfma_f32_16x16x32_bf16 v[44:47], a[16:19], a[12:15], v[44:47]
    ds_read_b128 a[36:39], v2 offset:19456
    v_mfma_f32_16x16x32_bf16 v[48:51], a[20:23], a[0:3], v[48:51]
    ds_read_b128 a[40:43], v3 offset:21504
    v_mfma_f32_16x16x32_bf16 v[52:55], a[20:23], a[4:7], v[52:55]
    ds_read_b128 a[44:47], v3 offset:23552
    v_mfma_f32_16x16x32_bf16 v[56:59], a[20:23], a[8:11], v[56:59]
    ds_read_b64_tr_b16 a[52:53], v5 offset:24576
    v_mfma_f32_16x16x32_bf16 v[60:63], a[20:23], a[12:15], v[60:63]
    ds_read_b64_tr_b16 a[54:55], v5 offset:25600
    v_mfma_f32_16x16x32_bf16 v[64:67], a[24:27], a[0:3], v[64:67]
    ds_read_b64_tr_b16 a[56:57], v6 offset:24576
    v_mfma_f32_16x16x32_bf16 v[68:71], a[24:27], a[4:7], v[68:71]
    ds_read_b64_tr_b16 a[58:59], v6 offset:25600
    v_mfma_f32_16x16x32_bf16 v[72:75], a[24:27], a[8:11], v[72:75]
    ds_read_b64_tr_b16 a[60:61], v7 offset:24576
    v_mfma_f32_16x16x32_bf16 v[76:79], a[24:27], a[12:15], v[76:79]
    ds_read_b64_tr_b16 a[62:63], v7 offset:25600
    v_mfma_f32_16x16x32_bf16 v[80:83], a[28:31], a[0:3], v[80:83]
    v_mfma_f32_16x16x32_bf16 v[84:87], a[28:31], a[4:7], v[84:87]
    v_mfma_f32_16x16x32_bf16 v[88:91], a[28:31], a[8:11], v[88:91]
    v_mfma_f32_16x16x32_bf16 v[92:95], a[28:31], a[12:15], v[92:95]
    s_waitcnt lgkmcnt(0)
    s_barrier
    v_mfma_f32_16x16x32_bf16 v[32:35], a[48:51], a[32:35], v[32:35]
    ds_read_b128 a[0:3], v2 offset:32768
    v_mfma_f32_16x16x32_bf16 v[36:39], a[48:51], a[36:39], v[36:39]
    ds_read_b64_tr_b16 a[16:17], v4 offset:32768
    v_mfma_f32_16x16x32_bf16 v[40:43], a[48:51], a[40:43], v[40:43]
    ds_read_b64_tr_b16 a[18:19], v4 offset:33792
    v_mfma_f32_16x16x32_bf16 v[44:47], a[48:51], a[44:47], v[44:47]
    ds_read_b128 a[4:7], v2 offset:34816
    v_mfma_f32_16x16x32_bf16 v[48:51], a[52:55], a[32:35], v[48:51]
    ds_read_b128 a[8:11], v3 offset:36864
    v_mfma_f32_16x16x32_bf16 v[52:55], a[52:55], a[36:39], v[52:55]
    ds_read_b128 a[12:15], v3 offset:38912
    v_mfma_f32_16x16x32_bf16 v[56:59], a[52:55], a[40:43], v[56:59]
    ds_read_b64_tr_b16 a[20:21], v5 offset:32768
    v_mfma_f32_16x16x32_bf16 v[60:63], a[52:55], a[44:47], v[60:63]
    ds_read_b64_tr_b16 a[22:23], v5 offset:33792
    v_mfma_f32_16x16x32_bf16 v[64:67], a[56:59], a[32:35], v[64:67]
    ds_read_b64_tr_b16 a[24:25], v6 offset:32768
    v_mfma_f32_16x16x32_bf16 v[68:71], a[56:59], a[36:39], v[68:71]
    ds_read_b64_tr_b16 a[26:27], v6 offset:33792
    v_mfma_f32_16x16x32_bf16 v[72:75], a[56:59], a[40:43], v[72:75]
    ds_read_b64_tr_b16 a[28:29], v7 offset:32768
    v_mfma_f32_16x16x32_bf16 v[76:79], a[56:59], a[44:47], v[76:79]
    ds_read_b64_tr_b16 a[30:31], v7 offset:33792
    v_mfma_f32_16x16x32_bf16 v[80:83], a[60:63], a[32:35], v[80:83]
    v_mfma_f32_16x16x32_bf16 v[84:87], a[60:63], a[36:39], v[84:87]
    v_mfma_f32_16x16x32_bf16 v[88:91], a[60:63], a[40:43], v[88:91]
    v_mfma_f32_16x16x32_bf16 v[92:95], a[60:63], a[44:47], v[92:95]
    s_waitcnt lgkmcnt(0)
    v_mfma_f32_16x16x32_bf16 v[32:35], a[16:19], a[0:3], v[32:35]
    ds_read_b128 a[32:35], v2 offset:33792
    v_mfma_f32_16x16x32_bf16 v[36:39], a[16:19], a[4:7], v[36:39]
    ds_read_b64_tr_b16 a[48:49], v4 offset:40960
    v_mfma_f32_16x16x32_bf16 v[40:43], a[16:19], a[8:11], v[40:43]
    ds_read_b64_tr_b16 a[50:51], v4 offset:41984
    v_mfma_f32_16x16x32_bf16 v[44:47], a[16:19], a[12:15], v[44:47]
    ds_read_b128 a[36:39], v2 offset:35840
    v_mfma_f32_16x16x32_bf16 v[48:51], a[20:23], a[0:3], v[48:51]
    ds_read_b128 a[40:43], v3 offset:37888
    v_mfma_f32_16x16x32_bf16 v[52:55], a[20:23], a[4:7], v[52:55]
    ds_read_b128 a[44:47], v3 offset:39936
    v_mfma_f32_16x16x32_bf16 v[56:59], a[20:23], a[8:11], v[56:59]
    ds_read_b64_tr_b16 a[52:53], v5 offset:40960
    v_mfma_f32_16x16x32_bf16 v[60:63], a[20:23], a[12:15], v[60:63]
    ds_read_b64_tr_b16 a[54:55], v5 offset:41984
    v_mfma_f32_16x16x32_bf16 v[64:67], a[24:27], a[0:3], v[64:67]
    ds_read_b64_tr_b16 a[56:57], v6 offset:40960
    v_mfma_f32_16x16x32_bf16 v[68:71], a[24:27], a[4:7], v[68:71]
    ds_read_b64_tr_b16 a[58:59], v6 offset:41984
    v_mfma_f32_16x16x32_bf16 v[72:75], a[24:27], a[8:11], v[72:75]
    ds_read_b64_tr_b16 a[60:61], v7 offset:40960
    v_mfma_f32_16x16x32_bf16 v[76:79], a[24:27], a[12:15], v[76:79]
    ds_read_b64_tr_b16 a[62:63], v7 offset:41984
    v_mfma_f32_16x16x32_bf16 v[80:83], a[28:31], a[0:3], v[80:83]
    v_mfma_f32_16x16x32_bf16 v[84:87], a[28:31], a[4:7], v[84:87]
    v_mfma_f32_16x16x32_bf16 v[88:91], a[28:31], a[8:11], v[88:91]
    v_mfma_f32_16x16x32_bf16 v[92:95], a[28:31], a[12:15], v[92:95]
    s_waitcnt lgkmcnt(0)
    s_barrier
    v_mfma_f32_16x16x32_bf16 v[32:35], a[48:51], a[32:35], v[32:35]
    ds_read_b128 a[0:3], v2 offset:49152
    v_mfma_f32_16x16x32_bf16 v[36:39], a[48:51], a[36:39], v[36:39]
    ds_read_b64_tr_b16 a[16:17], v4 offset:49152
    v_mfma_f32_16x16x32_bf16 v[40:43], a[48:51], a[40:43], v[40:43]
    ds_read_b64_tr_b16 a[18:19], v4 offset:50176
    v_mfma_f32_16x16x32_bf16 v[44:47], a[48:51], a[44:47], v[44:47]
    ds_read_b128 a[4:7], v2 offset:51200
    v_mfma_f32_16x16x32_bf16 v[48:51], a[52:55], a[32:35], v[48:51]
    ds_read_b128 a[8:11], v3 offset:53248
    v_mfma_f32_16x16x32_bf16 v[52:55], a[52:55], a[36:39], v[52:55]
    ds_read_b128 a[12:15], v3 offset:55296
    v_mfma_f32_16x16x32_bf16 v[56:59], a[52:55], a[40:43], v[56:59]
    ds_read_b64_tr_b16 a[20:21], v5 offset:49152
    v_mfma_f32_16x16x32_bf16 v[60:63], a[52:55], a[44:47], v[60:63]
    ds_read_b64_tr_b16 a[22:23], v5 offset:50176
    v_mfma_f32_16x16x32_bf16 v[64:67], a[56:59], a[32:35], v[64:67]
    ds_read_b64_tr_b16 a[24:25], v6 offset:49152
    v_mfma_f32_16x16x32_bf16 v[68:71], a[56:59], a[36:39], v[68:71]
    ds_read_b64_tr_b16 a[26:27], v6 offset:50176
    v_mfma_f32_16x16x32_bf16 v[72:75], a[56:59], a[40:43], v[72:75]
    ds_read_b64_tr_b16 a[28:29], v7 offset:49152
    v_mfma_f32_16x16x32_bf16 v[76:79], a[56:59], a[44:47], v[76:79]
    ds_read_b64_tr_b16 a[30:31], v7 offset:50176
    v_mfma_f32_16x16x32_bf16 v[80:83], a[60:63], a[32:35], v[80:83]
    v_mfma_f32_16x16x32_bf16 v[84:87], a[60:63], a[36:39], v[84:87]
    v_mfma_f32_16x16x32_bf16 v[88:91], a[60:63], a[40:43], v[88:91]
    v_mfma_f32_16x16x32_bf16 v[92:95], a[60:63], a[44:47], v[92:95]
    s_waitcnt lgkmcnt(0)
    v_mfma_f32_16x16x32_bf16 v[32:35], a[16:19], a[0:3], v[32:35]
    ds_read_b128 a[32:35], v2 offset:50176
    v_mfma_f32_16x16x32_bf16 v[36:39], a[16:19], a[4:7], v[36:39]
    ds_read_b64_tr_b16 a[48:49], v4 offset:57344
    v_mfma_f32_16x16x32_bf16 v[40:43], a[16:19], a[8:11], v[40:43]
    ds_read_b64_tr_b16 a[50:51], v4 offset:58368
    v_mfma_f32_16x16x32_bf16 v[44:47], a[16:19], a[12:15], v[44:47]
    ds_read_b128 a[36:39], v2 offset:52224
    v_mfma_f32_16x16x32_bf16 v[48:51], a[20:23], a[0:3], v[48:51]
    ds_read_b128 a[40:43], v3 offset:54272
    v_mfma_f32_16x16x32_bf16 v[52:55], a[20:23], a[4:7], v[52:55]
    ds_read_b128 a[44:47], v3 offset:56320
    v_mfma_f32_16x16x32_bf16 v[56:59], a[20:23], a[8:11], v[56:59]
    ds_read_b64_tr_b16 a[52:53], v5 offset:57344
    v_mfma_f32_16x16x32_bf16 v[60:63], a[20:23], a[12:15], v[60:63]
    ds_read_b64_tr_b16 a[54:55], v5 offset:58368
    v_mfma_f32_16x16x32_bf16 v[64:67], a[24:27], a[0:3], v[64:67]
    ds_read_b64_tr_b16 a[56:57], v6 offset:57344
    v_mfma_f32_16x16x32_bf16 v[68:71], a[24:27], a[4:7], v[68:71]
    ds_read_b64_tr_b16 a[58:59], v6 offset:58368
    v_mfma_f32_16x16x32_bf16 v[72:75], a[24:27], a[8:11], v[72:75]
    ds_read_b64_tr_b16 a[60:61], v7 offset:57344
    v_mfma_f32_16x16x32_bf16 v[76:79], a[24:27], a[12:15], v[76:79]
    ds_read_b64_tr_b16 a[62:63], v7 offset:58368
    v_mfma_f32_16x16x32_bf16 v[80:83], a[28:31], a[0:3], v[80:83]
    v_mfma_f32_16x16x32_bf16 v[84:87], a[28:31], a[4:7], v[84:87]
    v_mfma_f32_16x16x32_bf16 v[88:91], a[28:31], a[8:11], v[88:91]
    v_mfma_f32_16x16x32_bf16 v[92:95], a[28:31], a[12:15], v[92:95]
    s_waitcnt lgkmcnt(0)
    s_barrier
    v_mfma_f32_16x16x32_bf16 v[32:35], a[48:51], a[32:35], v[32:35]
    ds_read_b128 a[0:3], v2 offset:0
    v_mfma_f32_16x16x32_bf16 v[36:39], a[48:51], a[36:39], v[36:39]
    ds_read_b64_tr_b16 a[16:17], v4 offset:0
    v_mfma_f32_16x16x32_bf16 v[40:43], a[48:51], a[40:43], v[40:43]
    ds_read_b64_tr_b16 a[18:19], v4 offset:1024
    v_mfma_f32_16x16x32_bf16 v[44:47], a[48:51], a[44:47], v[44:47]
    ds_read_b128 a[4:7], v2 offset:2048
    v_mfma_f32_16x16x32_bf16 v[48:51], a[52:55], a[32:35], v[48:51]
    ds_read_b128 a[8:11], v3 offset:4096
    v_mfma_f32_16x16x32_bf16 v[52:55], a[52:55], a[36:39], v[52:55]
    ds_read_b128 a[12:15], v3 offset:6144
    v_mfma_f32_16x16x32_bf16 v[56:59], a[52:55], a[40:43], v[56:59]
    ds_read_b64_tr_b16 a[20:21], v5 offset:0
    v_mfma_f32_16x16x32_bf16 v[60:63], a[52:55], a[44:47], v[60:63]
    ds_read_b64_tr_b16 a[22:23], v5 offset:1024
    v_mfma_f32_16x16x32_bf16 v[64:67], a[56:59], a[32:35], v[64:67]
    ds_read_b64_tr_b16 a[24:25], v6 offset:0
    v_mfma_f32_16x16x32_bf16 v[68:71], a[56:59], a[36:39], v[68:71]
    ds_read_b64_tr_b16 a[26:27], v6 offset:1024
    v_mfma_f32_16x16x32_bf16 v[72:75], a[56:59], a[40:43], v[72:75]
    ds_read_b64_tr_b16 a[28:29], v7 offset:0
    v_mfma_f32_16x16x32_bf16 v[76:79], a[56:59], a[44:47], v[76:79]
    ds_read_b64_tr_b16 a[30:31], v7 offset:1024
    v_mfma_f32_16x16x32_bf16 v[80:83], a[60:63], a[32:35], v[80:83]
    v_mfma_f32_16x16x32_bf16 v[84:87], a[60:63], a[36:39], v[84:87]
    v_mfma_f32_16x16x32_bf16 v[88:91], a[60:63], a[40:43], v[88:91]
    v_mfma_f32_16x16x32_bf16 v[92:95], a[60:63], a[44:47], v[92:95]
    s_waitcnt lgkmcnt(0)
    v_mfma_f32_16x16x32_bf16 v[32:35], a[16:19], a[0:3], v[32:35]
    ds_read_b128 a[32:35], v2 offset:1024
    v_mfma_f32_16x16x32_bf16 v[36:39], a[16:19], a[4:7], v[36:39]
    ds_read_b64_tr_b16 a[48:49], v4 offset:8192
    v_mfma_f32_16x16x32_bf16 v[40:43], a[16:19], a[8:11], v[40:43]
    ds_read_b64_tr_b16 a[50:51], v4 offset:9216
    v_mfma_f32_16x16x32_bf16 v[44:47], a[16:19], a[12:15], v[44:47]
    ds_read_b128 a[36:39], v2 offset:3072
    v_mfma_f32_16x16x32_bf16 v[48:51], a[20:23], a[0:3], v[48:51]
    ds_read_b128 a[40:43], v3 offset:5120
    v_mfma_f32_16x16x32_bf16 v[52:55], a[20:23], a[4:7], v[52:55]
    ds_read_b128 a[44:47], v3 offset:7168
    v_mfma_f32_16x16x32_bf16 v[56:59], a[20:23], a[8:11], v[56:59]
    ds_read_b64_tr_b16 a[52:53], v5 offset:8192
    v_mfma_f32_16x16x32_bf16 v[60:63], a[20:23], a[12:15], v[60:63]
    ds_read_b64_tr_b16 a[54:55], v5 offset:9216
    v_mfma_f32_16x16x32_bf16 v[64:67], a[24:27], a[0:3], v[64:67]
    ds_read_b64_tr_b16 a[56:57], v6 offset:8192
    v_mfma_f32_16x16x32_bf16 v[68:71], a[24:27], a[4:7], v[68:71]
    ds_read_b64_tr_b16 a[58:59], v6 offset:9216
    v_mfma_f32_16x16x32_bf16 v[72:75], a[24:27], a[8:11], v[72:75]
    ds_read_b64_tr_b16 a[60:61], v7 offset:8192
    v_mfma_f32_16x16x32_bf16 v[76:79], a[24:27], a[12:15], v[76:79]
    ds_read_b64_tr_b16 a[62:63], v7 offset:9216
    v_mfma_f32_16x16x32_bf16 v[80:83], a[28:31], a[0:3], v[80:83]
    v_mfma_f32_16x16x32_bf16 v[84:87], a[28:31], a[4:7], v[84:87]
    v_mfma_f32_16x16x32_bf16 v[88:91], a[28:31], a[8:11], v[88:91]
    v_mfma_f32_16x16x32_bf16 v[92:95], a[28:31], a[12:15], v[92:95]
    s_waitcnt lgkmcnt(0)
    s_barrier
    v_mfma_f32_16x16x32_bf16 v[32:35], a[48:51], a[32:35], v[32:35]
    ds_read_b128 a[0:3], v2 offset:16384
    v_mfma_f32_16x16x32_bf16 v[36:39], a[48:51], a[36:39], v[36:39]
    ds_read_b64_tr_b16 a[16:17], v4 offset:16384
    v_mfma_f32_16x16x32_bf16 v[40:43], a[48:51], a[40:43], v[40:43]
    ds_read_b64_tr_b16 a[18:19], v4 offset:17408
    v_mfma_f32_16x16x32_bf16 v[44:47], a[48:51], a[44:47], v[44:47]
    ds_read_b128 a[4:7], v2 offset:18432
    v_mfma_f32_16x16x32_bf16 v[48:51], a[52:55], a[32:35], v[48:51]
    ds_read_b128 a[8:11], v3 offset:20480
    v_mfma_f32_16x16x32_bf16 v[52:55], a[52:55], a[36:39], v[52:55]
    ds_read_b128 a[12:15], v3 offset:22528
    v_mfma_f32_16x16x32_bf16 v[56:59], a[52:55], a[40:43], v[56:59]
    ds_read_b64_tr_b16 a[20:21], v5 offset:16384
    v_mfma_f32_16x16x32_bf16 v[60:63], a[52:55], a[44:47], v[60:63]
    ds_read_b64_tr_b16 a[22:23], v5 offset:17408
    v_mfma_f32_16x16x32_bf16 v[64:67], a[56:59], a[32:35], v[64:67]
    ds_read_b64_tr_b16 a[24:25], v6 offset:16384
    v_mfma_f32_16x16x32_bf16 v[68:71], a[56:59], a[36:39], v[68:71]
    ds_read_b64_tr_b16 a[26:27], v6 offset:17408
    v_mfma_f32_16x16x32_bf16 v[72:75], a[56:59], a[40:43], v[72:75]
    ds_read_b64_tr_b16 a[28:29], v7 offset:16384
    v_mfma_f32_16x16x32_bf16 v[76:79], a[56:59], a[44:47], v[76:79]
    ds_read_b64_tr_b16 a[30:31], v7 offset:17408
    v_mfma_f32_16x16x32_bf16 v[80:83], a[60:63], a[32:35], v[80:83]
    v_mfma_f32_16x16x32_bf16 v[84:87], a[60:63], a[36:39], v[84:87]
    v_mfma_f32_16x16x32_bf16 v[88:91], a[60:63], a[40:43], v[88:91]
    v_mfma_f32_16x16x32_bf16 v[92:95], a[60:63], a[44:47], v[92:95]
    s_waitcnt lgkmcnt(0)
    v_mfma_f32_16x16x32_bf16 v[32:35], a[16:19], a[0:3], v[32:35]
    ds_read_b128 a[32:35], v2 offset:17408
    v_mfma_f32_16x16x32_bf16 v[36:39], a[16:19], a[4:7], v[36:39]
    ds_read_b64_tr_b16 a[48:49], v4 offset:24576
    v_mfma_f32_16x16x32_bf16 v[40:43], a[16:19], a[8:11], v[40:43]
    ds_read_b64_tr_b16 a[50:51], v4 offset:25600
    v_mfma_f32_16x16x32_bf16 v[44:47], a[16:19], a[12:15], v[44:47]
    ds_read_b128 a[36:39], v2 offset:19456
    v_mfma_f32_16x16x32_bf16 v[48:51], a[20:23], a[0:3], v[48:51]
    ds_read_b128 a[40:43], v3 offset:21504
    v_mfma_f32_16x16x32_bf16 v[52:55], a[20:23], a[4:7], v[52:55]
    ds_read_b128 a[44:47], v3 offset:23552
    v_mfma_f32_16x16x32_bf16 v[56:59], a[20:23], a[8:11], v[56:59]
    ds_read_b64_tr_b16 a[52:53], v5 offset:24576
    v_mfma_f32_16x16x32_bf16 v[60:63], a[20:23], a[12:15], v[60:63]
    ds_read_b64_tr_b16 a[54:55], v5 offset:25600
    v_mfma_f32_16x16x32_bf16 v[64:67], a[24:27], a[0:3], v[64:67]
    ds_read_b64_tr_b16 a[56:57], v6 offset:24576
    v_mfma_f32_16x16x32_bf16 v[68:71], a[24:27], a[4:7], v[68:71]
    ds_read_b64_tr_b16 a[58:59], v6 offset:25600
    v_mfma_f32_16x16x32_bf16 v[72:75], a[24:27], a[8:11], v[72:75]
    ds_read_b64_tr_b16 a[60:61], v7 offset:24576
    v_mfma_f32_16x16x32_bf16 v[76:79], a[24:27], a[12:15], v[76:79]
    ds_read_b64_tr_b16 a[62:63], v7 offset:25600
    v_mfma_f32_16x16x32_bf16 v[80:83], a[28:31], a[0:3], v[80:83]
    v_mfma_f32_16x16x32_bf16 v[84:87], a[28:31], a[4:7], v[84:87]
    v_mfma_f32_16x16x32_bf16 v[88:91], a[28:31], a[8:11], v[88:91]
    v_mfma_f32_16x16x32_bf16 v[92:95], a[28:31], a[12:15], v[92:95]
    s_waitcnt lgkmcnt(0)
    s_barrier
    v_mfma_f32_16x16x32_bf16 v[32:35], a[48:51], a[32:35], v[32:35]
    ds_read_b128 a[0:3], v2 offset:32768
    v_mfma_f32_16x16x32_bf16 v[36:39], a[48:51], a[36:39], v[36:39]
    ds_read_b64_tr_b16 a[16:17], v4 offset:32768
    v_mfma_f32_16x16x32_bf16 v[40:43], a[48:51], a[40:43], v[40:43]
    ds_read_b64_tr_b16 a[18:19], v4 offset:33792
    v_mfma_f32_16x16x32_bf16 v[44:47], a[48:51], a[44:47], v[44:47]
    ds_read_b128 a[4:7], v2 offset:34816
    v_mfma_f32_16x16x32_bf16 v[48:51], a[52:55], a[32:35], v[48:51]
    ds_read_b128 a[8:11], v3 offset:36864
    v_mfma_f32_16x16x32_bf16 v[52:55], a[52:55], a[36:39], v[52:55]
    ds_read_b128 a[12:15], v3 offset:38912
    v_mfma_f32_16x16x32_bf16 v[56:59], a[52:55], a[40:43], v[56:59]
    ds_read_b64_tr_b16 a[20:21], v5 offset:32768
    v_mfma_f32_16x16x32_bf16 v[60:63], a[52:55], a[44:47], v[60:63]
    ds_read_b64_tr_b16 a[22:23], v5 offset:33792
    v_mfma_f32_16x16x32_bf16 v[64:67], a[56:59], a[32:35], v[64:67]
    ds_read_b64_tr_b16 a[24:25], v6 offset:32768
    v_mfma_f32_16x16x32_bf16 v[68:71], a[56:59], a[36:39], v[68:71]
    ds_read_b64_tr_b16 a[26:27], v6 offset:33792
    v_mfma_f32_16x16x32_bf16 v[72:75], a[56:59], a[40:43], v[72:75]
    ds_read_b64_tr_b16 a[28:29], v7 offset:32768
    v_mfma_f32_16x16x32_bf16 v[76:79], a[56:59], a[44:47], v[76:79]
    ds_read_b64_tr_b16 a[30:31], v7 offset:33792
    v_mfma_f32_16x16x32_bf16 v[80:83], a[60:63], a[32:35], v[80:83]
    v_mfma_f32_16x16x32_bf16 v[84:87], a[60:63], a[36:39], v[84:87]
    v_mfma_f32_16x16x32_bf16 v[88:91], a[60:63], a[40:43], v[88:91]
    v_mfma_f32_16x16x32_bf16 v[92:95], a[60:63], a[44:47], v[92:95]
    s_waitcnt lgkmcnt(0)
    v_mfma_f32_16x16x32_bf16 v[32:35], a[16:19], a[0:3], v[32:35]
    ds_read_b128 a[32:35], v2 offset:33792
    v_mfma_f32_16x16x32_bf16 v[36:39], a[16:19], a[4:7], v[36:39]
    ds_read_b64_tr_b16 a[48:49], v4 offset:40960
    v_mfma_f32_16x16x32_bf16 v[40:43], a[16:19], a[8:11], v[40:43]
    ds_read_b64_tr_b16 a[50:51], v4 offset:41984
    v_mfma_f32_16x16x32_bf16 v[44:47], a[16:19], a[12:15], v[44:47]
    ds_read_b128 a[36:39], v2 offset:35840
    v_mfma_f32_16x16x32_bf16 v[48:51], a[20:23], a[0:3], v[48:51]
    ds_read_b128 a[40:43], v3 offset:37888
    v_mfma_f32_16x16x32_bf16 v[52:55], a[20:23], a[4:7], v[52:55]
    ds_read_b128 a[44:47], v3 offset:39936
    v_mfma_f32_16x16x32_bf16 v[56:59], a[20:23], a[8:11], v[56:59]
    ds_read_b64_tr_b16 a[52:53], v5 offset:40960
    v_mfma_f32_16x16x32_bf16 v[60:63], a[20:23], a[12:15], v[60:63]
    ds_read_b64_tr_b16 a[54:55], v5 offset:41984
    v_mfma_f32_16x16x32_bf16 v[64:67], a[24:27], a[0:3], v[64:67]
    ds_read_b64_tr_b16 a[56:57], v6 offset:40960
    v_mfma_f32_16x16x32_bf16 v[68:71], a[24:27], a[4:7], v[68:71]
    ds_read_b64_tr_b16 a[58:59], v6 offset:41984
    v_mfma_f32_16x16x32_bf16 v[72:75], a[24:27], a[8:11], v[72:75]
    ds_read_b64_tr_b16 a[60:61], v7 offset:40960
    v_mfma_f32_16x16x32_bf16 v[76:79], a[24:27], a[12:15], v[76:79]
    ds_read_b64_tr_b16 a[62:63], v7 offset:41984
    v_mfma_f32_16x16x32_bf16 v[80:83], a[28:31], a[0:3], v[80:83]
    v_mfma_f32_16x16x32_bf16 v[84:87], a[28:31], a[4:7], v[84:87]
    v_mfma_f32_16x16x32_bf16 v[88:91], a[28:31], a[8:11], v[88:91]
    v_mfma_f32_16x16x32_bf16 v[92:95], a[28:31], a[12:15], v[92:95]
    s_waitcnt lgkmcnt(0)
    s_barrier
    v_mfma_f32_16x16x32_bf16 v[32:35], a[48:51], a[32:35], v[32:35]
    ds_read_b128 a[0:3], v2 offset:49152
    v_mfma_f32_16x16x32_bf16 v[36:39], a[48:51], a[36:39], v[36:39]
    ds_read_b64_tr_b16 a[16:17], v4 offset:49152
    v_mfma_f32_16x16x32_bf16 v[40:43], a[48:51], a[40:43], v[40:43]
    ds_read_b64_tr_b16 a[18:19], v4 offset:50176
    v_mfma_f32_16x16x32_bf16 v[44:47], a[48:51], a[44:47], v[44:47]
    ds_read_b128 a[4:7], v2 offset:51200
    v_mfma_f32_16x16x32_bf16 v[48:51], a[52:55], a[32:35], v[48:51]
    ds_read_b128 a[8:11], v3 offset:53248
    v_mfma_f32_16x16x32_bf16 v[52:55], a[52:55], a[36:39], v[52:55]
    ds_read_b128 a[12:15], v3 offset:55296
    v_mfma_f32_16x16x32_bf16 v[56:59], a[52:55], a[40:43], v[56:59]
    ds_read_b64_tr_b16 a[20:21], v5 offset:49152
    v_mfma_f32_16x16x32_bf16 v[60:63], a[52:55], a[44:47], v[60:63]
    ds_read_b64_tr_b16 a[22:23], v5 offset:50176
    v_mfma_f32_16x16x32_bf16 v[64:67], a[56:59], a[32:35], v[64:67]
    ds_read_b64_tr_b16 a[24:25], v6 offset:49152
    v_mfma_f32_16x16x32_bf16 v[68:71], a[56:59], a[36:39], v[68:71]
    ds_read_b64_tr_b16 a[26:27], v6 offset:50176
    v_mfma_f32_16x16x32_bf16 v[72:75], a[56:59], a[40:43], v[72:75]
    ds_read_b64_tr_b16 a[28:29], v7 offset:49152
    v_mfma_f32_16x16x32_bf16 v[76:79], a[56:59], a[44:47], v[76:79]
    ds_read_b64_tr_b16 a[30:31], v7 offset:50176
    v_mfma_f32_16x16x32_bf16 v[80:83], a[60:63], a[32:35], v[80:83]
    v_mfma_f32_16x16x32_bf16 v[84:87], a[60:63], a[36:39], v[84:87]
    v_mfma_f32_16x16x32_bf16 v[88:91], a[60:63], a[40:43], v[88:91]
    v_mfma_f32_16x16x32_bf16 v[92:95], a[60:63], a[44:47], v[92:95]
    s_waitcnt lgkmcnt(0)
    v_mfma_f32_16x16x32_bf16 v[32:35], a[16:19], a[0:3], v[32:35]
    ds_read_b128 a[32:35], v2 offset:50176
    v_mfma_f32_16x16x32_bf16 v[36:39], a[16:19], a[4:7], v[36:39]
    ds_read_b64_tr_b16 a[48:49], v4 offset:57344
    v_mfma_f32_16x16x32_bf16 v[40:43], a[16:19], a[8:11], v[40:43]
    ds_read_b64_tr_b16 a[50:51], v4 offset:58368
    v_mfma_f32_16x16x32_bf16 v[44:47], a[16:19], a[12:15], v[44:47]
    ds_read_b128 a[36:39], v2 offset:52224
    v_mfma_f32_16x16x32_bf16 v[48:51], a[20:23], a[0:3], v[48:51]
    ds_read_b128 a[40:43], v3 offset:54272
    v_mfma_f32_16x16x32_bf16 v[52:55], a[20:23], a[4:7], v[52:55]
    ds_read_b128 a[44:47], v3 offset:56320
    v_mfma_f32_16x16x32_bf16 v[56:59], a[20:23], a[8:11], v[56:59]
    ds_read_b64_tr_b16 a[52:53], v5 offset:57344
    v_mfma_f32_16x16x32_bf16 v[60:63], a[20:23], a[12:15], v[60:63]
    ds_read_b64_tr_b16 a[54:55], v5 offset:58368
    v_mfma_f32_16x16x32_bf16 v[64:67], a[24:27], a[0:3], v[64:67]
    ds_read_b64_tr_b16 a[56:57], v6 offset:57344
    v_mfma_f32_16x16x32_bf16 v[68:71], a[24:27], a[4:7], v[68:71]
    ds_read_b64_tr_b16 a[58:59], v6 offset:58368
    v_mfma_f32_16x16x32_bf16 v[72:75], a[24:27], a[8:11], v[72:75]
    ds_read_b64_tr_b16 a[60:61], v7 offset:57344
    v_mfma_f32_16x16x32_bf16 v[76:79], a[24:27], a[12:15], v[76:79]
    ds_read_b64_tr_b16 a[62:63], v7 offset:58368
    v_mfma_f32_16x16x32_bf16 v[80:83], a[28:31], a[0:3], v[80:83]
    v_mfma_f32_16x16x32_bf16 v[84:87], a[28:31], a[4:7], v[84:87]
    v_mfma_f32_16x16x32_bf16 v[88:91], a[28:31], a[8:11], v[88:91]
    v_mfma_f32_16x16x32_bf16 v[92:95], a[28:31], a[12:15], v[92:95]
    s_waitcnt lgkmcnt(0)
    s_barrier
    v_mfma_f32_16x16x32_bf16 v[32:35], a[48:51], a[32:35], v[32:35]
    ds_read_b128 a[0:3], v2 offset:0
    v_mfma_f32_16x16x32_bf16 v[36:39], a[48:51], a[36:39], v[36:39]
    ds_read_b64_tr_b16 a[16:17], v4 offset:0
    v_mfma_f32_16x16x32_bf16 v[40:43], a[48:51], a[40:43], v[40:43]
    ds_read_b64_tr_b16 a[18:19], v4 offset:1024
    v_mfma_f32_16x16x32_bf16 v[44:47], a[48:51], a[44:47], v[44:47]
    ds_read_b128 a[4:7], v2 offset:2048
    v_mfma_f32_16x16x32_bf16 v[48:51], a[52:55], a[32:35], v[48:51]
    ds_read_b128 a[8:11], v3 offset:4096
    v_mfma_f32_16x16x32_bf16 v[52:55], a[52:55], a[36:39], v[52:55]
    ds_read_b128 a[12:15], v3 offset:6144
    v_mfma_f32_16x16x32_bf16 v[56:59], a[52:55], a[40:43], v[56:59]
    ds_read_b64_tr_b16 a[20:21], v5 offset:0
    v_mfma_f32_16x16x32_bf16 v[60:63], a[52:55], a[44:47], v[60:63]
    ds_read_b64_tr_b16 a[22:23], v5 offset:1024
    v_mfma_f32_16x16x32_bf16 v[64:67], a[56:59], a[32:35], v[64:67]
    ds_read_b64_tr_b16 a[24:25], v6 offset:0
    v_mfma_f32_16x16x32_bf16 v[68:71], a[56:59], a[36:39], v[68:71]
    ds_read_b64_tr_b16 a[26:27], v6 offset:1024
    v_mfma_f32_16x16x32_bf16 v[72:75], a[56:59], a[40:43], v[72:75]
    ds_read_b64_tr_b16 a[28:29], v7 offset:0
    v_mfma_f32_16x16x32_bf16 v[76:79], a[56:59], a[44:47], v[76:79]
    ds_read_b64_tr_b16 a[30:31], v7 offset:1024
    v_mfma_f32_16x16x32_bf16 v[80:83], a[60:63], a[32:35], v[80:83]
    v_mfma_f32_16x16x32_bf16 v[84:87], a[60:63], a[36:39], v[84:87]
    v_mfma_f32_16x16x32_bf16 v[88:91], a[60:63], a[40:43], v[88:91]
    v_mfma_f32_16x16x32_bf16 v[92:95], a[60:63], a[44:47], v[92:95]
    s_waitcnt lgkmcnt(0)
    v_mfma_f32_16x16x32_bf16 v[32:35], a[16:19], a[0:3], v[32:35]
    ds_read_b128 a[32:35], v2 offset:1024
    v_mfma_f32_16x16x32_bf16 v[36:39], a[16:19], a[4:7], v[36:39]
    ds_read_b64_tr_b16 a[48:49], v4 offset:8192
    v_mfma_f32_16x16x32_bf16 v[40:43], a[16:19], a[8:11], v[40:43]
    ds_read_b64_tr_b16 a[50:51], v4 offset:9216
    v_mfma_f32_16x16x32_bf16 v[44:47], a[16:19], a[12:15], v[44:47]
    ds_read_b128 a[36:39], v2 offset:3072
    v_mfma_f32_16x16x32_bf16 v[48:51], a[20:23], a[0:3], v[48:51]
    ds_read_b128 a[40:43], v3 offset:5120
    v_mfma_f32_16x16x32_bf16 v[52:55], a[20:23], a[4:7], v[52:55]
    ds_read_b128 a[44:47], v3 offset:7168
    v_mfma_f32_16x16x32_bf16 v[56:59], a[20:23], a[8:11], v[56:59]
    ds_read_b64_tr_b16 a[52:53], v5 offset:8192
    v_mfma_f32_16x16x32_bf16 v[60:63], a[20:23], a[12:15], v[60:63]
    ds_read_b64_tr_b16 a[54:55], v5 offset:9216
    v_mfma_f32_16x16x32_bf16 v[64:67], a[24:27], a[0:3], v[64:67]
    ds_read_b64_tr_b16 a[56:57], v6 offset:8192
    v_mfma_f32_16x16x32_bf16 v[68:71], a[24:27], a[4:7], v[68:71]
    ds_read_b64_tr_b16 a[58:59], v6 offset:9216
    v_mfma_f32_16x16x32_bf16 v[72:75], a[24:27], a[8:11], v[72:75]
    ds_read_b64_tr_b16 a[60:61], v7 offset:8192
    v_mfma_f32_16x16x32_bf16 v[76:79], a[24:27], a[12:15], v[76:79]
    ds_read_b64_tr_b16 a[62:63], v7 offset:9216
    v_mfma_f32_16x16x32_bf16 v[80:83], a[28:31], a[0:3], v[80:83]
    v_mfma_f32_16x16x32_bf16 v[84:87], a[28:31], a[4:7], v[84:87]
    v_mfma_f32_16x16x32_bf16 v[88:91], a[28:31], a[8:11], v[88:91]
    v_mfma_f32_16x16x32_bf16 v[92:95], a[28:31], a[12:15], v[92:95]
    s_waitcnt lgkmcnt(0)
    s_barrier
    v_mfma_f32_16x16x32_bf16 v[32:35], a[48:51], a[32:35], v[32:35]
    ds_read_b128 a[0:3], v2 offset:16384
    v_mfma_f32_16x16x32_bf16 v[36:39], a[48:51], a[36:39], v[36:39]
    ds_read_b64_tr_b16 a[16:17], v4 offset:16384
    v_mfma_f32_16x16x32_bf16 v[40:43], a[48:51], a[40:43], v[40:43]
    ds_read_b64_tr_b16 a[18:19], v4 offset:17408
    v_mfma_f32_16x16x32_bf16 v[44:47], a[48:51], a[44:47], v[44:47]
    ds_read_b128 a[4:7], v2 offset:18432
    v_mfma_f32_16x16x32_bf16 v[48:51], a[52:55], a[32:35], v[48:51]
    ds_read_b128 a[8:11], v3 offset:20480
    v_mfma_f32_16x16x32_bf16 v[52:55], a[52:55], a[36:39], v[52:55]
    ds_read_b128 a[12:15], v3 offset:22528
    v_mfma_f32_16x16x32_bf16 v[56:59], a[52:55], a[40:43], v[56:59]
    ds_read_b64_tr_b16 a[20:21], v5 offset:16384
    v_mfma_f32_16x16x32_bf16 v[60:63], a[52:55], a[44:47], v[60:63]
    ds_read_b64_tr_b16 a[22:23], v5 offset:17408
    v_mfma_f32_16x16x32_bf16 v[64:67], a[56:59], a[32:35], v[64:67]
    ds_read_b64_tr_b16 a[24:25], v6 offset:16384
    v_mfma_f32_16x16x32_bf16 v[68:71], a[56:59], a[36:39], v[68:71]
    ds_read_b64_tr_b16 a[26:27], v6 offset:17408
    v_mfma_f32_16x16x32_bf16 v[72:75], a[56:59], a[40:43], v[72:75]
    ds_read_b64_tr_b16 a[28:29], v7 offset:16384
    v_mfma_f32_16x16x32_bf16 v[76:79], a[56:59], a[44:47], v[76:79]
    ds_read_b64_tr_b16 a[30:31], v7 offset:17408
    v_mfma_f32_16x16x32_bf16 v[80:83], a[60:63], a[32:35], v[80:83]
    v_mfma_f32_16x16x32_bf16 v[84:87], a[60:63], a[36:39], v[84:87]
    v_mfma_f32_16x16x32_bf16 v[88:91], a[60:63], a[40:43], v[88:91]
    v_mfma_f32_16x16x32_bf16 v[92:95], a[60:63], a[44:47], v[92:95]
    s_waitcnt lgkmcnt(0)
    v_mfma_f32_16x16x32_bf16 v[32:35], a[16:19], a[0:3], v[32:35]
    ds_read_b128 a[32:35], v2 offset:17408
    v_mfma_f32_16x16x32_bf16 v[36:39], a[16:19], a[4:7], v[36:39]
    ds_read_b64_tr_b16 a[48:49], v4 offset:24576
    v_mfma_f32_16x16x32_bf16 v[40:43], a[16:19], a[8:11], v[40:43]
    ds_read_b64_tr_b16 a[50:51], v4 offset:25600
    v_mfma_f32_16x16x32_bf16 v[44:47], a[16:19], a[12:15], v[44:47]
    ds_read_b128 a[36:39], v2 offset:19456
    v_mfma_f32_16x16x32_bf16 v[48:51], a[20:23], a[0:3], v[48:51]
    ds_read_b128 a[40:43], v3 offset:21504
    v_mfma_f32_16x16x32_bf16 v[52:55], a[20:23], a[4:7], v[52:55]
    ds_read_b128 a[44:47], v3 offset:23552
    v_mfma_f32_16x16x32_bf16 v[56:59], a[20:23], a[8:11], v[56:59]
    ds_read_b64_tr_b16 a[52:53], v5 offset:24576
    v_mfma_f32_16x16x32_bf16 v[60:63], a[20:23], a[12:15], v[60:63]
    ds_read_b64_tr_b16 a[54:55], v5 offset:25600
    v_mfma_f32_16x16x32_bf16 v[64:67], a[24:27], a[0:3], v[64:67]
    ds_read_b64_tr_b16 a[56:57], v6 offset:24576
    v_mfma_f32_16x16x32_bf16 v[68:71], a[24:27], a[4:7], v[68:71]
    ds_read_b64_tr_b16 a[58:59], v6 offset:25600
    v_mfma_f32_16x16x32_bf16 v[72:75], a[24:27], a[8:11], v[72:75]
    ds_read_b64_tr_b16 a[60:61], v7 offset:24576
    v_mfma_f32_16x16x32_bf16 v[76:79], a[24:27], a[12:15], v[76:79]
    ds_read_b64_tr_b16 a[62:63], v7 offset:25600
    v_mfma_f32_16x16x32_bf16 v[80:83], a[28:31], a[0:3], v[80:83]
    v_mfma_f32_16x16x32_bf16 v[84:87], a[28:31], a[4:7], v[84:87]
    v_mfma_f32_16x16x32_bf16 v[88:91], a[28:31], a[8:11], v[88:91]
    v_mfma_f32_16x16x32_bf16 v[92:95], a[28:31], a[12:15], v[92:95]
    s_waitcnt lgkmcnt(0)
    s_barrier
    v_mfma_f32_16x16x32_bf16 v[32:35], a[48:51], a[32:35], v[32:35]
    ds_read_b128 a[0:3], v2 offset:32768
    v_mfma_f32_16x16x32_bf16 v[36:39], a[48:51], a[36:39], v[36:39]
    ds_read_b64_tr_b16 a[16:17], v4 offset:32768
    v_mfma_f32_16x16x32_bf16 v[40:43], a[48:51], a[40:43], v[40:43]
    ds_read_b64_tr_b16 a[18:19], v4 offset:33792
    v_mfma_f32_16x16x32_bf16 v[44:47], a[48:51], a[44:47], v[44:47]
    ds_read_b128 a[4:7], v2 offset:34816
    v_mfma_f32_16x16x32_bf16 v[48:51], a[52:55], a[32:35], v[48:51]
    ds_read_b128 a[8:11], v3 offset:36864
    v_mfma_f32_16x16x32_bf16 v[52:55], a[52:55], a[36:39], v[52:55]
    ds_read_b128 a[12:15], v3 offset:38912
    v_mfma_f32_16x16x32_bf16 v[56:59], a[52:55], a[40:43], v[56:59]
    ds_read_b64_tr_b16 a[20:21], v5 offset:32768
    v_mfma_f32_16x16x32_bf16 v[60:63], a[52:55], a[44:47], v[60:63]
    ds_read_b64_tr_b16 a[22:23], v5 offset:33792
    v_mfma_f32_16x16x32_bf16 v[64:67], a[56:59], a[32:35], v[64:67]
    ds_read_b64_tr_b16 a[24:25], v6 offset:32768
    v_mfma_f32_16x16x32_bf16 v[68:71], a[56:59], a[36:39], v[68:71]
    ds_read_b64_tr_b16 a[26:27], v6 offset:33792
    v_mfma_f32_16x16x32_bf16 v[72:75], a[56:59], a[40:43], v[72:75]
    ds_read_b64_tr_b16 a[28:29], v7 offset:32768
    v_mfma_f32_16x16x32_bf16 v[76:79], a[56:59], a[44:47], v[76:79]
    ds_read_b64_tr_b16 a[30:31], v7 offset:33792
    v_mfma_f32_16x16x32_bf16 v[80:83], a[60:63], a[32:35], v[80:83]
    v_mfma_f32_16x16x32_bf16 v[84:87], a[60:63], a[36:39], v[84:87]
    v_mfma_f32_16x16x32_bf16 v[88:91], a[60:63], a[40:43], v[88:91]
    v_mfma_f32_16x16x32_bf16 v[92:95], a[60:63], a[44:47], v[92:95]
    s_waitcnt lgkmcnt(0)
    v_mfma_f32_16x16x32_bf16 v[32:35], a[16:19], a[0:3], v[32:35]
    ds_read_b128 a[32:35], v2 offset:33792
    v_mfma_f32_16x16x32_bf16 v[36:39], a[16:19], a[4:7], v[36:39]
    ds_read_b64_tr_b16 a[48:49], v4 offset:40960
    v_mfma_f32_16x16x32_bf16 v[40:43], a[16:19], a[8:11], v[40:43]
    ds_read_b64_tr_b16 a[50:51], v4 offset:41984
    v_mfma_f32_16x16x32_bf16 v[44:47], a[16:19], a[12:15], v[44:47]
    ds_read_b128 a[36:39], v2 offset:35840
    v_mfma_f32_16x16x32_bf16 v[48:51], a[20:23], a[0:3], v[48:51]
    ds_read_b128 a[40:43], v3 offset:37888
    v_mfma_f32_16x16x32_bf16 v[52:55], a[20:23], a[4:7], v[52:55]
    ds_read_b128 a[44:47], v3 offset:39936
    v_mfma_f32_16x16x32_bf16 v[56:59], a[20:23], a[8:11], v[56:59]
    ds_read_b64_tr_b16 a[52:53], v5 offset:40960
    v_mfma_f32_16x16x32_bf16 v[60:63], a[20:23], a[12:15], v[60:63]
    ds_read_b64_tr_b16 a[54:55], v5 offset:41984
    v_mfma_f32_16x16x32_bf16 v[64:67], a[24:27], a[0:3], v[64:67]
    ds_read_b64_tr_b16 a[56:57], v6 offset:40960
    v_mfma_f32_16x16x32_bf16 v[68:71], a[24:27], a[4:7], v[68:71]
    ds_read_b64_tr_b16 a[58:59], v6 offset:41984
    v_mfma_f32_16x16x32_bf16 v[72:75], a[24:27], a[8:11], v[72:75]
    ds_read_b64_tr_b16 a[60:61], v7 offset:40960
    v_mfma_f32_16x16x32_bf16 v[76:79], a[24:27], a[12:15], v[76:79]
    ds_read_b64_tr_b16 a[62:63], v7 offset:41984
    v_mfma_f32_16x16x32_bf16 v[80:83], a[28:31], a[0:3], v[80:83]
    v_mfma_f32_16x16x32_bf16 v[84:87], a[28:31], a[4:7], v[84:87]
    v_mfma_f32_16x16x32_bf16 v[88:91], a[28:31], a[8:11], v[88:91]
    v_mfma_f32_16x16x32_bf16 v[92:95], a[28:31], a[12:15], v[92:95]
    s_waitcnt lgkmcnt(0)
    s_barrier
    v_mfma_f32_16x16x32_bf16 v[32:35], a[48:51], a[32:35], v[32:35]
    ds_read_b128 a[0:3], v2 offset:49152
    v_mfma_f32_16x16x32_bf16 v[36:39], a[48:51], a[36:39], v[36:39]
    ds_read_b64_tr_b16 a[16:17], v4 offset:49152
    v_mfma_f32_16x16x32_bf16 v[40:43], a[48:51], a[40:43], v[40:43]
    ds_read_b64_tr_b16 a[18:19], v4 offset:50176
    v_mfma_f32_16x16x32_bf16 v[44:47], a[48:51], a[44:47], v[44:47]
    ds_read_b128 a[4:7], v2 offset:51200
    v_mfma_f32_16x16x32_bf16 v[48:51], a[52:55], a[32:35], v[48:51]
    ds_read_b128 a[8:11], v3 offset:53248
    v_mfma_f32_16x16x32_bf16 v[52:55], a[52:55], a[36:39], v[52:55]
    ds_read_b128 a[12:15], v3 offset:55296
    v_mfma_f32_16x16x32_bf16 v[56:59], a[52:55], a[40:43], v[56:59]
    ds_read_b64_tr_b16 a[20:21], v5 offset:49152
    v_mfma_f32_16x16x32_bf16 v[60:63], a[52:55], a[44:47], v[60:63]
    ds_read_b64_tr_b16 a[22:23], v5 offset:50176
    v_mfma_f32_16x16x32_bf16 v[64:67], a[56:59], a[32:35], v[64:67]
    ds_read_b64_tr_b16 a[24:25], v6 offset:49152
    v_mfma_f32_16x16x32_bf16 v[68:71], a[56:59], a[36:39], v[68:71]
    ds_read_b64_tr_b16 a[26:27], v6 offset:50176
    v_mfma_f32_16x16x32_bf16 v[72:75], a[56:59], a[40:43], v[72:75]
    ds_read_b64_tr_b16 a[28:29], v7 offset:49152
    v_mfma_f32_16x16x32_bf16 v[76:79], a[56:59], a[44:47], v[76:79]
    ds_read_b64_tr_b16 a[30:31], v7 offset:50176
    v_mfma_f32_16x16x32_bf16 v[80:83], a[60:63], a[32:35], v[80:83]
    v_mfma_f32_16x16x32_bf16 v[84:87], a[60:63], a[36:39], v[84:87]
    v_mfma_f32_16x16x32_bf16 v[88:91], a[60:63], a[40:43], v[88:91]
    v_mfma_f32_16x16x32_bf16 v[92:95], a[60:63], a[44:47], v[92:95]
    s_waitcnt lgkmcnt(0)
    v_mfma_f32_16x16x32_bf16 v[32:35], a[16:19], a[0:3], v[32:35]
    ds_read_b128 a[32:35], v2 offset:50176
    v_mfma_f32_16x16x32_bf16 v[36:39], a[16:19], a[4:7], v[36:39]
    ds_read_b64_tr_b16 a[48:49], v4 offset:57344
    v_mfma_f32_16x16x32_bf16 v[40:43], a[16:19], a[8:11], v[40:43]
    ds_read_b64_tr_b16 a[50:51], v4 offset:58368
    v_mfma_f32_16x16x32_bf16 v[44:47], a[16:19], a[12:15], v[44:47]
    ds_read_b128 a[36:39], v2 offset:52224
    v_mfma_f32_16x16x32_bf16 v[48:51], a[20:23], a[0:3], v[48:51]
    ds_read_b128 a[40:43], v3 offset:54272
    v_mfma_f32_16x16x32_bf16 v[52:55], a[20:23], a[4:7], v[52:55]
    ds_read_b128 a[44:47], v3 offset:56320
    v_mfma_f32_16x16x32_bf16 v[56:59], a[20:23], a[8:11], v[56:59]
    ds_read_b64_tr_b16 a[52:53], v5 offset:57344
    v_mfma_f32_16x16x32_bf16 v[60:63], a[20:23], a[12:15], v[60:63]
    ds_read_b64_tr_b16 a[54:55], v5 offset:58368
    v_mfma_f32_16x16x32_bf16 v[64:67], a[24:27], a[0:3], v[64:67]
    ds_read_b64_tr_b16 a[56:57], v6 offset:57344
    v_mfma_f32_16x16x32_bf16 v[68:71], a[24:27], a[4:7], v[68:71]
    ds_read_b64_tr_b16 a[58:59], v6 offset:58368
    v_mfma_f32_16x16x32_bf16 v[72:75], a[24:27], a[8:11], v[72:75]
    ds_read_b64_tr_b16 a[60:61], v7 offset:57344
    v_mfma_f32_16x16x32_bf16 v[76:79], a[24:27], a[12:15], v[76:79]
    ds_read_b64_tr_b16 a[62:63], v7 offset:58368
    v_mfma_f32_16x16x32_bf16 v[80:83], a[28:31], a[0:3], v[80:83]
    v_mfma_f32_16x16x32_bf16 v[84:87], a[28:31], a[4:7], v[84:87]
    v_mfma_f32_16x16x32_bf16 v[88:91], a[28:31], a[8:11], v[88:91]
    v_mfma_f32_16x16x32_bf16 v[92:95], a[28:31], a[12:15], v[92:95]
    s_waitcnt lgkmcnt(0)
    s_barrier
    v_mfma_f32_16x16x32_bf16 v[32:35], a[48:51], a[32:35], v[32:35]
    ds_read_b128 a[0:3], v2 offset:0
    v_mfma_f32_16x16x32_bf16 v[36:39], a[48:51], a[36:39], v[36:39]
    ds_read_b64_tr_b16 a[16:17], v4 offset:0
    v_mfma_f32_16x16x32_bf16 v[40:43], a[48:51], a[40:43], v[40:43]
    ds_read_b64_tr_b16 a[18:19], v4 offset:1024
    v_mfma_f32_16x16x32_bf16 v[44:47], a[48:51], a[44:47], v[44:47]
    ds_read_b128 a[4:7], v2 offset:2048
    v_mfma_f32_16x16x32_bf16 v[48:51], a[52:55], a[32:35], v[48:51]
    ds_read_b128 a[8:11], v3 offset:4096
    v_mfma_f32_16x16x32_bf16 v[52:55], a[52:55], a[36:39], v[52:55]
    ds_read_b128 a[12:15], v3 offset:6144
    v_mfma_f32_16x16x32_bf16 v[56:59], a[52:55], a[40:43], v[56:59]
    ds_read_b64_tr_b16 a[20:21], v5 offset:0
    v_mfma_f32_16x16x32_bf16 v[60:63], a[52:55], a[44:47], v[60:63]
    ds_read_b64_tr_b16 a[22:23], v5 offset:1024
    v_mfma_f32_16x16x32_bf16 v[64:67], a[56:59], a[32:35], v[64:67]
    ds_read_b64_tr_b16 a[24:25], v6 offset:0
    v_mfma_f32_16x16x32_bf16 v[68:71], a[56:59], a[36:39], v[68:71]
    ds_read_b64_tr_b16 a[26:27], v6 offset:1024
    v_mfma_f32_16x16x32_bf16 v[72:75], a[56:59], a[40:43], v[72:75]
    ds_read_b64_tr_b16 a[28:29], v7 offset:0
    v_mfma_f32_16x16x32_bf16 v[76:79], a[56:59], a[44:47], v[76:79]
    ds_read_b64_tr_b16 a[30:31], v7 offset:1024
    v_mfma_f32_16x16x32_bf16 v[80:83], a[60:63], a[32:35], v[80:83]
    v_mfma_f32_16x16x32_bf16 v[84:87], a[60:63], a[36:39], v[84:87]
    v_mfma_f32_16x16x32_bf16 v[88:91], a[60:63], a[40:43], v[88:91]
    v_mfma_f32_16x16x32_bf16 v[92:95], a[60:63], a[44:47], v[92:95]
    s_waitcnt lgkmcnt(0)
    v_mfma_f32_16x16x32_bf16 v[32:35], a[16:19], a[0:3], v[32:35]
    ds_read_b128 a[32:35], v2 offset:1024
    v_mfma_f32_16x16x32_bf16 v[36:39], a[16:19], a[4:7], v[36:39]
    ds_read_b64_tr_b16 a[48:49], v4 offset:8192
    v_mfma_f32_16x16x32_bf16 v[40:43], a[16:19], a[8:11], v[40:43]
    ds_read_b64_tr_b16 a[50:51], v4 offset:9216
    v_mfma_f32_16x16x32_bf16 v[44:47], a[16:19], a[12:15], v[44:47]
    ds_read_b128 a[36:39], v2 offset:3072
    v_mfma_f32_16x16x32_bf16 v[48:51], a[20:23], a[0:3], v[48:51]
    ds_read_b128 a[40:43], v3 offset:5120
    v_mfma_f32_16x16x32_bf16 v[52:55], a[20:23], a[4:7], v[52:55]
    ds_read_b128 a[44:47], v3 offset:7168
    v_mfma_f32_16x16x32_bf16 v[56:59], a[20:23], a[8:11], v[56:59]
    ds_read_b64_tr_b16 a[52:53], v5 offset:8192
    v_mfma_f32_16x16x32_bf16 v[60:63], a[20:23], a[12:15], v[60:63]
    ds_read_b64_tr_b16 a[54:55], v5 offset:9216
    v_mfma_f32_16x16x32_bf16 v[64:67], a[24:27], a[0:3], v[64:67]
    ds_read_b64_tr_b16 a[56:57], v6 offset:8192
    v_mfma_f32_16x16x32_bf16 v[68:71], a[24:27], a[4:7], v[68:71]
    ds_read_b64_tr_b16 a[58:59], v6 offset:9216
    v_mfma_f32_16x16x32_bf16 v[72:75], a[24:27], a[8:11], v[72:75]
    ds_read_b64_tr_b16 a[60:61], v7 offset:8192
    v_mfma_f32_16x16x32_bf16 v[76:79], a[24:27], a[12:15], v[76:79]
    ds_read_b64_tr_b16 a[62:63], v7 offset:9216
    v_mfma_f32_16x16x32_bf16 v[80:83], a[28:31], a[0:3], v[80:83]
    v_mfma_f32_16x16x32_bf16 v[84:87], a[28:31], a[4:7], v[84:87]
    v_mfma_f32_16x16x32_bf16 v[88:91], a[28:31], a[8:11], v[88:91]
    v_mfma_f32_16x16x32_bf16 v[92:95], a[28:31], a[12:15], v[92:95]
    s_waitcnt lgkmcnt(0)
    s_barrier
    v_mfma_f32_16x16x32_bf16 v[32:35], a[48:51], a[32:35], v[32:35]
    ds_read_b128 a[0:3], v2 offset:16384
    v_mfma_f32_16x16x32_bf16 v[36:39], a[48:51], a[36:39], v[36:39]
    ds_read_b64_tr_b16 a[16:17], v4 offset:16384
    v_mfma_f32_16x16x32_bf16 v[40:43], a[48:51], a[40:43], v[40:43]
    ds_read_b64_tr_b16 a[18:19], v4 offset:17408
    v_mfma_f32_16x16x32_bf16 v[44:47], a[48:51], a[44:47], v[44:47]
    ds_read_b128 a[4:7], v2 offset:18432
    v_mfma_f32_16x16x32_bf16 v[48:51], a[52:55], a[32:35], v[48:51]
    ds_read_b128 a[8:11], v3 offset:20480
    v_mfma_f32_16x16x32_bf16 v[52:55], a[52:55], a[36:39], v[52:55]
    ds_read_b128 a[12:15], v3 offset:22528
    v_mfma_f32_16x16x32_bf16 v[56:59], a[52:55], a[40:43], v[56:59]
    ds_read_b64_tr_b16 a[20:21], v5 offset:16384
    v_mfma_f32_16x16x32_bf16 v[60:63], a[52:55], a[44:47], v[60:63]
    ds_read_b64_tr_b16 a[22:23], v5 offset:17408
    v_mfma_f32_16x16x32_bf16 v[64:67], a[56:59], a[32:35], v[64:67]
    ds_read_b64_tr_b16 a[24:25], v6 offset:16384
    v_mfma_f32_16x16x32_bf16 v[68:71], a[56:59], a[36:39], v[68:71]
    ds_read_b64_tr_b16 a[26:27], v6 offset:17408
    v_mfma_f32_16x16x32_bf16 v[72:75], a[56:59], a[40:43], v[72:75]
    ds_read_b64_tr_b16 a[28:29], v7 offset:16384
    v_mfma_f32_16x16x32_bf16 v[76:79], a[56:59], a[44:47], v[76:79]
    ds_read_b64_tr_b16 a[30:31], v7 offset:17408
    v_mfma_f32_16x16x32_bf16 v[80:83], a[60:63], a[32:35], v[80:83]
    v_mfma_f32_16x16x32_bf16 v[84:87], a[60:63], a[36:39], v[84:87]
    v_mfma_f32_16x16x32_bf16 v[88:91], a[60:63], a[40:43], v[88:91]
    v_mfma_f32_16x16x32_bf16 v[92:95], a[60:63], a[44:47], v[92:95]
    s_waitcnt lgkmcnt(0)
    v_mfma_f32_16x16x32_bf16 v[32:35], a[16:19], a[0:3], v[32:35]
    ds_read_b128 a[32:35], v2 offset:17408
    v_mfma_f32_16x16x32_bf16 v[36:39], a[16:19], a[4:7], v[36:39]
    ds_read_b64_tr_b16 a[48:49], v4 offset:24576
    v_mfma_f32_16x16x32_bf16 v[40:43], a[16:19], a[8:11], v[40:43]
    ds_read_b64_tr_b16 a[50:51], v4 offset:25600
    v_mfma_f32_16x16x32_bf16 v[44:47], a[16:19], a[12:15], v[44:47]
    ds_read_b128 a[36:39], v2 offset:19456
    v_mfma_f32_16x16x32_bf16 v[48:51], a[20:23], a[0:3], v[48:51]
    ds_read_b128 a[40:43], v3 offset:21504
    v_mfma_f32_16x16x32_bf16 v[52:55], a[20:23], a[4:7], v[52:55]
    ds_read_b128 a[44:47], v3 offset:23552
    v_mfma_f32_16x16x32_bf16 v[56:59], a[20:23], a[8:11], v[56:59]
    ds_read_b64_tr_b16 a[52:53], v5 offset:24576
    v_mfma_f32_16x16x32_bf16 v[60:63], a[20:23], a[12:15], v[60:63]
    ds_read_b64_tr_b16 a[54:55], v5 offset:25600
    v_mfma_f32_16x16x32_bf16 v[64:67], a[24:27], a[0:3], v[64:67]
    ds_read_b64_tr_b16 a[56:57], v6 offset:24576
    v_mfma_f32_16x16x32_bf16 v[68:71], a[24:27], a[4:7], v[68:71]
    ds_read_b64_tr_b16 a[58:59], v6 offset:25600
    v_mfma_f32_16x16x32_bf16 v[72:75], a[24:27], a[8:11], v[72:75]
    ds_read_b64_tr_b16 a[60:61], v7 offset:24576
    v_mfma_f32_16x16x32_bf16 v[76:79], a[24:27], a[12:15], v[76:79]
    ds_read_b64_tr_b16 a[62:63], v7 offset:25600
    v_mfma_f32_16x16x32_bf16 v[80:83], a[28:31], a[0:3], v[80:83]
    v_mfma_f32_16x16x32_bf16 v[84:87], a[28:31], a[4:7], v[84:87]
    v_mfma_f32_16x16x32_bf16 v[88:91], a[28:31], a[8:11], v[88:91]
    v_mfma_f32_16x16x32_bf16 v[92:95], a[28:31], a[12:15], v[92:95]
    buffer_load_dword v17, v24, s[20:23], s47 offen sc1
    s_waitcnt lgkmcnt(0)
    s_barrier
    v_mfma_f32_16x16x32_bf16 v[32:35], a[48:51], a[32:35], v[32:35]
    ds_read_b128 a[0:3], v2 offset:32768
    v_mfma_f32_16x16x32_bf16 v[36:39], a[48:51], a[36:39], v[36:39]
    ds_read_b64_tr_b16 a[16:17], v4 offset:32768
    v_mfma_f32_16x16x32_bf16 v[40:43], a[48:51], a[40:43], v[40:43]
    ds_read_b64_tr_b16 a[18:19], v4 offset:33792
    v_mfma_f32_16x16x32_bf16 v[44:47], a[48:51], a[44:47], v[44:47]
    ds_read_b128 a[4:7], v2 offset:34816
    v_mfma_f32_16x16x32_bf16 v[48:51], a[52:55], a[32:35], v[48:51]
    ds_read_b128 a[8:11], v3 offset:36864
    v_mfma_f32_16x16x32_bf16 v[52:55], a[52:55], a[36:39], v[52:55]
    ds_read_b128 a[12:15], v3 offset:38912
    v_mfma_f32_16x16x32_bf16 v[56:59], a[52:55], a[40:43], v[56:59]
    ds_read_b64_tr_b16 a[20:21], v5 offset:32768
    v_mfma_f32_16x16x32_bf16 v[60:63], a[52:55], a[44:47], v[60:63]
    ds_read_b64_tr_b16 a[22:23], v5 offset:33792
    v_mfma_f32_16x16x32_bf16 v[64:67], a[56:59], a[32:35], v[64:67]
    ds_read_b64_tr_b16 a[24:25], v6 offset:32768
    v_mfma_f32_16x16x32_bf16 v[68:71], a[56:59], a[36:39], v[68:71]
    ds_read_b64_tr_b16 a[26:27], v6 offset:33792
    v_mfma_f32_16x16x32_bf16 v[72:75], a[56:59], a[40:43], v[72:75]
    ds_read_b64_tr_b16 a[28:29], v7 offset:32768
    v_mfma_f32_16x16x32_bf16 v[76:79], a[56:59], a[44:47], v[76:79]
    ds_read_b64_tr_b16 a[30:31], v7 offset:33792
    v_mfma_f32_16x16x32_bf16 v[80:83], a[60:63], a[32:35], v[80:83]
    v_mfma_f32_16x16x32_bf16 v[84:87], a[60:63], a[36:39], v[84:87]
    v_mfma_f32_16x16x32_bf16 v[88:91], a[60:63], a[40:43], v[88:91]
    v_mfma_f32_16x16x32_bf16 v[92:95], a[60:63], a[44:47], v[92:95]
    s_waitcnt lgkmcnt(0)
    v_mfma_f32_16x16x32_bf16 v[32:35], a[16:19], a[0:3], v[32:35]
    ds_read_b128 a[32:35], v2 offset:33792
    v_mfma_f32_16x16x32_bf16 v[36:39], a[16:19], a[4:7], v[36:39]
    ds_read_b64_tr_b16 a[48:49], v4 offset:40960
    v_mfma_f32_16x16x32_bf16 v[40:43], a[16:19], a[8:11], v[40:43]
    ds_read_b64_tr_b16 a[50:51], v4 offset:41984
    v_mfma_f32_16x16x32_bf16 v[44:47], a[16:19], a[12:15], v[44:47]
    ds_read_b128 a[36:39], v2 offset:35840
    v_mfma_f32_16x16x32_bf16 v[48:51], a[20:23], a[0:3], v[48:51]
    ds_read_b128 a[40:43], v3 offset:37888
    v_mfma_f32_16x16x32_bf16 v[52:55], a[20:23], a[4:7], v[52:55]
    ds_read_b128 a[44:47], v3 offset:39936
    v_mfma_f32_16x16x32_bf16 v[56:59], a[20:23], a[8:11], v[56:59]
    ds_read_b64_tr_b16 a[52:53], v5 offset:40960
    v_mfma_f32_16x16x32_bf16 v[60:63], a[20:23], a[12:15], v[60:63]
    ds_read_b64_tr_b16 a[54:55], v5 offset:41984
    v_mfma_f32_16x16x32_bf16 v[64:67], a[24:27], a[0:3], v[64:67]
    ds_read_b64_tr_b16 a[56:57], v6 offset:40960
    v_mfma_f32_16x16x32_bf16 v[68:71], a[24:27], a[4:7], v[68:71]
    ds_read_b64_tr_b16 a[58:59], v6 offset:41984
    v_mfma_f32_16x16x32_bf16 v[72:75], a[24:27], a[8:11], v[72:75]
    ds_read_b64_tr_b16 a[60:61], v7 offset:40960
    v_mfma_f32_16x16x32_bf16 v[76:79], a[24:27], a[12:15], v[76:79]
    ds_read_b64_tr_b16 a[62:63], v7 offset:41984
    v_mfma_f32_16x16x32_bf16 v[80:83], a[28:31], a[0:3], v[80:83]
    v_mfma_f32_16x16x32_bf16 v[84:87], a[28:31], a[4:7], v[84:87]
    v_mfma_f32_16x16x32_bf16 v[88:91], a[28:31], a[8:11], v[88:91]
    v_mfma_f32_16x16x32_bf16 v[92:95], a[28:31], a[12:15], v[92:95]
    s_waitcnt lgkmcnt(0)
    s_barrier
    v_mfma_f32_16x16x32_bf16 v[32:35], a[48:51], a[32:35], v[32:35]
    ds_read_b128 a[0:3], v2 offset:49152
    v_mfma_f32_16x16x32_bf16 v[36:39], a[48:51], a[36:39], v[36:39]
    ds_read_b64_tr_b16 a[16:17], v4 offset:49152
    v_mfma_f32_16x16x32_bf16 v[40:43], a[48:51], a[40:43], v[40:43]
    ds_read_b64_tr_b16 a[18:19], v4 offset:50176
    v_mfma_f32_16x16x32_bf16 v[44:47], a[48:51], a[44:47], v[44:47]
    ds_read_b128 a[4:7], v2 offset:51200
    v_mfma_f32_16x16x32_bf16 v[48:51], a[52:55], a[32:35], v[48:51]
    ds_read_b128 a[8:11], v3 offset:53248
    v_mfma_f32_16x16x32_bf16 v[52:55], a[52:55], a[36:39], v[52:55]
    ds_read_b128 a[12:15], v3 offset:55296
    v_mfma_f32_16x16x32_bf16 v[56:59], a[52:55], a[40:43], v[56:59]
    ds_read_b64_tr_b16 a[20:21], v5 offset:49152
    v_mfma_f32_16x16x32_bf16 v[60:63], a[52:55], a[44:47], v[60:63]
    ds_read_b64_tr_b16 a[22:23], v5 offset:50176
    v_mfma_f32_16x16x32_bf16 v[64:67], a[56:59], a[32:35], v[64:67]
    ds_read_b64_tr_b16 a[24:25], v6 offset:49152
    v_mfma_f32_16x16x32_bf16 v[68:71], a[56:59], a[36:39], v[68:71]
    ds_read_b64_tr_b16 a[26:27], v6 offset:50176
    v_mfma_f32_16x16x32_bf16 v[72:75], a[56:59], a[40:43], v[72:75]
    ds_read_b64_tr_b16 a[28:29], v7 offset:49152
    v_mfma_f32_16x16x32_bf16 v[76:79], a[56:59], a[44:47], v[76:79]
    ds_read_b64_tr_b16 a[30:31], v7 offset:50176
    v_mfma_f32_16x16x32_bf16 v[80:83], a[60:63], a[32:35], v[80:83]
    v_mfma_f32_16x16x32_bf16 v[84:87], a[60:63], a[36:39], v[84:87]
    v_mfma_f32_16x16x32_bf16 v[88:91], a[60:63], a[40:43], v[88:91]
    v_mfma_f32_16x16x32_bf16 v[92:95], a[60:63], a[44:47], v[92:95]
    s_waitcnt lgkmcnt(0)
    v_mfma_f32_16x16x32_bf16 v[32:35], a[16:19], a[0:3], v[32:35]
    ds_read_b128 a[32:35], v2 offset:50176
    v_mfma_f32_16x16x32_bf16 v[36:39], a[16:19], a[4:7], v[36:39]
    ds_read_b64_tr_b16 a[48:49], v4 offset:57344
    v_mfma_f32_16x16x32_bf16 v[40:43], a[16:19], a[8:11], v[40:43]
    ds_read_b64_tr_b16 a[50:51], v4 offset:58368
    v_mfma_f32_16x16x32_bf16 v[44:47], a[16:19], a[12:15], v[44:47]
    ds_read_b128 a[36:39], v2 offset:52224
    v_mfma_f32_16x16x32_bf16 v[48:51], a[20:23], a[0:3], v[48:51]
    ds_read_b128 a[40:43], v3 offset:54272
    v_mfma_f32_16x16x32_bf16 v[52:55], a[20:23], a[4:7], v[52:55]
    ds_read_b128 a[44:47], v3 offset:56320
    v_mfma_f32_16x16x32_bf16 v[56:59], a[20:23], a[8:11], v[56:59]
    ds_read_b64_tr_b16 a[52:53], v5 offset:57344
    v_mfma_f32_16x16x32_bf16 v[60:63], a[20:23], a[12:15], v[60:63]
    ds_read_b64_tr_b16 a[54:55], v5 offset:58368
    v_mfma_f32_16x16x32_bf16 v[64:67], a[24:27], a[0:3], v[64:67]
    ds_read_b64_tr_b16 a[56:57], v6 offset:57344
    v_mfma_f32_16x16x32_bf16 v[68:71], a[24:27], a[4:7], v[68:71]
    ds_read_b64_tr_b16 a[58:59], v6 offset:58368
    v_mfma_f32_16x16x32_bf16 v[72:75], a[24:27], a[8:11], v[72:75]
    ds_read_b64_tr_b16 a[60:61], v7 offset:57344
    v_mfma_f32_16x16x32_bf16 v[76:79], a[24:27], a[12:15], v[76:79]
    ds_read_b64_tr_b16 a[62:63], v7 offset:58368
    v_mfma_f32_16x16x32_bf16 v[80:83], a[28:31], a[0:3], v[80:83]
    v_mfma_f32_16x16x32_bf16 v[84:87], a[28:31], a[4:7], v[84:87]
    v_mfma_f32_16x16x32_bf16 v[88:91], a[28:31], a[8:11], v[88:91]
    v_mfma_f32_16x16x32_bf16 v[92:95], a[28:31], a[12:15], v[92:95]
    s_waitcnt lgkmcnt(0)
    s_barrier
    v_mfma_f32_16x16x32_bf16 v[32:35], a[48:51], a[32:35], v[32:35]
    ds_read_b128 a[0:3], v2 offset:0
    v_mfma_f32_16x16x32_bf16 v[36:39], a[48:51], a[36:39], v[36:39]
    ds_read_b64_tr_b16 a[16:17], v4 offset:0
    v_mfma_f32_16x16x32_bf16 v[40:43], a[48:51], a[40:43], v[40:43]
    ds_read_b64_tr_b16 a[18:19], v4 offset:1024
    v_mfma_f32_16x16x32_bf16 v[44:47], a[48:51], a[44:47], v[44:47]
    ds_read_b128 a[4:7], v2 offset:2048
    v_mfma_f32_16x16x32_bf16 v[48:51], a[52:55], a[32:35], v[48:51]
    ds_read_b128 a[8:11], v3 offset:4096
    v_mfma_f32_16x16x32_bf16 v[52:55], a[52:55], a[36:39], v[52:55]
    ds_read_b128 a[12:15], v3 offset:6144
    v_mfma_f32_16x16x32_bf16 v[56:59], a[52:55], a[40:43], v[56:59]
    ds_read_b64_tr_b16 a[20:21], v5 offset:0
    v_mfma_f32_16x16x32_bf16 v[60:63], a[52:55], a[44:47], v[60:63]
    ds_read_b64_tr_b16 a[22:23], v5 offset:1024
    v_mfma_f32_16x16x32_bf16 v[64:67], a[56:59], a[32:35], v[64:67]
    ds_read_b64_tr_b16 a[24:25], v6 offset:0
    v_mfma_f32_16x16x32_bf16 v[68:71], a[56:59], a[36:39], v[68:71]
    ds_read_b64_tr_b16 a[26:27], v6 offset:1024
    v_mfma_f32_16x16x32_bf16 v[72:75], a[56:59], a[40:43], v[72:75]
    ds_read_b64_tr_b16 a[28:29], v7 offset:0
    v_mfma_f32_16x16x32_bf16 v[76:79], a[56:59], a[44:47], v[76:79]
    ds_read_b64_tr_b16 a[30:31], v7 offset:1024
    v_mfma_f32_16x16x32_bf16 v[80:83], a[60:63], a[32:35], v[80:83]
    v_mfma_f32_16x16x32_bf16 v[84:87], a[60:63], a[36:39], v[84:87]
    v_mfma_f32_16x16x32_bf16 v[88:91], a[60:63], a[40:43], v[88:91]
    v_mfma_f32_16x16x32_bf16 v[92:95], a[60:63], a[44:47], v[92:95]
    s_waitcnt lgkmcnt(0)
    v_mfma_f32_16x16x32_bf16 v[32:35], a[16:19], a[0:3], v[32:35]
    ds_read_b128 a[32:35], v2 offset:1024
    v_mfma_f32_16x16x32_bf16 v[36:39], a[16:19], a[4:7], v[36:39]
    ds_read_b64_tr_b16 a[48:49], v4 offset:8192
    v_mfma_f32_16x16x32_bf16 v[40:43], a[16:19], a[8:11], v[40:43]
    ds_read_b64_tr_b16 a[50:51], v4 offset:9216
    v_mfma_f32_16x16x32_bf16 v[44:47], a[16:19], a[12:15], v[44:47]
    ds_read_b128 a[36:39], v2 offset:3072
    v_mfma_f32_16x16x32_bf16 v[48:51], a[20:23], a[0:3], v[48:51]
    ds_read_b128 a[40:43], v3 offset:5120
    v_mfma_f32_16x16x32_bf16 v[52:55], a[20:23], a[4:7], v[52:55]
    ds_read_b128 a[44:47], v3 offset:7168
    v_mfma_f32_16x16x32_bf16 v[56:59], a[20:23], a[8:11], v[56:59]
    ds_read_b64_tr_b16 a[52:53], v5 offset:8192
    v_mfma_f32_16x16x32_bf16 v[60:63], a[20:23], a[12:15], v[60:63]
    ds_read_b64_tr_b16 a[54:55], v5 offset:9216
    v_mfma_f32_16x16x32_bf16 v[64:67], a[24:27], a[0:3], v[64:67]
    ds_read_b64_tr_b16 a[56:57], v6 offset:8192
    v_mfma_f32_16x16x32_bf16 v[68:71], a[24:27], a[4:7], v[68:71]
    ds_read_b64_tr_b16 a[58:59], v6 offset:9216
    v_mfma_f32_16x16x32_bf16 v[72:75], a[24:27], a[8:11], v[72:75]
    ds_read_b64_tr_b16 a[60:61], v7 offset:8192
    v_mfma_f32_16x16x32_bf16 v[76:79], a[24:27], a[12:15], v[76:79]
    ds_read_b64_tr_b16 a[62:63], v7 offset:9216
    v_mfma_f32_16x16x32_bf16 v[80:83], a[28:31], a[0:3], v[80:83]
    v_mfma_f32_16x16x32_bf16 v[84:87], a[28:31], a[4:7], v[84:87]
    v_mfma_f32_16x16x32_bf16 v[88:91], a[28:31], a[8:11], v[88:91]
    v_mfma_f32_16x16x32_bf16 v[92:95], a[28:31], a[12:15], v[92:95]
    s_waitcnt vmcnt(0)
    s_mov_b32 s37, 0x40000
L_opoll:
    v_cmp_eq_u32 vcc, 1, v17
    s_nop 0
    s_cmp_eq_u64 vcc, -1
    s_cbranch_scc1 L_opoll_ok
    s_sleep 2
    buffer_load_dword v17, v24, s[20:23], s47 offen sc1
    s_sub_u32 s37, s37, 1
    s_waitcnt vmcnt(0)
    s_cbranch_scc0 L_opoll
L_opoll_ok:
    buffer_load_dword v8, v11, s[20:23], 0 offen offset:0 sc1
    buffer_load_dword v10, v11, s[20:23], 0 offen offset:64 sc1
    s_lshl_b32 s3, s54, 8
    v_subrev_u32 v11, s3, v11
    buffer_load_dword v12, v11, s[20:23], 0 offen offset:128 sc1
    buffer_load_dword v14, v11, s[20:23], 0 offen offset:192 sc1
    s_waitcnt lgkmcnt(0)
    s_barrier
    v_mfma_f32_16x16x32_bf16 v[32:35], a[48:51], a[32:35], v[32:35]
    ds_read_b128 a[0:3], v2 offset:16384
    v_mfma_f32_16x16x32_bf16 v[36:39], a[48:51], a[36:39], v[36:39]
    ds_read_b64_tr_b16 a[16:17], v4 offset:16384
    v_mfma_f32_16x16x32_bf16 v[40:43], a[48:51], a[40:43], v[40:43]
    ds_read_b64_tr_b16 a[18:19], v4 offset:17408
    v_mfma_f32_16x16x32_bf16 v[44:47], a[48:51], a[44:47], v[44:47]
    ds_read_b128 a[4:7], v2 offset:18432
    v_mfma_f32_16x16x32_bf16 v[48:51], a[52:55], a[32:35], v[48:51]
    ds_read_b128 a[8:11], v3 offset:20480
    v_mfma_f32_16x16x32_bf16 v[52:55], a[52:55], a[36:39], v[52:55]
    ds_read_b128 a[12:15], v3 offset:22528
    v_mfma_f32_16x16x32_bf16 v[56:59], a[52:55], a[40:43], v[56:59]
    ds_read_b64_tr_b16 a[20:21], v5 offset:16384
    v_mfma_f32_16x16x32_bf16 v[60:63], a[52:55], a[44:47], v[60:63]
    ds_read_b64_tr_b16 a[22:23], v5 offset:17408
    v_mfma_f32_16x16x32_bf16 v[64:67], a[56:59], a[32:35], v[64:67]
    ds_read_b64_tr_b16 a[24:25], v6 offset:16384
    v_mfma_f32_16x16x32_bf16 v[68:71], a[56:59], a[36:39], v[68:71]
    ds_read_b64_tr_b16 a[26:27], v6 offset:17408
    v_mfma_f32_16x16x32_bf16 v[72:75], a[56:59], a[40:43], v[72:75]
    ds_read_b64_tr_b16 a[28:29], v7 offset:16384
    v_mfma_f32_16x16x32_bf16 v[76:79], a[56:59], a[44:47], v[76:79]
    ds_read_b64_tr_b16 a[30:31], v7 offset:17408
    v_mfma_f32_16x16x32_bf16 v[80:83], a[60:63], a[32:35], v[80:83]
    v_mfma_f32_16x16x32_bf16 v[84:87], a[60:63], a[36:39], v[84:87]
    v_mfma_f32_16x16x32_bf16 v[88:91], a[60:63], a[40:43], v[88:91]
    v_mfma_f32_16x16x32_bf16 v[92:95], a[60:63], a[44:47], v[92:95]
    s_waitcnt lgkmcnt(0)
    v_mfma_f32_16x16x32_bf16 v[32:35], a[16:19], a[0:3], v[32:35]
    ds_read_b128 a[32:35], v2 offset:17408
    v_mfma_f32_16x16x32_bf16 v[36:39], a[16:19], a[4:7], v[36:39]
    ds_read_b64_tr_b16 a[48:49], v4 offset:24576
    v_mfma_f32_16x16x32_bf16 v[40:43], a[16:19], a[8:11], v[40:43]
    ds_read_b64_tr_b16 a[50:51], v4 offset:25600
    v_mfma_f32_16x16x32_bf16 v[44:47], a[16:19], a[12:15], v[44:47]
    ds_read_b128 a[36:39], v2 offset:19456
    v_mfma_f32_16x16x32_bf16 v[48:51], a[20:23], a[0:3], v[48:51]
    ds_read_b128 a[40:43], v3 offset:21504
    v_mfma_f32_16x16x32_bf16 v[52:55], a[20:23], a[4:7], v[52:55]
    ds_read_b128 a[44:47], v3 offset:23552
    v_mfma_f32_16x16x32_bf16 v[56:59], a[20:23], a[8:11], v[56:59]
    ds_read_b64_tr_b16 a[52:53], v5 offset:24576
    v_mfma_f32_16x16x32_bf16 v[60:63], a[20:23], a[12:15], v[60:63]
    ds_read_b64_tr_b16 a[54:55], v5 offset:25600
    v_mfma_f32_16x16x32_bf16 v[64:67], a[24:27], a[0:3], v[64:67]
    ds_read_b64_tr_b16 a[56:57], v6 offset:24576
    v_mfma_f32_16x16x32_bf16 v[68:71], a[24:27], a[4:7], v[68:71]
    ds_read_b64_tr_b16 a[58:59], v6 offset:25600
    v_mfma_f32_16x16x32_bf16 v[72:75], a[24:27], a[8:11], v[72:75]
    ds_read_b64_tr_b16 a[60:61], v7 offset:24576
    v_mfma_f32_16x16x32_bf16 v[76:79], a[24:27], a[12:15], v[76:79]
    ds_read_b64_tr_b16 a[62:63], v7 offset:25600
    v_mfma_f32_16x16x32_bf16 v[80:83], a[28:31], a[0:3], v[80:83]
    v_mfma_f32_16x16x32_bf16 v[84:87], a[28:31], a[4:7], v[84:87]
    v_mfma_f32_16x16x32_bf16 v[88:91], a[28:31], a[8:11], v[88:91]
    v_mfma_f32_16x16x32_bf16 v[92:95], a[28:31], a[12:15], v[92:95]
    s_waitcnt lgkmcnt(0)
    s_barrier
    v_mfma_f32_16x16x32_bf16 v[32:35], a[48:51], a[32:35], v[32:35]
    ds_read_b128 a[0:3], v2 offset:32768
    v_mfma_f32_16x16x32_bf16 v[36:39], a[48:51], a[36:39], v[36:39]
    ds_read_b64_tr_b16 a[16:17], v4 offset:32768
    v_mfma_f32_16x16x32_bf16 v[40:43], a[48:51], a[40:43], v[40:43]
    ds_read_b64_tr_b16 a[18:19], v4 offset:33792
    v_mfma_f32_16x16x32_bf16 v[44:47], a[48:51], a[44:47], v[44:47]
    ds_read_b128 a[4:7], v2 offset:34816
    v_mfma_f32_16x16x32_bf16 v[48:51], a[52:55], a[32:35], v[48:51]
    ds_read_b128 a[8:11], v3 offset:36864
    v_mfma_f32_16x16x32_bf16 v[52:55], a[52:55], a[36:39], v[52:55]
    ds_read_b128 a[12:15], v3 offset:38912
    v_mfma_f32_16x16x32_bf16 v[56:59], a[52:55], a[40:43], v[56:59]
    ds_read_b64_tr_b16 a[20:21], v5 offset:32768
    v_mfma_f32_16x16x32_bf16 v[60:63], a[52:55], a[44:47], v[60:63]
    ds_read_b64_tr_b16 a[22:23], v5 offset:33792
    v_mfma_f32_16x16x32_bf16 v[64:67], a[56:59], a[32:35], v[64:67]
    ds_read_b64_tr_b16 a[24:25], v6 offset:32768
    v_mfma_f32_16x16x32_bf16 v[68:71], a[56:59], a[36:39], v[68:71]
    ds_read_b64_tr_b16 a[26:27], v6 offset:33792
    v_mfma_f32_16x16x32_bf16 v[72:75], a[56:59], a[40:43], v[72:75]
    ds_read_b64_tr_b16 a[28:29], v7 offset:32768
    v_mfma_f32_16x16x32_bf16 v[76:79], a[56:59], a[44:47], v[76:79]
    ds_read_b64_tr_b16 a[30:31], v7 offset:33792
    v_mfma_f32_16x16x32_bf16 v[80:83], a[60:63], a[32:35], v[80:83]
    v_mfma_f32_16x16x32_bf16 v[84:87], a[60:63], a[36:39], v[84:87]
    v_mfma_f32_16x16x32_bf16 v[88:91], a[60:63], a[40:43], v[88:91]
    v_mfma_f32_16x16x32_bf16 v[92:95], a[60:63], a[44:47], v[92:95]
    s_waitcnt lgkmcnt(0)
    v_mfma_f32_16x16x32_bf16 v[32:35], a[16:19], a[0:3], v[32:35]
    ds_read_b128 a[32:35], v2 offset:33792
    v_mfma_f32_16x16x32_bf16 v[36:39], a[16:19], a[4:7], v[36:39]
    ds_read_b64_tr_b16 a[48:49], v4 offset:40960
    v_mfma_f32_16x16x32_bf16 v[40:43], a[16:19], a[8:11], v[40:43]
    ds_read_b64_tr_b16 a[50:51], v4 offset:41984
    v_mfma_f32_16x16x32_bf16 v[44:47], a[16:19], a[12:15], v[44:47]
    ds_read_b128 a[36:39], v2 offset:35840
    v_mfma_f32_16x16x32_bf16 v[48:51], a[20:23], a[0:3], v[48:51]
    ds_read_b128 a[40:43], v3 offset:37888
    v_mfma_f32_16x16x32_bf16 v[52:55], a[20:23], a[4:7], v[52:55]
    ds_read_b128 a[44:47], v3 offset:39936
    v_mfma_f32_16x16x32_bf16 v[56:59], a[20:23], a[8:11], v[56:59]
    ds_read_b64_tr_b16 a[52:53], v5 offset:40960
    v_mfma_f32_16x16x32_bf16 v[60:63], a[20:23], a[12:15], v[60:63]
    ds_read_b64_tr_b16 a[54:55], v5 offset:41984
    v_mfma_f32_16x16x32_bf16 v[64:67], a[24:27], a[0:3], v[64:67]
    ds_read_b64_tr_b16 a[56:57], v6 offset:40960
    v_mfma_f32_16x16x32_bf16 v[68:71], a[24:27], a[4:7], v[68:71]
    ds_read_b64_tr_b16 a[58:59], v6 offset:41984
    v_mfma_f32_16x16x32_bf16 v[72:75], a[24:27], a[8:11], v[72:75]
    ds_read_b64_tr_b16 a[60:61], v7 offset:40960
    v_mfma_f32_16x16x32_bf16 v[76:79], a[24:27], a[12:15], v[76:79]
    ds_read_b64_tr_b16 a[62:63], v7 offset:41984
    v_mfma_f32_16x16x32_bf16 v[80:83], a[28:31], a[0:3], v[80:83]
    v_mfma_f32_16x16x32_bf16 v[84:87], a[28:31], a[4:7], v[84:87]
    v_mfma_f32_16x16x32_bf16 v[88:91], a[28:31], a[8:11], v[88:91]
    v_mfma_f32_16x16x32_bf16 v[92:95], a[28:31], a[12:15], v[92:95]
    s_waitcnt lgkmcnt(0)
    s_barrier
    v_mfma_f32_16x16x32_bf16 v[32:35], a[48:51], a[32:35], v[32:35]
    ds_read_b128 a[0:3], v2 offset:49152
    v_mfma_f32_16x16x32_bf16 v[36:39], a[48:51], a[36:39], v[36:39]
    ds_read_b64_tr_b16 a[16:17], v4 offset:49152
    v_mfma_f32_16x16x32_bf16 v[40:43], a[48:51], a[40:43], v[40:43]
    ds_read_b64_tr_b16 a[18:19], v4 offset:50176
    v_mfma_f32_16x16x32_bf16 v[44:47], a[48:51], a[44:47], v[44:47]
    ds_read_b128 a[4:7], v2 offset:51200
    v_mfma_f32_16x16x32_bf16 v[48:51], a[52:55], a[32:35], v[48:51]
    ds_read_b128 a[8:11], v3 offset:53248
    v_mfma_f32_16x16x32_bf16 v[52:55], a[52:55], a[36:39], v[52:55]
    ds_read_b128 a[12:15], v3 offset:55296
    v_mfma_f32_16x16x32_bf16 v[56:59], a[52:55], a[40:43], v[56:59]
    ds_read_b64_tr_b16 a[20:21], v5 offset:49152
    v_mfma_f32_16x16x32_bf16 v[60:63], a[52:55], a[44:47], v[60:63]
    ds_read_b64_tr_b16 a[22:23], v5 offset:50176
    v_mfma_f32_16x16x32_bf16 v[64:67], a[56:59], a[32:35], v[64:67]
    ds_read_b64_tr_b16 a[24:25], v6 offset:49152
    v_mfma_f32_16x16x32_bf16 v[68:71], a[56:59], a[36:39], v[68:71]
    ds_read_b64_tr_b16 a[26:27], v6 offset:50176
    v_mfma_f32_16x16x32_bf16 v[72:75], a[56:59], a[40:43], v[72:75]
    ds_read_b64_tr_b16 a[28:29], v7 offset:49152
    v_mfma_f32_16x16x32_bf16 v[76:79], a[56:59], a[44:47], v[76:79]
    ds_read_b64_tr_b16 a[30:31], v7 offset:50176
    v_mfma_f32_16x16x32_bf16 v[80:83], a[60:63], a[32:35], v[80:83]
    v_mfma_f32_16x16x32_bf16 v[84:87], a[60:63], a[36:39], v[84:87]
    v_mfma_f32_16x16x32_bf16 v[88:91], a[60:63], a[40:43], v[88:91]
    v_mfma_f32_16x16x32_bf16 v[92:95], a[60:63], a[44:47], v[92:95]
    s_waitcnt lgkmcnt(0)
    v_mfma_f32_16x16x32_bf16 v[32:35], a[16:19], a[0:3], v[32:35]
    ds_read_b128 a[32:35], v2 offset:50176
    v_mfma_f32_16x16x32_bf16 v[36:39], a[16:19], a[4:7], v[36:39]
    ds_read_b64_tr_b16 a[48:49], v4 offset:57344
    v_mfma_f32_16x16x32_bf16 v[40:43], a[16:19], a[8:11], v[40:43]
    ds_read_b64_tr_b16 a[50:51], v4 offset:58368
    v_mfma_f32_16x16x32_bf16 v[44:47], a[16:19], a[12:15], v[44:47]
    ds_read_b128 a[36:39], v2 offset:52224
    v_mfma_f32_16x16x32_bf16 v[48:51], a[20:23], a[0:3], v[48:51]
    ds_read_b128 a[40:43], v3 offset:54272
    v_mfma_f32_16x16x32_bf16 v[52:55], a[20:23], a[4:7], v[52:55]
    ds_read_b128 a[44:47], v3 offset:56320
    v_mfma_f32_16x16x32_bf16 v[56:59], a[20:23], a[8:11], v[56:59]
    ds_read_b64_tr_b16 a[52:53], v5 offset:57344
    v_mfma_f32_16x16x32_bf16 v[60:63], a[20:23], a[12:15], v[60:63]
    ds_read_b64_tr_b16 a[54:55], v5 offset:58368
    v_mfma_f32_16x16x32_bf16 v[64:67], a[24:27], a[0:3], v[64:67]
    ds_read_b64_tr_b16 a[56:57], v6 offset:57344
    v_mfma_f32_16x16x32_bf16 v[68:71], a[24:27], a[4:7], v[68:71]
    ds_read_b64_tr_b16 a[58:59], v6 offset:58368
    v_mfma_f32_16x16x32_bf16 v[72:75], a[24:27], a[8:11], v[72:75]
    ds_read_b64_tr_b16 a[60:61], v7 offset:57344
    v_mfma_f32_16x16x32_bf16 v[76:79], a[24:27], a[12:15], v[76:79]
    ds_read_b64_tr_b16 a[62:63], v7 offset:58368
    v_mfma_f32_16x16x32_bf16 v[80:83], a[28:31], a[0:3], v[80:83]
    v_mfma_f32_16x16x32_bf16 v[84:87], a[28:31], a[4:7], v[84:87]
    v_mfma_f32_16x16x32_bf16 v[88:91], a[28:31], a[8:11], v[88:91]
    v_mfma_f32_16x16x32_bf16 v[92:95], a[28:31], a[12:15], v[92:95]
    s_waitcnt lgkmcnt(0)
    s_barrier
    v_mfma_f32_16x16x32_bf16 v[32:35], a[48:51], a[32:35], v[32:35]
    ds_read_b128 a[0:3], v2 offset:0
    v_mfma_f32_16x16x32_bf16 v[36:39], a[48:51], a[36:39], v[36:39]
    ds_read_b64_tr_b16 a[16:17], v4 offset:0
    v_mfma_f32_16x16x32_bf16 v[40:43], a[48:51], a[40:43], v[40:43]
    ds_read_b64_tr_b16 a[18:19], v4 offset:1024
    v_mfma_f32_16x16x32_bf16 v[44:47], a[48:51], a[44:47], v[44:47]
    ds_read_b128 a[4:7], v2 offset:2048
    v_mfma_f32_16x16x32_bf16 v[48:51], a[52:55], a[32:35], v[48:51]
    ds_read_b128 a[8:11], v3 offset:4096
    v_mfma_f32_16x16x32_bf16 v[52:55], a[52:55], a[36:39], v[52:55]
    ds_read_b128 a[12:15], v3 offset:6144
    v_mfma_f32_16x16x32_bf16 v[56:59], a[52:55], a[40:43], v[56:59]
    ds_read_b64_tr_b16 a[20:21], v5 offset:0
    v_mfma_f32_16x16x32_bf16 v[60:63], a[52:55], a[44:47], v[60:63]
    ds_read_b64_tr_b16 a[22:23], v5 offset:1024
    v_mfma_f32_16x16x32_bf16 v[64:67], a[56:59], a[32:35], v[64:67]
    ds_read_b64_tr_b16 a[24:25], v6 offset:0
    v_mfma_f32_16x16x32_bf16 v[68:71], a[56:59], a[36:39], v[68:71]
    ds_read_b64_tr_b16 a[26:27], v6 offset:1024
    v_mfma_f32_16x16x32_bf16 v[72:75], a[56:59], a[40:43], v[72:75]
    ds_read_b64_tr_b16 a[28:29], v7 offset:0
    v_mfma_f32_16x16x32_bf16 v[76:79], a[56:59], a[44:47], v[76:79]
    ds_read_b64_tr_b16 a[30:31], v7 offset:1024
    v_mfma_f32_16x16x32_bf16 v[80:83], a[60:63], a[32:35], v[80:83]
    v_mfma_f32_16x16x32_bf16 v[84:87], a[60:63], a[36:39], v[84:87]
    v_mfma_f32_16x16x32_bf16 v[88:91], a[60:63], a[40:43], v[88:91]
    v_mfma_f32_16x16x32_bf16 v[92:95], a[60:63], a[44:47], v[92:95]
    s_waitcnt vmcnt(0)
    s_waitcnt lgkmcnt(0)
    v_mfma_f32_16x16x32_bf16 v[96:99], a[16:19], a[0:3], 0
    ds_read_b128 a[32:35], v2 offset:1024
    v_sub_f32 v16, 1.0, v8
    v_mfma_f32_16x16x32_bf16 v[100:103], a[16:19], a[4:7], 0
    ds_read_b64_tr_b16 a[48:49], v4 offset:8192
    v_sub_f32 v18, 1.0, v10
    v_mfma_f32_16x16x32_bf16 v[104:107], a[16:19], a[8:11], 0
    ds_read_b64_tr_b16 a[50:51], v4 offset:9216
    v_sub_f32 v20, 1.0, v12
    v_mfma_f32_16x16x32_bf16 v[108:111], a[16:19], a[12:15], 0
    ds_read_b128 a[36:39], v2 offset:3072
    v_sub_f32 v22, 1.0, v14
    v_mfma_f32_16x16x32_bf16 v[112:115], a[20:23], a[0:3], 0
    ds_read_b128 a[40:43], v3 offset:5120
    s_cmp_eq_u32 s54, 1
    s_cselect_b64 vcc, -1, 0
    v_mfma_f32_16x16x32_bf16 v[116:119], a[20:23], a[4:7], 0
    ds_read_b128 a[44:47], v3 offset:7168
    v_cndmask_b32 v24, v16, v8, vcc
    v_mfma_f32_16x16x32_bf16 v[120:123], a[20:23], a[8:11], 0
    ds_read_b64_tr_b16 a[52:53], v5 offset:8192
    v_cndmask_b32 v26, v18, v10, vcc
    v_mfma_f32_16x16x32_bf16 v[124:127], a[20:23], a[12:15], 0
    ds_read_b64_tr_b16 a[54:55], v5 offset:9216
    v_cndmask_b32 v28, v20, v12, vcc
    v_mfma_f32_16x16x32_bf16 v[128:131], a[24:27], a[0:3], 0
    ds_read_b64_tr_b16 a[56:57], v6 offset:8192
    v_cndmask_b32 v30, v22, v14, vcc
    v_mfma_f32_16x16x32_bf16 v[132:135], a[24:27], a[4:7], 0
    ds_read_b64_tr_b16 a[58:59], v6 offset:9216
    v_mul_f32 v32, v32, v16
    v_mfma_f32_16x16x32_bf16 v[136:139], a[24:27], a[8:11], 0
    ds_read_b64_tr_b16 a[60:61], v7 offset:8192
    v_mul_f32 v33, v33, v16
    v_mfma_f32_16x16x32_bf16 v[140:143], a[24:27], a[12:15], 0
    ds_read_b64_tr_b16 a[62:63], v7 offset:9216
    v_mul_f32 v34, v34, v16
    v_mfma_f32_16x16x32_bf16 v[144:147], a[28:31], a[0:3], 0
    v_mul_f32 v35, v35, v16
    v_mfma_f32_16x16x32_bf16 v[148:151], a[28:31], a[4:7], 0
    v_mul_f32 v36, v36, v18
    v_mfma_f32_16x16x32_bf16 v[152:155], a[28:31], a[8:11], 0
    v_mul_f32 v37, v37, v18
    v_mfma_f32_16x16x32_bf16 v[156:159], a[28:31], a[12:15], 0
    v_mul_f32 v38, v38, v18
    s_waitcnt lgkmcnt(0)
    s_barrier
    v_mfma_f32_16x16x32_bf16 v[96:99], a[48:51], a[32:35], v[96:99]
    ds_read_b128 a[0:3], v2 offset:16384
    v_mul_f32 v39, v39, v18
    v_mfma_f32_16x16x32_bf16 v[100:103], a[48:51], a[36:39], v[100:103]
    ds_read_b64_tr_b16 a[16:17], v4 offset:16384
    v_mul_f32 v40, v40, v20
    v_mfma_f32_16x16x32_bf16 v[104:107], a[48:51], a[40:43], v[104:107]
    ds_read_b64_tr_b16 a[18:19], v4 offset:17408
    v_mul_f32 v41, v41, v20
    v_mfma_f32_16x16x32_bf16 v[108:111], a[48:51], a[44:47], v[108:111]
    ds_read_b128 a[4:7], v2 offset:18432
    v_mul_f32 v42, v42, v20
    v_mfma_f32_16x16x32_bf16 v[112:115], a[52:55], a[32:35], v[112:115]
    ds_read_b128 a[8:11], v3 offset:20480
    v_mul_f32 v43, v43, v20
    v_mfma_f32_16x16x32_bf16 v[116:119], a[52:55], a[36:39], v[116:119]
    ds_read_b128 a[12:15], v3 offset:22528
    v_mul_f32 v44, v44, v22
    v_mfma_f32_16x16x32_bf16 v[120:123], a[52:55], a[40:43], v[120:123]
    ds_read_b64_tr_b16 a[20:21], v5 offset:16384
    v_mul_f32 v45, v45, v22
    v_mfma_f32_16x16x32_bf16 v[124:127], a[52:55], a[44:47], v[124:127]
    ds_read_b64_tr_b16 a[22:23], v5 offset:17408
    v_mul_f32 v46, v46, v22
    v_mfma_f32_16x16x32_bf16 v[128:131], a[56:59], a[32:35], v[128:131]
    ds_read_b64_tr_b16 a[24:25], v6 offset:16384
    v_mul_f32 v47, v47, v22
    v_mfma_f32_16x16x32_bf16 v[132:135], a[56:59], a[36:39], v[132:135]
    ds_read_b64_tr_b16 a[26:27], v6 offset:17408
    v_mul_f32 v48, v48, v16
    v_mfma_f32_16x16x32_bf16 v[136:139], a[56:59], a[40:43], v[136:139]
    ds_read_b64_tr_b16 a[28:29], v7 offset:16384
    v_mul_f32 v49, v49, v16
    v_mfma_f32_16x16x32_bf16 v[140:143], a[56:59], a[44:47], v[140:143]
    ds_read_b64_tr_b16 a[30:31], v7 offset:17408
    v_mul_f32 v50, v50, v16
    v_mfma_f32_16x16x32_bf16 v[144:147], a[60:63], a[32:35], v[144:147]
    v_mul_f32 v51, v51, v16
    v_mfma_f32_16x16x32_bf16 v[148:151], a[60:63], a[36:39], v[148:151]
    v_mul_f32 v52, v52, v18
    v_mfma_f32_16x16x32_bf16 v[152:155], a[60:63], a[40:43], v[152:155]
    v_mul_f32 v53, v53, v18
    v_mfma_f32_16x16x32_bf16 v[156:159], a[60:63], a[44:47], v[156:159]
    v_mul_f32 v54, v54, v18
    s_waitcnt lgkmcnt(0)
    v_mfma_f32_16x16x32_bf16 v[96:99], a[16:19], a[0:3], v[96:99]
    ds_read_b128 a[32:35], v2 offset:17408
    v_mul_f32 v55, v55, v18
    v_mfma_f32_16x16x32_bf16 v[100:103], a[16:19], a[4:7], v[100:103]
    ds_read_b64_tr_b16 a[48:49], v4 offset:24576
    v_mul_f32 v56, v56, v20
    v_mfma_f32_16x16x32_bf16 v[104:107], a[16:19], a[8:11], v[104:107]
    ds_read_b64_tr_b16 a[50:51], v4 offset:25600
    v_mul_f32 v57, v57, v20
    v_mfma_f32_16x16x32_bf16 v[108:111], a[16:19], a[12:15], v[108:111]
    ds_read_b128 a[36:39], v2 offset:19456
    v_mul_f32 v58, v58, v20
    v_mfma_f32_16x16x32_bf16 v[112:115], a[20:23], a[0:3], v[112:115]
    ds_read_b128 a[40:43], v3 offset:21504
    v_mul_f32 v59, v59, v20
    v_mfma_f32_16x16x32_bf16 v[116:119], a[20:23], a[4:7], v[116:119]
    ds_read_b128 a[44:47], v3 offset:23552
    v_mul_f32 v60, v60, v22
    v_mfma_f32_16x16x32_bf16 v[120:123], a[20:23], a[8:11], v[120:123]
    ds_read_b64_tr_b16 a[52:53], v5 offset:24576
    v_mul_f32 v61, v61, v22
    v_mfma_f32_16x16x32_bf16 v[124:127], a[20:23], a[12:15], v[124:127]
    ds_read_b64_tr_b16 a[54:55], v5 offset:25600
    v_mul_f32 v62, v62, v22
    v_mfma_f32_16x16x32_bf16 v[128:131], a[24:27], a[0:3], v[128:131]
    ds_read_b64_tr_b16 a[56:57], v6 offset:24576
    v_mul_f32 v63, v63, v22
    v_mfma_f32_16x16x32_bf16 v[132:135], a[24:27], a[4:7], v[132:135]
    ds_read_b64_tr_b16 a[58:59], v6 offset:25600
    v_mul_f32 v64, v64, v16
    v_mfma_f32_16x16x32_bf16 v[136:139], a[24:27], a[8:11], v[136:139]
    ds_read_b64_tr_b16 a[60:61], v7 offset:24576
    v_mul_f32 v65, v65, v16
    v_mfma_f32_16x16x32_bf16 v[140:143], a[24:27], a[12:15], v[140:143]
    ds_read_b64_tr_b16 a[62:63], v7 offset:25600
    v_mul_f32 v66, v66, v16
    v_mfma_f32_16x16x32_bf16 v[144:147], a[28:31], a[0:3], v[144:147]
    v_mul_f32 v67, v67, v16
    v_mfma_f32_16x16x32_bf16 v[148:151], a[28:31], a[4:7], v[148:151]
    v_mul_f32 v68, v68, v18
    v_mfma_f32_16x16x32_bf16 v[152:155], a[28:31], a[8:11], v[152:155]
    v_mul_f32 v69, v69, v18
    v_mfma_f32_16x16x32_bf16 v[156:159], a[28:31], a[12:15], v[156:159]
    v_mul_f32 v70, v70, v18
    s_waitcnt lgkmcnt(0)
    s_barrier
    v_mfma_f32_16x16x32_bf16 v[96:99], a[48:51], a[32:35], v[96:99]
    ds_read_b128 a[0:3], v2 offset:32768
    v_mul_f32 v71, v71, v18
    v_mfma_f32_16x16x32_bf16 v[100:103], a[48:51], a[36:39], v[100:103]
    ds_read_b64_tr_b16 a[16:17], v4 offset:32768
    v_mul_f32 v72, v72, v20
    v_mfma_f32_16x16x32_bf16 v[104:107], a[48:51], a[40:43], v[104:107]
    ds_read_b64_tr_b16 a[18:19], v4 offset:33792
    v_mul_f32 v73, v73, v20
    v_mfma_f32_16x16x32_bf16 v[108:111], a[48:51], a[44:47], v[108:111]
    ds_read_b128 a[4:7], v2 offset:34816
    v_mul_f32 v74, v74, v20
    v_mfma_f32_16x16x32_bf16 v[112:115], a[52:55], a[32:35], v[112:115]
    ds_read_b128 a[8:11], v3 offset:36864
    v_mul_f32 v75, v75, v20
    v_mfma_f32_16x16x32_bf16 v[116:119], a[52:55], a[36:39], v[116:119]
    ds_read_b128 a[12:15], v3 offset:38912
    v_mul_f32 v76, v76, v22
    v_mfma_f32_16x16x32_bf16 v[120:123], a[52:55], a[40:43], v[120:123]
    ds_read_b64_tr_b16 a[20:21], v5 offset:32768
    v_mul_f32 v77, v77, v22
    v_mfma_f32_16x16x32_bf16 v[124:127], a[52:55], a[44:47], v[124:127]
    ds_read_b64_tr_b16 a[22:23], v5 offset:33792
    v_mul_f32 v78, v78, v22
    v_mfma_f32_16x16x32_bf16 v[128:131], a[56:59], a[32:35], v[128:131]
    ds_read_b64_tr_b16 a[24:25], v6 offset:32768
    v_mul_f32 v79, v79, v22
    v_mfma_f32_16x16x32_bf16 v[132:135], a[56:59], a[36:39], v[132:135]
    ds_read_b64_tr_b16 a[26:27], v6 offset:33792
    v_mul_f32 v80, v80, v16
    v_mfma_f32_16x16x32_bf16 v[136:139], a[56:59], a[40:43], v[136:139]
    ds_read_b64_tr_b16 a[28:29], v7 offset:32768
    v_mul_f32 v81, v81, v16
    v_mfma_f32_16x16x32_bf16 v[140:143], a[56:59], a[44:47], v[140:143]
    ds_read_b64_tr_b16 a[30:31], v7 offset:33792
    v_mul_f32 v82, v82, v16
    v_mfma_f32_16x16x32_bf16 v[144:147], a[60:63], a[32:35], v[144:147]
    v_mul_f32 v83, v83, v16
    v_mfma_f32_16x16x32_bf16 v[148:151], a[60:63], a[36:39], v[148:151]
    v_mul_f32 v84, v84, v18
    v_mfma_f32_16x16x32_bf16 v[152:155], a[60:63], a[40:43], v[152:155]
    v_mul_f32 v85, v85, v18
    v_mfma_f32_16x16x32_bf16 v[156:159], a[60:63], a[44:47], v[156:159]
    v_mul_f32 v86, v86, v18
    s_waitcnt lgkmcnt(0)
    v_mfma_f32_16x16x32_bf16 v[96:99], a[16:19], a[0:3], v[96:99]
    ds_read_b128 a[32:35], v2 offset:33792
    v_mul_f32 v87, v87, v18
    v_mfma_f32_16x16x32_bf16 v[100:103], a[16:19], a[4:7], v[100:103]
    ds_read_b64_tr_b16 a[48:49], v4 offset:40960
    v_mul_f32 v88, v88, v20
    v_mfma_f32_16x16x32_bf16 v[104:107], a[16:19], a[8:11], v[104:107]
    ds_read_b64_tr_b16 a[50:51], v4 offset:41984
    v_mul_f32 v89, v89, v20
    v_mfma_f32_16x16x32_bf16 v[108:111], a[16:19], a[12:15], v[108:111]
    ds_read_b128 a[36:39], v2 offset:35840
    v_mul_f32 v90, v90, v20
    v_mfma_f32_16x16x32_bf16 v[112:115], a[20:23], a[0:3], v[112:115]
    ds_read_b128 a[40:43], v3 offset:37888
    v_mul_f32 v91, v91, v20
    v_mfma_f32_16x16x32_bf16 v[116:119], a[20:23], a[4:7], v[116:119]
    ds_read_b128 a[44:47], v3 offset:39936
    v_mul_f32 v92, v92, v22
    v_mfma_f32_16x16x32_bf16 v[120:123], a[20:23], a[8:11], v[120:123]
    ds_read_b64_tr_b16 a[52:53], v5 offset:40960
    v_mul_f32 v93, v93, v22
    v_mfma_f32_16x16x32_bf16 v[124:127], a[20:23], a[12:15], v[124:127]
    ds_read_b64_tr_b16 a[54:55], v5 offset:41984
    v_mul_f32 v94, v94, v22
    v_mfma_f32_16x16x32_bf16 v[128:131], a[24:27], a[0:3], v[128:131]
    ds_read_b64_tr_b16 a[56:57], v6 offset:40960
    v_mul_f32 v95, v95, v22
    v_mfma_f32_16x16x32_bf16 v[132:135], a[24:27], a[4:7], v[132:135]
    ds_read_b64_tr_b16 a[58:59], v6 offset:41984
    v_mfma_f32_16x16x32_bf16 v[136:139], a[24:27], a[8:11], v[136:139]
    ds_read_b64_tr_b16 a[60:61], v7 offset:40960
    v_mfma_f32_16x16x32_bf16 v[140:143], a[24:27], a[12:15], v[140:143]
    ds_read_b64_tr_b16 a[62:63], v7 offset:41984
    v_mfma_f32_16x16x32_bf16 v[144:147], a[28:31], a[0:3], v[144:147]
    v_mfma_f32_16x16x32_bf16 v[148:151], a[28:31], a[4:7], v[148:151]
    v_mfma_f32_16x16x32_bf16 v[152:155], a[28:31], a[8:11], v[152:155]
    v_mfma_f32_16x16x32_bf16 v[156:159], a[28:31], a[12:15], v[156:159]
    s_waitcnt lgkmcnt(0)
    s_barrier
    v_mfma_f32_16x16x32_bf16 v[96:99], a[48:51], a[32:35], v[96:99]
    ds_read_b128 a[0:3], v2 offset:49152
    v_mfma_f32_16x16x32_bf16 v[100:103], a[48:51], a[36:39], v[100:103]
    ds_read_b64_tr_b16 a[16:17], v4 offset:49152
    v_mfma_f32_16x16x32_bf16 v[104:107], a[48:51], a[40:43], v[104:107]
    ds_read_b64_tr_b16 a[18:19], v4 offset:50176
    v_mfma_f32_16x16x32_bf16 v[108:111], a[48:51], a[44:47], v[108:111]
    ds_read_b128 a[4:7], v2 offset:51200
    v_mfma_f32_16x16x32_bf16 v[112:115], a[52:55], a[32:35], v[112:115]
    ds_read_b128 a[8:11], v3 offset:53248
    v_mfma_f32_16x16x32_bf16 v[116:119], a[52:55], a[36:39], v[116:119]
    ds_read_b128 a[12:15], v3 offset:55296
    v_mfma_f32_16x16x32_bf16 v[120:123], a[52:55], a[40:43], v[120:123]
    ds_read_b64_tr_b16 a[20:21], v5 offset:49152
    v_mfma_f32_16x16x32_bf16 v[124:127], a[52:55], a[44:47], v[124:127]
    ds_read_b64_tr_b16 a[22:23], v5 offset:50176
    v_mfma_f32_16x16x32_bf16 v[128:131], a[56:59], a[32:35], v[128:131]
    ds_read_b64_tr_b16 a[24:25], v6 offset:49152
    v_mfma_f32_16x16x32_bf16 v[132:135], a[56:59], a[36:39], v[132:135]
    ds_read_b64_tr_b16 a[26:27], v6 offset:50176
    v_mfma_f32_16x16x32_bf16 v[136:139], a[56:59], a[40:43], v[136:139]
    ds_read_b64_tr_b16 a[28:29], v7 offset:49152
    v_mfma_f32_16x16x32_bf16 v[140:143], a[56:59], a[44:47], v[140:143]
    ds_read_b64_tr_b16 a[30:31], v7 offset:50176
    v_mfma_f32_16x16x32_bf16 v[144:147], a[60:63], a[32:35], v[144:147]
    v_mfma_f32_16x16x32_bf16 v[148:151], a[60:63], a[36:39], v[148:151]
    v_mfma_f32_16x16x32_bf16 v[152:155], a[60:63], a[40:43], v[152:155]
    v_mfma_f32_16x16x32_bf16 v[156:159], a[60:63], a[44:47], v[156:159]
    s_waitcnt lgkmcnt(0)
    v_mfma_f32_16x16x32_bf16 v[96:99], a[16:19], a[0:3], v[96:99]
    ds_read_b128 a[32:35], v2 offset:50176
    v_mfma_f32_16x16x32_bf16 v[100:103], a[16:19], a[4:7], v[100:103]
    ds_read_b64_tr_b16 a[48:49], v4 offset:57344
    v_mfma_f32_16x16x32_bf16 v[104:107], a[16:19], a[8:11], v[104:107]
    ds_read_b64_tr_b16 a[50:51], v4 offset:58368
    v_mfma_f32_16x16x32_bf16 v[108:111], a[16:19], a[12:15], v[108:111]
    ds_read_b128 a[36:39], v2 offset:52224
    v_mfma_f32_16x16x32_bf16 v[112:115], a[20:23], a[0:3], v[112:115]
    ds_read_b128 a[40:43], v3 offset:54272
    v_mfma_f32_16x16x32_bf16 v[116:119], a[20:23], a[4:7], v[116:119]
    ds_read_b128 a[44:47], v3 offset:56320
    v_mfma_f32_16x16x32_bf16 v[120:123], a[20:23], a[8:11], v[120:123]
    ds_read_b64_tr_b16 a[52:53], v5 offset:57344
    v_mfma_f32_16x16x32_bf16 v[124:127], a[20:23], a[12:15], v[124:127]
    ds_read_b64_tr_b16 a[54:55], v5 offset:58368
    v_mfma_f32_16x16x32_bf16 v[128:131], a[24:27], a[0:3], v[128:131]
    ds_read_b64_tr_b16 a[56:57], v6 offset:57344
    v_mfma_f32_16x16x32_bf16 v[132:135], a[24:27], a[4:7], v[132:135]
    ds_read_b64_tr_b16 a[58:59], v6 offset:58368
    v_mfma_f32_16x16x32_bf16 v[136:139], a[24:27], a[8:11], v[136:139]
    ds_read_b64_tr_b16 a[60:61], v7 offset:57344
    v_mfma_f32_16x16x32_bf16 v[140:143], a[24:27], a[12:15], v[140:143]
    ds_read_b64_tr_b16 a[62:63], v7 offset:58368
    v_mfma_f32_16x16x32_bf16 v[144:147], a[28:31], a[0:3], v[144:147]
    v_mfma_f32_16x16x32_bf16 v[148:151], a[28:31], a[4:7], v[148:151]
    v_mfma_f32_16x16x32_bf16 v[152:155], a[28:31], a[8:11], v[152:155]
    v_mfma_f32_16x16x32_bf16 v[156:159], a[28:31], a[12:15], v[156:159]
    s_waitcnt lgkmcnt(0)
    s_barrier
    v_mfma_f32_16x16x32_bf16 v[96:99], a[48:51], a[32:35], v[96:99]
    ds_read_b128 a[0:3], v2 offset:0
    v_mfma_f32_16x16x32_bf16 v[100:103], a[48:51], a[36:39], v[100:103]
    ds_read_b64_tr_b16 a[16:17], v4 offset:0
    v_mfma_f32_16x16x32_bf16 v[104:107], a[48:51], a[40:43], v[104:107]
    ds_read_b64_tr_b16 a[18:19], v4 offset:1024
    v_mfma_f32_16x16x32_bf16 v[108:111], a[48:51], a[44:47], v[108:111]
    ds_read_b128 a[4:7], v2 offset:2048
    v_mfma_f32_16x16x32_bf16 v[112:115], a[52:55], a[32:35], v[112:115]
    ds_read_b128 a[8:11], v3 offset:4096
    v_mfma_f32_16x16x32_bf16 v[116:119], a[52:55], a[36:39], v[116:119]
    ds_read_b128 a[12:15], v3 offset:6144
    v_mfma_f32_16x16x32_bf16 v[120:123], a[52:55], a[40:43], v[120:123]
    ds_read_b64_tr_b16 a[20:21], v5 offset:0
    v_mfma_f32_16x16x32_bf16 v[124:127], a[52:55], a[44:47], v[124:127]
    ds_read_b64_tr_b16 a[22:23], v5 offset:1024
    v_mfma_f32_16x16x32_bf16 v[128:131], a[56:59], a[32:35], v[128:131]
    ds_read_b64_tr_b16 a[24:25], v6 offset:0
    v_mfma_f32_16x16x32_bf16 v[132:135], a[56:59], a[36:39], v[132:135]
    ds_read_b64_tr_b16 a[26:27], v6 offset:1024
    v_mfma_f32_16x16x32_bf16 v[136:139], a[56:59], a[40:43], v[136:139]
    ds_read_b64_tr_b16 a[28:29], v7 offset:0
    v_mfma_f32_16x16x32_bf16 v[140:143], a[56:59], a[44:47], v[140:143]
    ds_read_b64_tr_b16 a[30:31], v7 offset:1024
    v_mfma_f32_16x16x32_bf16 v[144:147], a[60:63], a[32:35], v[144:147]
    v_mfma_f32_16x16x32_bf16 v[148:151], a[60:63], a[36:39], v[148:151]
    v_mfma_f32_16x16x32_bf16 v[152:155], a[60:63], a[40:43], v[152:155]
    v_mfma_f32_16x16x32_bf16 v[156:159], a[60:63], a[44:47], v[156:159]
    s_waitcnt lgkmcnt(0)
    v_mfma_f32_16x16x32_bf16 v[96:99], a[16:19], a[0:3], v[96:99]
    ds_read_b128 a[32:35], v2 offset:1024
    v_mfma_f32_16x16x32_bf16 v[100:103], a[16:19], a[4:7], v[100:103]
    ds_read_b64_tr_b16 a[48:49], v4 offset:8192
    v_mfma_f32_16x16x32_bf16 v[104:107], a[16:19], a[8:11], v[104:107]
    ds_read_b64_tr_b16 a[50:51], v4 offset:9216
    v_mfma_f32_16x16x32_bf16 v[108:111], a[16:19], a[12:15], v[108:111]
    ds_read_b128 a[36:39], v2 offset:3072
    v_mfma_f32_16x16x32_bf16 v[112:115], a[20:23], a[0:3], v[112:115]
    ds_read_b128 a[40:43], v3 offset:5120
    v_mfma_f32_16x16x32_bf16 v[116:119], a[20:23], a[4:7], v[116:119]
    ds_read_b128 a[44:47], v3 offset:7168
    v_mfma_f32_16x16x32_bf16 v[120:123], a[20:23], a[8:11], v[120:123]
    ds_read_b64_tr_b16 a[52:53], v5 offset:8192
    v_mfma_f32_16x16x32_bf16 v[124:127], a[20:23], a[12:15], v[124:127]
    ds_read_b64_tr_b16 a[54:55], v5 offset:9216
    v_mfma_f32_16x16x32_bf16 v[128:131], a[24:27], a[0:3], v[128:131]
    ds_read_b64_tr_b16 a[56:57], v6 offset:8192
    v_mfma_f32_16x16x32_bf16 v[132:135], a[24:27], a[4:7], v[132:135]
    ds_read_b64_tr_b16 a[58:59], v6 offset:9216
    v_mfma_f32_16x16x32_bf16 v[136:139], a[24:27], a[8:11], v[136:139]
    ds_read_b64_tr_b16 a[60:61], v7 offset:8192
    v_mfma_f32_16x16x32_bf16 v[140:143], a[24:27], a[12:15], v[140:143]
    ds_read_b64_tr_b16 a[62:63], v7 offset:9216
    v_mfma_f32_16x16x32_bf16 v[144:147], a[28:31], a[0:3], v[144:147]
    v_mfma_f32_16x16x32_bf16 v[148:151], a[28:31], a[4:7], v[148:151]
    v_mfma_f32_16x16x32_bf16 v[152:155], a[28:31], a[8:11], v[152:155]
    v_mfma_f32_16x16x32_bf16 v[156:159], a[28:31], a[12:15], v[156:159]
    s_waitcnt lgkmcnt(0)
    s_barrier
    v_mfma_f32_16x16x32_bf16 v[96:99], a[48:51], a[32:35], v[96:99]
    ds_read_b128 a[0:3], v2 offset:16384
    v_mfma_f32_16x16x32_bf16 v[100:103], a[48:51], a[36:39], v[100:103]
    ds_read_b64_tr_b16 a[16:17], v4 offset:16384
    v_mfma_f32_16x16x32_bf16 v[104:107], a[48:51], a[40:43], v[104:107]
    ds_read_b64_tr_b16 a[18:19], v4 offset:17408
    v_mfma_f32_16x16x32_bf16 v[108:111], a[48:51], a[44:47], v[108:111]
    ds_read_b128 a[4:7], v2 offset:18432
    v_mfma_f32_16x16x32_bf16 v[112:115], a[52:55], a[32:35], v[112:115]
    ds_read_b128 a[8:11], v3 offset:20480
    v_mfma_f32_16x16x32_bf16 v[116:119], a[52:55], a[36:39], v[116:119]
    ds_read_b128 a[12:15], v3 offset:22528
    v_mfma_f32_16x16x32_bf16 v[120:123], a[52:55], a[40:43], v[120:123]
    ds_read_b64_tr_b16 a[20:21], v5 offset:16384
    v_mfma_f32_16x16x32_bf16 v[124:127], a[52:55], a[44:47], v[124:127]
    ds_read_b64_tr_b16 a[22:23], v5 offset:17408
    v_mfma_f32_16x16x32_bf16 v[128:131], a[56:59], a[32:35], v[128:131]
    ds_read_b64_tr_b16 a[24:25], v6 offset:16384
    v_mfma_f32_16x16x32_bf16 v[132:135], a[56:59], a[36:39], v[132:135]
    ds_read_b64_tr_b16 a[26:27], v6 offset:17408
    v_mfma_f32_16x16x32_bf16 v[136:139], a[56:59], a[40:43], v[136:139]
    ds_read_b64_tr_b16 a[28:29], v7 offset:16384
    v_mfma_f32_16x16x32_bf16 v[140:143], a[56:59], a[44:47], v[140:143]
    ds_read_b64_tr_b16 a[30:31], v7 offset:17408
    v_mfma_f32_16x16x32_bf16 v[144:147], a[60:63], a[32:35], v[144:147]
    v_mfma_f32_16x16x32_bf16 v[148:151], a[60:63], a[36:39], v[148:151]
    v_mfma_f32_16x16x32_bf16 v[152:155], a[60:63], a[40:43], v[152:155]
    v_mfma_f32_16x16x32_bf16 v[156:159], a[60:63], a[44:47], v[156:159]
    s_waitcnt lgkmcnt(0)
    v_mfma_f32_16x16x32_bf16 v[96:99], a[16:19], a[0:3], v[96:99]
    ds_read_b128 a[32:35], v2 offset:17408
    v_mfma_f32_16x16x32_bf16 v[100:103], a[16:19], a[4:7], v[100:103]
    ds_read_b64_tr_b16 a[48:49], v4 offset:24576
    v_mfma_f32_16x16x32_bf16 v[104:107], a[16:19], a[8:11], v[104:107]
    ds_read_b64_tr_b16 a[50:51], v4 offset:25600
    v_mfma_f32_16x16x32_bf16 v[108:111], a[16:19], a[12:15], v[108:111]
    ds_read_b128 a[36:39], v2 offset:19456
    v_mfma_f32_16x16x32_bf16 v[112:115], a[20:23], a[0:3], v[112:115]
    ds_read_b128 a[40:43], v3 offset:21504
    v_mfma_f32_16x16x32_bf16 v[116:119], a[20:23], a[4:7], v[116:119]
    ds_read_b128 a[44:47], v3 offset:23552
    v_mfma_f32_16x16x32_bf16 v[120:123], a[20:23], a[8:11], v[120:123]
    ds_read_b64_tr_b16 a[52:53], v5 offset:24576
    v_mfma_f32_16x16x32_bf16 v[124:127], a[20:23], a[12:15], v[124:127]
    ds_read_b64_tr_b16 a[54:55], v5 offset:25600
    v_mfma_f32_16x16x32_bf16 v[128:131], a[24:27], a[0:3], v[128:131]
    ds_read_b64_tr_b16 a[56:57], v6 offset:24576
    v_mfma_f32_16x16x32_bf16 v[132:135], a[24:27], a[4:7], v[132:135]
    ds_read_b64_tr_b16 a[58:59], v6 offset:25600
    v_mfma_f32_16x16x32_bf16 v[136:139], a[24:27], a[8:11], v[136:139]
    ds_read_b64_tr_b16 a[60:61], v7 offset:24576
    v_mfma_f32_16x16x32_bf16 v[140:143], a[24:27], a[12:15], v[140:143]
    ds_read_b64_tr_b16 a[62:63], v7 offset:25600
    v_mfma_f32_16x16x32_bf16 v[144:147], a[28:31], a[0:3], v[144:147]
    v_mfma_f32_16x16x32_bf16 v[148:151], a[28:31], a[4:7], v[148:151]
    v_mfma_f32_16x16x32_bf16 v[152:155], a[28:31], a[8:11], v[152:155]
    v_mfma_f32_16x16x32_bf16 v[156:159], a[28:31], a[12:15], v[156:159]
    s_waitcnt lgkmcnt(0)
    s_barrier
    v_mfma_f32_16x16x32_bf16 v[96:99], a[48:51], a[32:35], v[96:99]
    ds_read_b128 a[0:3], v2 offset:32768
    v_mfma_f32_16x16x32_bf16 v[100:103], a[48:51], a[36:39], v[100:103]
    ds_read_b64_tr_b16 a[16:17], v4 offset:32768
    v_mfma_f32_16x16x32_bf16 v[104:107], a[48:51], a[40:43], v[104:107]
    ds_read_b64_tr_b16 a[18:19], v4 offset:33792
    v_mfma_f32_16x16x32_bf16 v[108:111], a[48:51], a[44:47], v[108:111]
    ds_read_b128 a[4:7], v2 offset:34816
    v_mfma_f32_16x16x32_bf16 v[112:115], a[52:55], a[32:35], v[112:115]
    ds_read_b128 a[8:11], v3 offset:36864
    v_mfma_f32_16x16x32_bf16 v[116:119], a[52:55], a[36:39], v[116:119]
    ds_read_b128 a[12:15], v3 offset:38912
    v_mfma_f32_16x16x32_bf16 v[120:123], a[52:55], a[40:43], v[120:123]
    ds_read_b64_tr_b16 a[20:21], v5 offset:32768
    v_mfma_f32_16x16x32_bf16 v[124:127], a[52:55], a[44:47], v[124:127]
    ds_read_b64_tr_b16 a[22:23], v5 offset:33792
    v_mfma_f32_16x16x32_bf16 v[128:131], a[56:59], a[32:35], v[128:131]
    ds_read_b64_tr_b16 a[24:25], v6 offset:32768
    v_mfma_f32_16x16x32_bf16 v[132:135], a[56:59], a[36:39], v[132:135]
    ds_read_b64_tr_b16 a[26:27], v6 offset:33792
    v_mfma_f32_16x16x32_bf16 v[136:139], a[56:59], a[40:43], v[136:139]
    ds_read_b64_tr_b16 a[28:29], v7 offset:32768
    v_mfma_f32_16x16x32_bf16 v[140:143], a[56:59], a[44:47], v[140:143]
    ds_read_b64_tr_b16 a[30:31], v7 offset:33792
    v_mfma_f32_16x16x32_bf16 v[144:147], a[60:63], a[32:35], v[144:147]
    v_mfma_f32_16x16x32_bf16 v[148:151], a[60:63], a[36:39], v[148:151]
    v_mfma_f32_16x16x32_bf16 v[152:155], a[60:63], a[40:43], v[152:155]
    v_mfma_f32_16x16x32_bf16 v[156:159], a[60:63], a[44:47], v[156:159]
    s_waitcnt lgkmcnt(0)
    v_mfma_f32_16x16x32_bf16 v[96:99], a[16:19], a[0:3], v[96:99]
    ds_read_b128 a[32:35], v2 offset:33792
    v_mfma_f32_16x16x32_bf16 v[100:103], a[16:19], a[4:7], v[100:103]
    ds_read_b64_tr_b16 a[48:49], v4 offset:40960
    v_mfma_f32_16x16x32_bf16 v[104:107], a[16:19], a[8:11], v[104:107]
    ds_read_b64_tr_b16 a[50:51], v4 offset:41984
    v_mfma_f32_16x16x32_bf16 v[108:111], a[16:19], a[12:15], v[108:111]
    ds_read_b128 a[36:39], v2 offset:35840
    v_mfma_f32_16x16x32_bf16 v[112:115], a[20:23], a[0:3], v[112:115]
    ds_read_b128 a[40:43], v3 offset:37888
    v_mfma_f32_16x16x32_bf16 v[116:119], a[20:23], a[4:7], v[116:119]
    ds_read_b128 a[44:47], v3 offset:39936
    v_mfma_f32_16x16x32_bf16 v[120:123], a[20:23], a[8:11], v[120:123]
    ds_read_b64_tr_b16 a[52:53], v5 offset:40960
    v_mfma_f32_16x16x32_bf16 v[124:127], a[20:23], a[12:15], v[124:127]
    ds_read_b64_tr_b16 a[54:55], v5 offset:41984
    v_mfma_f32_16x16x32_bf16 v[128:131], a[24:27], a[0:3], v[128:131]
    ds_read_b64_tr_b16 a[56:57], v6 offset:40960
    v_mfma_f32_16x16x32_bf16 v[132:135], a[24:27], a[4:7], v[132:135]
    ds_read_b64_tr_b16 a[58:59], v6 offset:41984
    v_mfma_f32_16x16x32_bf16 v[136:139], a[24:27], a[8:11], v[136:139]
    ds_read_b64_tr_b16 a[60:61], v7 offset:40960
    v_mfma_f32_16x16x32_bf16 v[140:143], a[24:27], a[12:15], v[140:143]
    ds_read_b64_tr_b16 a[62:63], v7 offset:41984
    v_mfma_f32_16x16x32_bf16 v[144:147], a[28:31], a[0:3], v[144:147]
    v_mfma_f32_16x16x32_bf16 v[148:151], a[28:31], a[4:7], v[148:151]
    v_mfma_f32_16x16x32_bf16 v[152:155], a[28:31], a[8:11], v[152:155]
    v_mfma_f32_16x16x32_bf16 v[156:159], a[28:31], a[12:15], v[156:159]
    s_waitcnt lgkmcnt(0)
    s_barrier
    v_mfma_f32_16x16x32_bf16 v[96:99], a[48:51], a[32:35], v[96:99]
    ds_read_b128 a[0:3], v2 offset:49152
    v_mfma_f32_16x16x32_bf16 v[100:103], a[48:51], a[36:39], v[100:103]
    ds_read_b64_tr_b16 a[16:17], v4 offset:49152
    v_mfma_f32_16x16x32_bf16 v[104:107], a[48:51], a[40:43], v[104:107]
    ds_read_b64_tr_b16 a[18:19], v4 offset:50176
    v_mfma_f32_16x16x32_bf16 v[108:111], a[48:51], a[44:47], v[108:111]
    ds_read_b128 a[4:7], v2 offset:51200
    v_mfma_f32_16x16x32_bf16 v[112:115], a[52:55], a[32:35], v[112:115]
    ds_read_b128 a[8:11], v3 offset:53248
    v_mfma_f32_16x16x32_bf16 v[116:119], a[52:55], a[36:39], v[116:119]
    ds_read_b128 a[12:15], v3 offset:55296
    v_mfma_f32_16x16x32_bf16 v[120:123], a[52:55], a[40:43], v[120:123]
    ds_read_b64_tr_b16 a[20:21], v5 offset:49152
    v_mfma_f32_16x16x32_bf16 v[124:127], a[52:55], a[44:47], v[124:127]
    ds_read_b64_tr_b16 a[22:23], v5 offset:50176
    v_mfma_f32_16x16x32_bf16 v[128:131], a[56:59], a[32:35], v[128:131]
    ds_read_b64_tr_b16 a[24:25], v6 offset:49152
    v_mfma_f32_16x16x32_bf16 v[132:135], a[56:59], a[36:39], v[132:135]
    ds_read_b64_tr_b16 a[26:27], v6 offset:50176
    v_mfma_f32_16x16x32_bf16 v[136:139], a[56:59], a[40:43], v[136:139]
    ds_read_b64_tr_b16 a[28:29], v7 offset:49152
    v_mfma_f32_16x16x32_bf16 v[140:143], a[56:59], a[44:47], v[140:143]
    ds_read_b64_tr_b16 a[30:31], v7 offset:50176
    v_mfma_f32_16x16x32_bf16 v[144:147], a[60:63], a[32:35], v[144:147]
    v_mfma_f32_16x16x32_bf16 v[148:151], a[60:63], a[36:39], v[148:151]
    v_mfma_f32_16x16x32_bf16 v[152:155], a[60:63], a[40:43], v[152:155]
    v_mfma_f32_16x16x32_bf16 v[156:159], a[60:63], a[44:47], v[156:159]
    s_waitcnt lgkmcnt(0)
    v_mfma_f32_16x16x32_bf16 v[96:99], a[16:19], a[0:3], v[96:99]
    ds_read_b128 a[32:35], v2 offset:50176
    v_mfma_f32_16x16x32_bf16 v[100:103], a[16:19], a[4:7], v[100:103]
    ds_read_b64_tr_b16 a[48:49], v4 offset:57344
    v_mfma_f32_16x16x32_bf16 v[104:107], a[16:19], a[8:11], v[104:107]
    ds_read_b64_tr_b16 a[50:51], v4 offset:58368
    v_mfma_f32_16x16x32_bf16 v[108:111], a[16:19], a[12:15], v[108:111]
    ds_read_b128 a[36:39], v2 offset:52224
    v_mfma_f32_16x16x32_bf16 v[112:115], a[20:23], a[0:3], v[112:115]
    ds_read_b128 a[40:43], v3 offset:54272
    v_mfma_f32_16x16x32_bf16 v[116:119], a[20:23], a[4:7], v[116:119]
    ds_read_b128 a[44:47], v3 offset:56320
    v_mfma_f32_16x16x32_bf16 v[120:123], a[20:23], a[8:11], v[120:123]
    ds_read_b64_tr_b16 a[52:53], v5 offset:57344
    v_mfma_f32_16x16x32_bf16 v[124:127], a[20:23], a[12:15], v[124:127]
    ds_read_b64_tr_b16 a[54:55], v5 offset:58368
    v_mfma_f32_16x16x32_bf16 v[128:131], a[24:27], a[0:3], v[128:131]
    ds_read_b64_tr_b16 a[56:57], v6 offset:57344
    v_mfma_f32_16x16x32_bf16 v[132:135], a[24:27], a[4:7], v[132:135]
    ds_read_b64_tr_b16 a[58:59], v6 offset:58368
    v_mfma_f32_16x16x32_bf16 v[136:139], a[24:27], a[8:11], v[136:139]
    ds_read_b64_tr_b16 a[60:61], v7 offset:57344
    v_mfma_f32_16x16x32_bf16 v[140:143], a[24:27], a[12:15], v[140:143]
    ds_read_b64_tr_b16 a[62:63], v7 offset:58368
    v_mfma_f32_16x16x32_bf16 v[144:147], a[28:31], a[0:3], v[144:147]
    v_mfma_f32_16x16x32_bf16 v[148:151], a[28:31], a[4:7], v[148:151]
    v_mfma_f32_16x16x32_bf16 v[152:155], a[28:31], a[8:11], v[152:155]
    v_mfma_f32_16x16x32_bf16 v[156:159], a[28:31], a[12:15], v[156:159]
    s_waitcnt lgkmcnt(0)
    s_barrier
    v_mfma_f32_16x16x32_bf16 v[96:99], a[48:51], a[32:35], v[96:99]
    ds_read_b128 a[0:3], v2 offset:0
    v_mfma_f32_16x16x32_bf16 v[100:103], a[48:51], a[36:39], v[100:103]
    ds_read_b64_tr_b16 a[16:17], v4 offset:0
    v_mfma_f32_16x16x32_bf16 v[104:107], a[48:51], a[40:43], v[104:107]
    ds_read_b64_tr_b16 a[18:19], v4 offset:1024
    v_mfma_f32_16x16x32_bf16 v[108:111], a[48:51], a[44:47], v[108:111]
    ds_read_b128 a[4:7], v2 offset:2048
    v_mfma_f32_16x16x32_bf16 v[112:115], a[52:55], a[32:35], v[112:115]
    ds_read_b64_tr_b16 a[20:21], v5 offset:0
    v_mfma_f32_16x16x32_bf16 v[116:119], a[52:55], a[36:39], v[116:119]
    ds_read_b64_tr_b16 a[22:23], v5 offset:1024
    v_mfma_f32_16x16x32_bf16 v[120:123], a[52:55], a[40:43], v[120:123]
    ds_read_b64_tr_b16 a[24:25], v6 offset:0
    v_mfma_f32_16x16x32_bf16 v[124:127], a[52:55], a[44:47], v[124:127]
    ds_read_b64_tr_b16 a[26:27], v6 offset:1024
    v_mfma_f32_16x16x32_bf16 v[128:131], a[56:59], a[32:35], v[128:131]
    ds_read_b64_tr_b16 a[28:29], v7 offset:0
    v_mfma_f32_16x16x32_bf16 v[132:135], a[56:59], a[36:39], v[132:135]
    ds_read_b64_tr_b16 a[30:31], v7 offset:1024
    v_mfma_f32_16x16x32_bf16 v[136:139], a[56:59], a[40:43], v[136:139]
    v_mfma_f32_16x16x32_bf16 v[140:143], a[56:59], a[44:47], v[140:143]
    v_mfma_f32_16x16x32_bf16 v[144:147], a[60:63], a[32:35], v[144:147]
    v_mfma_f32_16x16x32_bf16 v[148:151], a[60:63], a[36:39], v[148:151]
    v_mfma_f32_16x16x32_bf16 v[152:155], a[60:63], a[40:43], v[152:155]
    v_mfma_f32_16x16x32_bf16 v[156:159], a[60:63], a[44:47], v[156:159]
    v_pk_fma_f32 v[40:41], v[104:105], v[28:29], v[40:41] op_sel_hi:[1,0,1]
    v_pk_fma_f32 v[42:43], v[106:107], v[28:29], v[42:43] op_sel_hi:[1,0,1]
    v_pk_fma_f32 v[56:57], v[120:121], v[28:29], v[56:57] op_sel_hi:[1,0,1]
    v_pk_fma_f32 v[58:59], v[122:123], v[28:29], v[58:59] op_sel_hi:[1,0,1]
    v_pk_fma_f32 v[72:73], v[136:137], v[28:29], v[72:73] op_sel_hi:[1,0,1]
    v_pk_fma_f32 v[74:75], v[138:139], v[28:29], v[74:75] op_sel_hi:[1,0,1]
    s_nop 0
    v_pk_fma_f32 v[88:89], v[152:153], v[28:29], v[88:89] op_sel_hi:[1,0,1]
    v_pk_fma_f32 v[90:91], v[154:155], v[28:29], v[90:91] op_sel_hi:[1,0,1]
    v_cvt_pk_bf16_f32 v160, v40, v41
    v_cvt_pk_bf16_f32 v161, v42, v43
    v_cvt_pk_bf16_f32 v162, v56, v57
    v_cvt_pk_bf16_f32 v163, v58, v59
    v_cvt_pk_bf16_f32 v164, v72, v73
    v_cvt_pk_bf16_f32 v165, v74, v75
    v_cvt_pk_bf16_f32 v166, v88, v89
    v_cvt_pk_bf16_f32 v167, v90, v91
    buffer_store_dwordx4 v[160:163], v13, s[20:23], s60 offen offset:0 sc1
    buffer_store_dwordx4 v[164:167], v13, s[20:23], s60 offen offset:1024 sc1
    v_pk_fma_f32 v[44:45], v[108:109], v[30:31], v[44:45] op_sel_hi:[1,0,1]
    v_pk_fma_f32 v[46:47], v[110:111], v[30:31], v[46:47] op_sel_hi:[1,0,1]
    v_pk_fma_f32 v[60:61], v[124:125], v[30:31], v[60:61] op_sel_hi:[1,0,1]
    v_pk_fma_f32 v[62:63], v[126:127], v[30:31], v[62:63] op_sel_hi:[1,0,1]
    v_pk_fma_f32 v[76:77], v[140:141], v[30:31], v[76:77] op_sel_hi:[1,0,1]
    v_pk_fma_f32 v[78:79], v[142:143], v[30:31], v[78:79] op_sel_hi:[1,0,1]
    v_pk_fma_f32 v[92:93], v[156:157], v[30:31], v[92:93] op_sel_hi:[1,0,1]
    v_pk_fma_f32 v[94:95], v[158:159], v[30:31], v[94:95] op_sel_hi:[1,0,1]
    v_cvt_pk_bf16_f32 v168, v44, v45
    v_cvt_pk_bf16_f32 v169, v46, v47
    v_cvt_pk_bf16_f32 v170, v60, v61
    v_cvt_pk_bf16_f32 v171, v62, v63
    v_cvt_pk_bf16_f32 v172, v76, v77
    v_cvt_pk_bf16_f32 v173, v78, v79
    v_cvt_pk_bf16_f32 v174, v92, v93
    v_cvt_pk_bf16_f32 v175, v94, v95
    buffer_store_dwordx4 v[168:171], v13, s[20:23], s60 offen offset:2048 sc1
    buffer_store_dwordx4 v[172:175], v13, s[20:23], s60 offen offset:3072 sc1
    v_pk_fma_f32 v[32:33], v[96:97], v[24:25], v[32:33] op_sel_hi:[1,0,1]
    v_pk_fma_f32 v[34:35], v[98:99], v[24:25], v[34:35] op_sel_hi:[1,0,1]
    v_pk_fma_f32 v[48:49], v[112:113], v[24:25], v[48:49] op_sel_hi:[1,0,1]
    v_pk_fma_f32 v[50:51], v[114:115], v[24:25], v[50:51] op_sel_hi:[1,0,1]
    v_pk_fma_f32 v[64:65], v[128:129], v[24:25], v[64:65] op_sel_hi:[1,0,1]
    v_pk_fma_f32 v[66:67], v[130:131], v[24:25], v[66:67] op_sel_hi:[1,0,1]
    v_pk_fma_f32 v[80:81], v[144:145], v[24:25], v[80:81] op_sel_hi:[1,0,1]
    v_pk_fma_f32 v[82:83], v[146:147], v[24:25], v[82:83] op_sel_hi:[1,0,1]
    v_pk_fma_f32 v[36:37], v[100:101], v[26:27], v[36:37] op_sel_hi:[1,0,1]
    v_pk_fma_f32 v[38:39], v[102:103], v[26:27], v[38:39] op_sel_hi:[1,0,1]
    v_pk_fma_f32 v[52:53], v[116:117], v[26:27], v[52:53] op_sel_hi:[1,0,1]
    v_pk_fma_f32 v[54:55], v[118:119], v[26:27], v[54:55] op_sel_hi:[1,0,1]
    v_pk_fma_f32 v[68:69], v[132:133], v[26:27], v[68:69] op_sel_hi:[1,0,1]
    v_pk_fma_f32 v[70:71], v[134:135], v[26:27], v[70:71] op_sel_hi:[1,0,1]
    v_pk_fma_f32 v[84:85], v[148:149], v[26:27], v[84:85] op_sel_hi:[1,0,1]
    v_pk_fma_f32 v[86:87], v[150:151], v[26:27], v[86:87] op_sel_hi:[1,0,1]
    s_waitcnt lgkmcnt(0)
    v_mfma_f32_16x16x32_bf16 v[96:99], a[16:19], a[0:3], 0
    ds_read_b128 a[32:35], v2 offset:1024
    ds_read_b64_tr_b16 a[48:49], v4 offset:8192
    v_mfma_f32_16x16x32_bf16 v[100:103], a[16:19], a[4:7], 0
    ds_read_b64_tr_b16 a[50:51], v4 offset:9216
    ds_read_b128 a[36:39], v2 offset:3072
    v_mfma_f32_16x16x32_bf16 v[112:115], a[20:23], a[0:3], 0
    ds_read_b64_tr_b16 a[52:53], v5 offset:8192
    v_mfma_f32_16x16x32_bf16 v[116:119], a[20:23], a[4:7], 0
    ds_read_b64_tr_b16 a[54:55], v5 offset:9216
    v_mfma_f32_16x16x32_bf16 v[128:131], a[24:27], a[0:3], 0
    ds_read_b64_tr_b16 a[56:57], v6 offset:8192
    v_mfma_f32_16x16x32_bf16 v[132:135], a[24:27], a[4:7], 0
    ds_read_b64_tr_b16 a[58:59], v6 offset:9216
    v_mfma_f32_16x16x32_bf16 v[144:147], a[28:31], a[0:3], 0
    ds_read_b64_tr_b16 a[60:61], v7 offset:8192
    v_mfma_f32_16x16x32_bf16 v[148:151], a[28:31], a[4:7], 0
    ds_read_b64_tr_b16 a[62:63], v7 offset:9216
    s_waitcnt lgkmcnt(0)
    s_barrier
    v_mfma_f32_16x16x32_bf16 v[96:99], a[48:51], a[32:35], v[96:99]
    ds_read_b128 a[0:3], v2 offset:16384
    ds_read_b64_tr_b16 a[16:17], v4 offset:16384
    v_mfma_f32_16x16x32_bf16 v[100:103], a[48:51], a[36:39], v[100:103]
    ds_read_b64_tr_b16 a[18:19], v4 offset:17408
    ds_read_b128 a[4:7], v2 offset:18432
    v_mfma_f32_16x16x32_bf16 v[112:115], a[52:55], a[32:35], v[112:115]
    ds_read_b64_tr_b16 a[20:21], v5 offset:16384
    v_mfma_f32_16x16x32_bf16 v[116:119], a[52:55], a[36:39], v[116:119]
    ds_read_b64_tr_b16 a[22:23], v5 offset:17408
    v_mfma_f32_16x16x32_bf16 v[128:131], a[56:59], a[32:35], v[128:131]
    ds_read_b64_tr_b16 a[24:25], v6 offset:16384
    v_mfma_f32_16x16x32_bf16 v[132:135], a[56:59], a[36:39], v[132:135]
    ds_read_b64_tr_b16 a[26:27], v6 offset:17408
    v_mfma_f32_16x16x32_bf16 v[144:147], a[60:63], a[32:35], v[144:147]
    ds_read_b64_tr_b16 a[28:29], v7 offset:16384
    v_mfma_f32_16x16x32_bf16 v[148:151], a[60:63], a[36:39], v[148:151]
    ds_read_b64_tr_b16 a[30:31], v7 offset:17408
    s_waitcnt lgkmcnt(0)
    v_mfma_f32_16x16x32_bf16 v[96:99], a[16:19], a[0:3], v[96:99]
    ds_read_b128 a[32:35], v2 offset:17408
    ds_read_b64_tr_b16 a[48:49], v4 offset:24576
    v_mfma_f32_16x16x32_bf16 v[100:103], a[16:19], a[4:7], v[100:103]
    ds_read_b64_tr_b16 a[50:51], v4 offset:25600
    ds_read_b128 a[36:39], v2 offset:19456
    v_mfma_f32_16x16x32_bf16 v[112:115], a[20:23], a[0:3], v[112:115]
    ds_read_b64_tr_b16 a[52:53], v5 offset:24576
    v_mfma_f32_16x16x32_bf16 v[116:119], a[20:23], a[4:7], v[116:119]
    ds_read_b64_tr_b16 a[54:55], v5 offset:25600
    v_mfma_f32_16x16x32_bf16 v[128:131], a[24:27], a[0:3], v[128:131]
    ds_read_b64_tr_b16 a[56:57], v6 offset:24576
    v_mfma_f32_16x16x32_bf16 v[132:135], a[24:27], a[4:7], v[132:135]
    ds_read_b64_tr_b16 a[58:59], v6 offset:25600
    v_mfma_f32_16x16x32_bf16 v[144:147], a[28:31], a[0:3], v[144:147]
    ds_read_b64_tr_b16 a[60:61], v7 offset:24576
    v_mfma_f32_16x16x32_bf16 v[148:151], a[28:31], a[4:7], v[148:151]
    ds_read_b64_tr_b16 a[62:63], v7 offset:25600
    s_waitcnt vmcnt(0)
    v_mov_b32 v19, s55
    v_mov_b32 v21, 1
    s_mov_b64 exec, 1
    buffer_store_dword v21, v19, s[20:23], 0 offen sc1
    s_mov_b64 exec, -1
    s_waitcnt lgkmcnt(0)
    s_barrier
    v_mfma_f32_16x16x32_bf16 v[96:99], a[48:51], a[32:35], v[96:99]
    ds_read_b128 a[0:3], v2 offset:32768
    ds_read_b64_tr_b16 a[16:17], v4 offset:32768
    v_mfma_f32_16x16x32_bf16 v[100:103], a[48:51], a[36:39], v[100:103]
    ds_read_b64_tr_b16 a[18:19], v4 offset:33792
    ds_read_b128 a[4:7], v2 offset:34816
    v_mfma_f32_16x16x32_bf16 v[112:115], a[52:55], a[32:35], v[112:115]
    ds_read_b64_tr_b16 a[20:21], v5 offset:32768
    v_mfma_f32_16x16x32_bf16 v[116:119], a[52:55], a[36:39], v[116:119]
    ds_read_b64_tr_b16 a[22:23], v5 offset:33792
    v_mfma_f32_16x16x32_bf16 v[128:131], a[56:59], a[32:35], v[128:131]
    ds_read_b64_tr_b16 a[24:25], v6 offset:32768
    v_mfma_f32_16x16x32_bf16 v[132:135], a[56:59], a[36:39], v[132:135]
    ds_read_b64_tr_b16 a[26:27], v6 offset:33792
    v_mfma_f32_16x16x32_bf16 v[144:147], a[60:63], a[32:35], v[144:147]
    ds_read_b64_tr_b16 a[28:29], v7 offset:32768
    v_mfma_f32_16x16x32_bf16 v[148:151], a[60:63], a[36:39], v[148:151]
    ds_read_b64_tr_b16 a[30:31], v7 offset:33792
    s_waitcnt lgkmcnt(0)
    v_mfma_f32_16x16x32_bf16 v[96:99], a[16:19], a[0:3], v[96:99]
    ds_read_b128 a[32:35], v2 offset:33792
    ds_read_b64_tr_b16 a[48:49], v4 offset:40960
    v_mfma_f32_16x16x32_bf16 v[100:103], a[16:19], a[4:7], v[100:103]
    ds_read_b64_tr_b16 a[50:51], v4 offset:41984
    ds_read_b128 a[36:39], v2 offset:35840
    v_mfma_f32_16x16x32_bf16 v[112:115], a[20:23], a[0:3], v[112:115]
    ds_read_b64_tr_b16 a[52:53], v5 offset:40960
    v_mfma_f32_16x16x32_bf16 v[116:119], a[20:23], a[4:7], v[116:119]
    ds_read_b64_tr_b16 a[54:55], v5 offset:41984
    v_mfma_f32_16x16x32_bf16 v[128:131], a[24:27], a[0:3], v[128:131]
    ds_read_b64_tr_b16 a[56:57], v6 offset:40960
    v_mfma_f32_16x16x32_bf16 v[132:135], a[24:27], a[4:7], v[132:135]
    ds_read_b64_tr_b16 a[58:59], v6 offset:41984
    v_mfma_f32_16x16x32_bf16 v[144:147], a[28:31], a[0:3], v[144:147]
    ds_read_b64_tr_b16 a[60:61], v7 offset:40960
    v_mfma_f32_16x16x32_bf16 v[148:151], a[28:31], a[4:7], v[148:151]
    ds_read_b64_tr_b16 a[62:63], v7 offset:41984
    s_waitcnt lgkmcnt(0)
    s_barrier
    v_mfma_f32_16x16x32_bf16 v[96:99], a[48:51], a[32:35], v[96:99]
    ds_read_b128 a[0:3], v2 offset:49152
    ds_read_b64_tr_b16 a[16:17], v4 offset:49152
    v_mfma_f32_16x16x32_bf16 v[100:103], a[48:51], a[36:39], v[100:103]
    ds_read_b64_tr_b16 a[18:19], v4 offset:50176
    ds_read_b128 a[4:7], v2 offset:51200
    v_mfma_f32_16x16x32_bf16 v[112:115], a[52:55], a[32:35], v[112:115]
    ds_read_b64_tr_b16 a[20:21], v5 offset:49152
    v_mfma_f32_16x16x32_bf16 v[116:119], a[52:55], a[36:39], v[116:119]
    ds_read_b64_tr_b16 a[22:23], v5 offset:50176
    v_mfma_f32_16x16x32_bf16 v[128:131], a[56:59], a[32:35], v[128:131]
    ds_read_b64_tr_b16 a[24:25], v6 offset:49152
    v_mfma_f32_16x16x32_bf16 v[132:135], a[56:59], a[36:39], v[132:135]
    ds_read_b64_tr_b16 a[26:27], v6 offset:50176
    v_mfma_f32_16x16x32_bf16 v[144:147], a[60:63], a[32:35], v[144:147]
    ds_read_b64_tr_b16 a[28:29], v7 offset:49152
    v_mfma_f32_16x16x32_bf16 v[148:151], a[60:63], a[36:39], v[148:151]
    ds_read_b64_tr_b16 a[30:31], v7 offset:50176
    s_waitcnt lgkmcnt(0)
    v_mfma_f32_16x16x32_bf16 v[96:99], a[16:19], a[0:3], v[96:99]
    ds_read_b128 a[32:35], v2 offset:50176
    ds_read_b64_tr_b16 a[48:49], v4 offset:57344
    v_mfma_f32_16x16x32_bf16 v[100:103], a[16:19], a[4:7], v[100:103]
    ds_read_b64_tr_b16 a[50:51], v4 offset:58368
    ds_read_b128 a[36:39], v2 offset:52224
    v_mfma_f32_16x16x32_bf16 v[112:115], a[20:23], a[0:3], v[112:115]
    ds_read_b64_tr_b16 a[52:53], v5 offset:57344
    v_mfma_f32_16x16x32_bf16 v[116:119], a[20:23], a[4:7], v[116:119]
    ds_read_b64_tr_b16 a[54:55], v5 offset:58368
    v_mfma_f32_16x16x32_bf16 v[128:131], a[24:27], a[0:3], v[128:131]
    ds_read_b64_tr_b16 a[56:57], v6 offset:57344
    v_mfma_f32_16x16x32_bf16 v[132:135], a[24:27], a[4:7], v[132:135]
    ds_read_b64_tr_b16 a[58:59], v6 offset:58368
    v_mfma_f32_16x16x32_bf16 v[144:147], a[28:31], a[0:3], v[144:147]
    ds_read_b64_tr_b16 a[60:61], v7 offset:57344
    v_mfma_f32_16x16x32_bf16 v[148:151], a[28:31], a[4:7], v[148:151]
    ds_read_b64_tr_b16 a[62:63], v7 offset:58368
    s_waitcnt lgkmcnt(0)
    s_barrier
    v_mfma_f32_16x16x32_bf16 v[96:99], a[48:51], a[32:35], v[96:99]
    ds_read_b128 a[0:3], v2 offset:0
    ds_read_b64_tr_b16 a[16:17], v4 offset:0
    v_mfma_f32_16x16x32_bf16 v[100:103], a[48:51], a[36:39], v[100:103]
    ds_read_b64_tr_b16 a[18:19], v4 offset:1024
    ds_read_b128 a[4:7], v2 offset:2048
    v_mfma_f32_16x16x32_bf16 v[112:115], a[52:55], a[32:35], v[112:115]
    ds_read_b64_tr_b16 a[20:21], v5 offset:0
    v_mfma_f32_16x16x32_bf16 v[116:119], a[52:55], a[36:39], v[116:119]
    ds_read_b64_tr_b16 a[22:23], v5 offset:1024
    v_mfma_f32_16x16x32_bf16 v[128:131], a[56:59], a[32:35], v[128:131]
    ds_read_b64_tr_b16 a[24:25], v6 offset:0
    v_mfma_f32_16x16x32_bf16 v[132:135], a[56:59], a[36:39], v[132:135]
    ds_read_b64_tr_b16 a[26:27], v6 offset:1024
    v_mfma_f32_16x16x32_bf16 v[144:147], a[60:63], a[32:35], v[144:147]
    ds_read_b64_tr_b16 a[28:29], v7 offset:0
    v_mfma_f32_16x16x32_bf16 v[148:151], a[60:63], a[36:39], v[148:151]
    ds_read_b64_tr_b16 a[30:31], v7 offset:1024
    s_waitcnt lgkmcnt(0)
    v_mfma_f32_16x16x32_bf16 v[96:99], a[16:19], a[0:3], v[96:99]
    ds_read_b128 a[32:35], v2 offset:1024
    ds_read_b64_tr_b16 a[48:49], v4 offset:8192
    v_mfma_f32_16x16x32_bf16 v[100:103], a[16:19], a[4:7], v[100:103]
    ds_read_b64_tr_b16 a[50:51], v4 offset:9216
    ds_read_b128 a[36:39], v2 offset:3072
    v_mfma_f32_16x16x32_bf16 v[112:115], a[20:23], a[0:3], v[112:115]
    ds_read_b64_tr_b16 a[52:53], v5 offset:8192
    v_mfma_f32_16x16x32_bf16 v[116:119], a[20:23], a[4:7], v[116:119]
    ds_read_b64_tr_b16 a[54:55], v5 offset:9216
    v_mfma_f32_16x16x32_bf16 v[128:131], a[24:27], a[0:3], v[128:131]
    ds_read_b64_tr_b16 a[56:57], v6 offset:8192
    v_mfma_f32_16x16x32_bf16 v[132:135], a[24:27], a[4:7], v[132:135]
    ds_read_b64_tr_b16 a[58:59], v6 offset:9216
    v_mfma_f32_16x16x32_bf16 v[144:147], a[28:31], a[0:3], v[144:147]
    ds_read_b64_tr_b16 a[60:61], v7 offset:8192
    v_mfma_f32_16x16x32_bf16 v[148:151], a[28:31], a[4:7], v[148:151]
    ds_read_b64_tr_b16 a[62:63], v7 offset:9216
    buffer_load_dword v17, v15, s[20:23], s64 offen sc1
    s_waitcnt lgkmcnt(0)
    s_barrier
    v_mfma_f32_16x16x32_bf16 v[96:99], a[48:51], a[32:35], v[96:99]
    ds_read_b128 a[0:3], v2 offset:16384
    ds_read_b64_tr_b16 a[16:17], v4 offset:16384
    v_mfma_f32_16x16x32_bf16 v[100:103], a[48:51], a[36:39], v[100:103]
    ds_read_b64_tr_b16 a[18:19], v4 offset:17408
    ds_read_b128 a[4:7], v2 offset:18432
    v_mfma_f32_16x16x32_bf16 v[112:115], a[52:55], a[32:35], v[112:115]
    ds_read_b64_tr_b16 a[20:21], v5 offset:16384
    v_mfma_f32_16x16x32_bf16 v[116:119], a[52:55], a[36:39], v[116:119]
    ds_read_b64_tr_b16 a[22:23], v5 offset:17408
    v_mfma_f32_16x16x32_bf16 v[128:131], a[56:59], a[32:35], v[128:131]
    ds_read_b64_tr_b16 a[24:25], v6 offset:16384
    v_mfma_f32_16x16x32_bf16 v[132:135], a[56:59], a[36:39], v[132:135]
    ds_read_b64_tr_b16 a[26:27], v6 offset:17408
    v_mfma_f32_16x16x32_bf16 v[144:147], a[60:63], a[32:35], v[144:147]
    ds_read_b64_tr_b16 a[28:29], v7 offset:16384
    v_mfma_f32_16x16x32_bf16 v[148:151], a[60:63], a[36:39], v[148:151]
    ds_read_b64_tr_b16 a[30:31], v7 offset:17408
    s_waitcnt lgkmcnt(0)
    v_mfma_f32_16x16x32_bf16 v[96:99], a[16:19], a[0:3], v[96:99]
    ds_read_b128 a[32:35], v2 offset:17408
    ds_read_b64_tr_b16 a[48:49], v4 offset:24576
    v_mfma_f32_16x16x32_bf16 v[100:103], a[16:19], a[4:7], v[100:103]
    ds_read_b64_tr_b16 a[50:51], v4 offset:25600
    ds_read_b128 a[36:39], v2 offset:19456
    v_mfma_f32_16x16x32_bf16 v[112:115], a[20:23], a[0:3], v[112:115]
    ds_read_b64_tr_b16 a[52:53], v5 offset:24576
    v_mfma_f32_16x16x32_bf16 v[116:119], a[20:23], a[4:7], v[116:119]
    ds_read_b64_tr_b16 a[54:55], v5 offset:25600
    v_mfma_f32_16x16x32_bf16 v[128:131], a[24:27], a[0:3], v[128:131]
    ds_read_b64_tr_b16 a[56:57], v6 offset:24576
    v_mfma_f32_16x16x32_bf16 v[132:135], a[24:27], a[4:7], v[132:135]
    ds_read_b64_tr_b16 a[58:59], v6 offset:25600
    v_mfma_f32_16x16x32_bf16 v[144:147], a[28:31], a[0:3], v[144:147]
    ds_read_b64_tr_b16 a[60:61], v7 offset:24576
    v_mfma_f32_16x16x32_bf16 v[148:151], a[28:31], a[4:7], v[148:151]
    ds_read_b64_tr_b16 a[62:63], v7 offset:25600
    s_waitcnt lgkmcnt(0)
    s_barrier
    v_mfma_f32_16x16x32_bf16 v[96:99], a[48:51], a[32:35], v[96:99]
    ds_read_b128 a[0:3], v2 offset:32768
    ds_read_b64_tr_b16 a[16:17], v4 offset:32768
    v_mfma_f32_16x16x32_bf16 v[100:103], a[48:51], a[36:39], v[100:103]
    ds_read_b64_tr_b16 a[18:19], v4 offset:33792
    ds_read_b128 a[4:7], v2 offset:34816
    v_mfma_f32_16x16x32_bf16 v[112:115], a[52:55], a[32:35], v[112:115]
    ds_read_b64_tr_b16 a[20:21], v5 offset:32768
    v_mfma_f32_16x16x32_bf16 v[116:119], a[52:55], a[36:39], v[116:119]
    ds_read_b64_tr_b16 a[22:23], v5 offset:33792
    v_mfma_f32_16x16x32_bf16 v[128:131], a[56:59], a[32:35], v[128:131]
    ds_read_b64_tr_b16 a[24:25], v6 offset:32768
    v_mfma_f32_16x16x32_bf16 v[132:135], a[56:59], a[36:39], v[132:135]
    ds_read_b64_tr_b16 a[26:27], v6 offset:33792
    v_mfma_f32_16x16x32_bf16 v[144:147], a[60:63], a[32:35], v[144:147]
    ds_read_b64_tr_b16 a[28:29], v7 offset:32768
    v_mfma_f32_16x16x32_bf16 v[148:151], a[60:63], a[36:39], v[148:151]
    ds_read_b64_tr_b16 a[30:31], v7 offset:33792
    s_waitcnt lgkmcnt(0)
    v_mfma_f32_16x16x32_bf16 v[96:99], a[16:19], a[0:3], v[96:99]
    ds_read_b128 a[32:35], v2 offset:33792
    ds_read_b64_tr_b16 a[48:49], v4 offset:40960
    v_mfma_f32_16x16x32_bf16 v[100:103], a[16:19], a[4:7], v[100:103]
    ds_read_b64_tr_b16 a[50:51], v4 offset:41984
    ds_read_b128 a[36:39], v2 offset:35840
    v_mfma_f32_16x16x32_bf16 v[112:115], a[20:23], a[0:3], v[112:115]
    ds_read_b64_tr_b16 a[52:53], v5 offset:40960
    v_mfma_f32_16x16x32_bf16 v[116:119], a[20:23], a[4:7], v[116:119]
    ds_read_b64_tr_b16 a[54:55], v5 offset:41984
    v_mfma_f32_16x16x32_bf16 v[128:131], a[24:27], a[0:3], v[128:131]
    ds_read_b64_tr_b16 a[56:57], v6 offset:40960
    v_mfma_f32_16x16x32_bf16 v[132:135], a[24:27], a[4:7], v[132:135]
    ds_read_b64_tr_b16 a[58:59], v6 offset:41984
    v_mfma_f32_16x16x32_bf16 v[144:147], a[28:31], a[0:3], v[144:147]
    ds_read_b64_tr_b16 a[60:61], v7 offset:40960
    v_mfma_f32_16x16x32_bf16 v[148:151], a[28:31], a[4:7], v[148:151]
    ds_read_b64_tr_b16 a[62:63], v7 offset:41984
    s_waitcnt vmcnt(0)
    s_mov_b32 s37, 0x40000
L_xpoll:
    v_cmp_eq_u32 vcc, 1, v17
    s_nop 0
    s_cmp_eq_u64 vcc, -1
    s_cbranch_scc1 L_xpoll_ok
    s_sleep 2
    buffer_load_dword v17, v15, s[20:23], s64 offen sc1
    s_sub_u32 s37, s37, 1
    s_waitcnt vmcnt(0)
    s_cbranch_scc0 L_xpoll
L_xpoll_ok:
    buffer_load_dwordx4 v[176:179], v13, s[20:23], s62 offen offset:0 sc1
    buffer_load_dwordx4 v[180:183], v13, s[20:23], s62 offen offset:1024 sc1
    buffer_load_dwordx4 v[184:187], v13, s[20:23], s62 offen offset:2048 sc1
    buffer_load_dwordx4 v[188:191], v13, s[20:23], s62 offen offset:3072 sc1
    s_waitcnt lgkmcnt(0)
    s_barrier
    v_mfma_f32_16x16x32_bf16 v[96:99], a[48:51], a[32:35], v[96:99]
    ds_read_b128 a[0:3], v2 offset:49152
    ds_read_b64_tr_b16 a[16:17], v4 offset:49152
    v_mfma_f32_16x16x32_bf16 v[100:103], a[48:51], a[36:39], v[100:103]
    ds_read_b64_tr_b16 a[18:19], v4 offset:50176
    ds_read_b128 a[4:7], v2 offset:51200
    v_mfma_f32_16x16x32_bf16 v[112:115], a[52:55], a[32:35], v[112:115]
    ds_read_b64_tr_b16 a[20:21], v5 offset:49152
    v_mfma_f32_16x16x32_bf16 v[116:119], a[52:55], a[36:39], v[116:119]
    ds_read_b64_tr_b16 a[22:23], v5 offset:50176
    v_mfma_f32_16x16x32_bf16 v[128:131], a[56:59], a[32:35], v[128:131]
    ds_read_b64_tr_b16 a[24:25], v6 offset:49152
    v_mfma_f32_16x16x32_bf16 v[132:135], a[56:59], a[36:39], v[132:135]
    ds_read_b64_tr_b16 a[26:27], v6 offset:50176
    v_mfma_f32_16x16x32_bf16 v[144:147], a[60:63], a[32:35], v[144:147]
    ds_read_b64_tr_b16 a[28:29], v7 offset:49152
    v_mfma_f32_16x16x32_bf16 v[148:151], a[60:63], a[36:39], v[148:151]
    ds_read_b64_tr_b16 a[30:31], v7 offset:50176
    s_waitcnt lgkmcnt(0)
    v_mfma_f32_16x16x32_bf16 v[96:99], a[16:19], a[0:3], v[96:99]
    ds_read_b128 a[32:35], v2 offset:50176
    ds_read_b64_tr_b16 a[48:49], v4 offset:57344
    v_mfma_f32_16x16x32_bf16 v[100:103], a[16:19], a[4:7], v[100:103]
    ds_read_b64_tr_b16 a[50:51], v4 offset:58368
    ds_read_b128 a[36:39], v2 offset:52224
    v_mfma_f32_16x16x32_bf16 v[112:115], a[20:23], a[0:3], v[112:115]
    ds_read_b64_tr_b16 a[52:53], v5 offset:57344
    v_mfma_f32_16x16x32_bf16 v[116:119], a[20:23], a[4:7], v[116:119]
    ds_read_b64_tr_b16 a[54:55], v5 offset:58368
    v_mfma_f32_16x16x32_bf16 v[128:131], a[24:27], a[0:3], v[128:131]
    ds_read_b64_tr_b16 a[56:57], v6 offset:57344
    v_mfma_f32_16x16x32_bf16 v[132:135], a[24:27], a[4:7], v[132:135]
    ds_read_b64_tr_b16 a[58:59], v6 offset:58368
    v_mfma_f32_16x16x32_bf16 v[144:147], a[28:31], a[0:3], v[144:147]
    ds_read_b64_tr_b16 a[60:61], v7 offset:57344
    v_mfma_f32_16x16x32_bf16 v[148:151], a[28:31], a[4:7], v[148:151]
    ds_read_b64_tr_b16 a[62:63], v7 offset:58368
    s_waitcnt lgkmcnt(0)
    v_mfma_f32_16x16x32_bf16 v[96:99], a[48:51], a[32:35], v[96:99]
    v_mfma_f32_16x16x32_bf16 v[100:103], a[48:51], a[36:39], v[100:103]
    v_mfma_f32_16x16x32_bf16 v[112:115], a[52:55], a[32:35], v[112:115]
    v_mfma_f32_16x16x32_bf16 v[116:119], a[52:55], a[36:39], v[116:119]
    v_mfma_f32_16x16x32_bf16 v[128:131], a[56:59], a[32:35], v[128:131]
    v_mfma_f32_16x16x32_bf16 v[132:135], a[56:59], a[36:39], v[132:135]
    v_mfma_f32_16x16x32_bf16 v[144:147], a[60:63], a[32:35], v[144:147]
    v_mfma_f32_16x16x32_bf16 v[148:151], a[60:63], a[36:39], v[148:151]
    v_lshlrev_b32 v21, 11, v9
    v_bfe_u32 v23, v1, 4, 1
    v_lshl_add_u32 v21, v23, 5, v21
    v_lshrrev_b32 v23, 5, v1
    v_lshl_add_u32 v21, v23, 4, v21
    v_bfe_u32 v23, v1, 3, 1
    v_mul_u32_u24 v25, 16320, v23
    v_sub_u32 v21, v21, v25
    v_cmp_eq_u32 vcc, 0, v23
    v_pk_fma_f32 v[32:33], v[96:97], v[8:9], v[32:33] op_sel_hi:[1,0,1]
    v_pk_fma_f32 v[34:35], v[98:99], v[8:9], v[34:35] op_sel_hi:[1,0,1]
    v_pk_fma_f32 v[48:49], v[112:113], v[8:9], v[48:49] op_sel_hi:[1,0,1]
    v_pk_fma_f32 v[50:51], v[114:115], v[8:9], v[50:51] op_sel_hi:[1,0,1]
    v_pk_fma_f32 v[64:65], v[128:129], v[8:9], v[64:65] op_sel_hi:[1,0,1]
    v_pk_fma_f32 v[66:67], v[130:131], v[8:9], v[66:67] op_sel_hi:[1,0,1]
    v_pk_fma_f32 v[80:81], v[144:145], v[8:9], v[80:81] op_sel_hi:[1,0,1]
    v_pk_fma_f32 v[82:83], v[146:147], v[8:9], v[82:83] op_sel_hi:[1,0,1]
    v_pk_fma_f32 v[36:37], v[100:101], v[10:11], v[36:37] op_sel_hi:[1,0,1]
    v_pk_fma_f32 v[38:39], v[102:103], v[10:11], v[38:39] op_sel_hi:[1,0,1]
    v_pk_fma_f32 v[52:53], v[116:117], v[10:11], v[52:53] op_sel_hi:[1,0,1]
    v_pk_fma_f32 v[54:55], v[118:119], v[10:11], v[54:55] op_sel_hi:[1,0,1]
    v_pk_fma_f32 v[68:69], v[132:133], v[10:11], v[68:69] op_sel_hi:[1,0,1]
    v_pk_fma_f32 v[70:71], v[134:135], v[10:11], v[70:71] op_sel_hi:[1,0,1]
    v_pk_fma_f32 v[84:85], v[148:149], v[10:11], v[84:85] op_sel_hi:[1,0,1]
    v_pk_fma_f32 v[86:87], v[150:151], v[10:11], v[86:87] op_sel_hi:[1,0,1]
    s_waitcnt vmcnt(2)
    v_lshlrev_b32 v40, 16, v176
    v_and_b32 v41, 0xffff0000, v176
    v_lshlrev_b32 v42, 16, v177
    v_and_b32 v43, 0xffff0000, v177
    v_lshlrev_b32 v56, 16, v178
    v_and_b32 v57, 0xffff0000, v178
    v_lshlrev_b32 v58, 16, v179
    v_and_b32 v59, 0xffff0000, v179
    v_lshlrev_b32 v72, 16, v180
    v_and_b32 v73, 0xffff0000, v180
    v_lshlrev_b32 v74, 16, v181
    v_and_b32 v75, 0xffff0000, v181
    v_lshlrev_b32 v88, 16, v182
    v_and_b32 v89, 0xffff0000, v182
    v_lshlrev_b32 v90, 16, v183
    v_and_b32 v91, 0xffff0000, v183
    v_pk_add_f32 v[32:33], v[32:33], v[40:41]
    v_pk_add_f32 v[34:35], v[34:35], v[42:43]
    v_pk_add_f32 v[48:49], v[48:49], v[56:57]
    v_pk_add_f32 v[50:51], v[50:51], v[58:59]
    v_pk_add_f32 v[64:65], v[64:65], v[72:73]
    v_pk_add_f32 v[66:67], v[66:67], v[74:75]
    v_pk_add_f32 v[80:81], v[80:81], v[88:89]
    v_pk_add_f32 v[82:83], v[82:83], v[90:91]
    v_cvt_pk_bf16_f32 v160, v32, v33
    v_cvt_pk_bf16_f32 v161, v34, v35
    v_cvt_pk_bf16_f32 v162, v48, v49
    v_cvt_pk_bf16_f32 v163, v50, v51
    v_cvt_pk_bf16_f32 v164, v64, v65
    v_cvt_pk_bf16_f32 v165, v66, v67
    v_cvt_pk_bf16_f32 v166, v80, v81
    v_cvt_pk_bf16_f32 v167, v82, v83
    v_permlane16_swap_b32 v160, v162
    v_permlane16_swap_b32 v161, v163
    v_permlane16_swap_b32 v164, v166
    v_permlane16_swap_b32 v165, v167
    s_nop 0
    v_cndmask_b32_dpp v104, v164, v160, vcc row_ror:8 row_mask:0xf bank_mask:0xf
    v_cndmask_b32_dpp v105, v165, v161, vcc row_ror:8 row_mask:0xf bank_mask:0xf
    v_cndmask_b32_dpp v106, v166, v162, vcc row_ror:8 row_mask:0xf bank_mask:0xf
    v_cndmask_b32_dpp v107, v167, v163, vcc row_ror:8 row_mask:0xf bank_mask:0xf
    s_not_b64 vcc, vcc
    v_cndmask_b32_dpp v108, v160, v164, vcc row_ror:8 row_mask:0xf bank_mask:0xf
    v_cndmask_b32_dpp v109, v161, v165, vcc row_ror:8 row_mask:0xf bank_mask:0xf
    v_cndmask_b32_dpp v110, v162, v166, vcc row_ror:8 row_mask:0xf bank_mask:0xf
    v_cndmask_b32_dpp v111, v163, v167, vcc row_ror:8 row_mask:0xf bank_mask:0xf
    s_not_b64 vcc, vcc
    buffer_store_dwordx4 v[104:107], v21, s[16:19], s72 offen sc1
    buffer_store_dwordx4 v[108:111], v21, s[16:19], s73 offen sc1
    s_add_u32 s72, s72, 32768
    s_add_u32 s73, s73, 32768
    s_waitcnt vmcnt(2)
    v_lshlrev_b32 v44, 16, v184
    v_and_b32 v45, 0xffff0000, v184
    v_lshlrev_b32 v46, 16, v185
    v_and_b32 v47, 0xffff0000, v185
    v_lshlrev_b32 v60, 16, v186
    v_and_b32 v61, 0xffff0000, v186
    v_lshlrev_b32 v62, 16, v187
    v_and_b32 v63, 0xffff0000, v187
    v_lshlrev_b32 v76, 16, v188
    v_and_b32 v77, 0xffff0000, v188
    v_lshlrev_b32 v78, 16, v189
    v_and_b32 v79, 0xffff0000, v189
    v_lshlrev_b32 v92, 16, v190
    v_and_b32 v93, 0xffff0000, v190
    v_lshlrev_b32 v94, 16, v191
    v_and_b32 v95, 0xffff0000, v191
    v_pk_add_f32 v[36:37], v[36:37], v[44:45]
    v_pk_add_f32 v[38:39], v[38:39], v[46:47]
    v_pk_add_f32 v[52:53], v[52:53], v[60:61]
    v_pk_add_f32 v[54:55], v[54:55], v[62:63]
    v_pk_add_f32 v[68:69], v[68:69], v[76:77]
    v_pk_add_f32 v[70:71], v[70:71], v[78:79]
    v_pk_add_f32 v[84:85], v[84:85], v[92:93]
    v_pk_add_f32 v[86:87], v[86:87], v[94:95]
    v_cvt_pk_bf16_f32 v168, v36, v37
    v_cvt_pk_bf16_f32 v169, v38, v39
    v_cvt_pk_bf16_f32 v170, v52, v53
    v_cvt_pk_bf16_f32 v171, v54, v55
    v_cvt_pk_bf16_f32 v172, v68, v69
    v_cvt_pk_bf16_f32 v173, v70, v71
    v_cvt_pk_bf16_f32 v174, v84, v85
    v_cvt_pk_bf16_f32 v175, v86, v87
    v_permlane16_swap_b32 v168, v170
    v_permlane16_swap_b32 v169, v171
    v_permlane16_swap_b32 v172, v174
    v_permlane16_swap_b32 v173, v175
    s_nop 0
    v_cndmask_b32_dpp v120, v172, v168, vcc row_ror:8 row_mask:0xf bank_mask:0xf
    v_cndmask_b32_dpp v121, v173, v169, vcc row_ror:8 row_mask:0xf bank_mask:0xf
    v_cndmask_b32_dpp v122, v174, v170, vcc row_ror:8 row_mask:0xf bank_mask:0xf
    v_cndmask_b32_dpp v123, v175, v171, vcc row_ror:8 row_mask:0xf bank_mask:0xf
    s_not_b64 vcc, vcc
    v_cndmask_b32_dpp v124, v168, v172, vcc row_ror:8 row_mask:0xf bank_mask:0xf
    v_cndmask_b32_dpp v125, v169, v173, vcc row_ror:8 row_mask:0xf bank_mask:0xf
    v_cndmask_b32_dpp v126, v170, v174, vcc row_ror:8 row_mask:0xf bank_mask:0xf
    v_cndmask_b32_dpp v127, v171, v175, vcc row_ror:8 row_mask:0xf bank_mask:0xf
    s_not_b64 vcc, vcc
    buffer_store_dwordx4 v[120:123], v21, s[16:19], s72 offen sc1
    buffer_store_dwordx4 v[124:127], v21, s[16:19], s73 offen sc1
    s_add_u32 s72, s72, 32768
    s_add_u32 s73, s73, 32768
L_end:
    s_endpgm
L_code_end:
.section .rodata,"a"
.p2align 6
.amdhsa_kernel gated_mix__linear_kernel_hedgehog__glu_gated_glu__prompt_kernel
  .amdhsa_next_free_vgpr 256
  .amdhsa_next_free_sgpr 102
  .amdhsa_accum_offset 192
  .amdhsa_group_segment_fixed_size 0
  .amdhsa_kernarg_size 96
  .amdhsa_user_sgpr_count 2
  .amdhsa_user_sgpr_kernarg_segment_ptr 1
  .amdhsa_system_sgpr_workgroup_id_x 1
.end_amdhsa_kernel
```
